```python
import torch

def _softmax(x, axis=-1):
    return torch.softmax(x, dim=axis)
def _gelu(x):
    return torch.nn.functional.gelu(x, approximate="tanh")
def _silu(x):
    return torch.nn.functional.silu(x)
def _sigmoid(x):
    return torch.sigmoid(x)
def _layernorm(x, axis=-1, eps=1e-5):
    m = x.mean(dim=axis, keepdim=True)
    v = x.var(dim=axis, keepdim=True, unbiased=False)
    return (x - m) / torch.sqrt(v + eps)
def _scatter_add(tgt, idx, src, axis=0):
    return tgt.clone().index_add_(axis, idx, src)
def _segment_sum(src, seg, n):
    out = torch.zeros((n,) + src.shape[1:], dtype=src.dtype)
    return out.index_add_(0, seg, src)
def _pad(x, pw):
    flat = tuple(v for pair in reversed(pw) for v in pair)
    return torch.nn.functional.pad(x, flat)

kernel_name = 'sequential_preLN__grouped_kv_mqa__mixer_token_mlp__prompt'

def setup_inputs():

    _w = (lambda a: (lambda t: t.to(torch.bfloat16) if t.is_floating_point() else t)(torch.as_tensor(a)))
    def _A_setup():
        B, S, D, H = 1, 2048, 640, 32
        Dh = D // H
        return {
            "x": _w((lambda *s: torch.randn(*s, dtype=torch.bfloat16) * 0.05)(B, S, D)),
            "wq": _w((lambda *s: torch.randn(*s, dtype=torch.bfloat16) * 0.05)(D, H * Dh)),
            "wk": _w((lambda *s: torch.randn(*s, dtype=torch.bfloat16) * 0.05)(D, Dh)),
            "wv": _w((lambda *s: torch.randn(*s, dtype=torch.bfloat16) * 0.05)(D, Dh)),
            "wo": _w((lambda *s: torch.randn(*s, dtype=torch.bfloat16) * 0.05)(H * Dh, D)),
        }
    _A_in = _A_setup()

    def _B_setup():
        B, S, D, F = 1, 2048, 640, 1536
        return {
            "x": _w((lambda *s: torch.randn(*s, dtype=torch.bfloat16) * 0.05)(B, S, D)),
            "w1": _w((lambda *s: torch.randn(*s, dtype=torch.bfloat16) * 1.6)(S, F) * (S ** -0.5)),
            "b1": _w((lambda *s: torch.randn(*s, dtype=torch.bfloat16) * 1.6)(F) * 0.02),
            "w2": _w((lambda *s: torch.randn(*s, dtype=torch.bfloat16) * 1.6)(F, S) * (F ** -0.5)),
            "b2": _w((lambda *s: torch.randn(*s, dtype=torch.bfloat16) * 0.8)(S) * 0.02),
        }
    _B_in = _B_setup()

    return {
        "A_x": _A_in["x"],
        "A_wq": _A_in["wq"],
        "A_wk": _A_in["wk"],
        "A_wv": _A_in["wv"],
        "A_wo": _A_in["wo"],
        "B_x": _B_in["x"],
        "B_w1": _B_in["w1"],
        "B_b1": _B_in["b1"],
        "B_w2": _B_in["w2"],
        "B_b2": _B_in["b2"],
    }

def reference(A_x, A_wq, A_wk, A_wv, A_wo, B_x, B_w1, B_b1, B_w2, B_b2):
    def _A_ref(x, wq, wk, wv, wo):
        B, S, D = x.shape
        H = 32
        Dh = D // H
        q = (lambda x, *d: x.permute(*d))((x @ wq).reshape(B, S, H, Dh), 0, 2, 1, 3)
        k = x @ wk
        v = x @ wv
        scores = torch.einsum("bhqd,bkd->bhqk", q, k) * (Dh ** -0.5)
        p = _softmax(scores, axis=-1)
        o = torch.einsum("bhqk,bkd->bhqd", p, v)
        return (lambda x, *d: x.permute(*d))(o, 0, 2, 1, 3).reshape(B, S, H * Dh) @ wo

    def _B_ref(x, w1, b1, w2, b2):
        B, S, D = x.shape
        h = _layernorm(x, axis=-1)
        u = torch.einsum("bsd,sf->bdf", h, w1) + b1
        u = _gelu(u)
        y = torch.einsum("bdf,fs->bds", u, w2) + b2
        return (lambda x, *d: x.permute(*d))(y, 0, 2, 1)

    x = A_x
    h = x + _A_ref(_layernorm(x, axis=-1), A_wq, A_wk, A_wv, A_wo)
    h2 = h + _B_ref(_layernorm(h, axis=-1), B_w1, B_b1, B_w2, B_b2)
    return h2
```

```asm
; @launch grid=(256,1,1) block=(256,1,1) lds=163840
.amdgcn_target "amdgcn-amd-amdhsa--gfx950"
.text
.globl sequential_preLN__grouped_kv_mqa__mixer_token_mlp__prompt_kernel
.p2align 8
.type sequential_preLN__grouped_kv_mqa__mixer_token_mlp__prompt_kernel,@function
sequential_preLN__grouped_kv_mqa__mixer_token_mlp__prompt_kernel:
  s_cmp_ge_u32 s2, 256
  s_cbranch_scc1 L_exit
  s_load_dwordx16 s[4:19], s[0:1], 0
  s_load_dwordx2 s[28:29], s[0:1], 96
  s_getpc_b64 s[100:101]
  v_lshrrev_b32 v1, 6, v0
  v_and_b32 v0, 63, v0
  v_readfirstlane_b32 s64, v1
  v_lshlrev_b32 v64, 7, v0
  s_and_b32 s65, s2, 7
  s_lshr_b32 s66, s2, 3
  s_lshl_b32 s72, s66, 2
  s_add_u32 s3, s72, s64
  s_lshl_b32 s72, s3, 9
  s_min_u32 s72, s72, 44752
  v_add_u32 v66, s72, v64
  s_lshl_b32 s73, s65, 7
  s_add_u32 s73, s73, s3
  s_mul_i32 s73, s73, 2560
  v_add_u32 v67, s73, v64
  s_lshr_b32 s73, s3, 5
  s_lshl_b32 s73, s73, 4
  s_and_b32 s74, s3, 15
  s_add_u32 s73, s73, s74
  s_mul_i32 s73, s73, 12800
  s_bitcmp1_b32 s3, 4
  s_cselect_b32 s74, 6400, 0
  s_cselect_b32 s71, 14, 14
  s_lshr_b64 s[30:31], -1, s71
  s_add_u32 s73, s73, s74
  v_add_u32 v72, s73, v64
  s_mov_b64 exec, 15
  global_load_dword v65, v66, s[100:101]
  s_cmp_lg_u32 s66, 31
  s_waitcnt lgkmcnt(0)
  s_cbranch_scc1 L_noprefill
  s_mov_b64 exec, -1
  s_lshl_b32 s72, s65, 2
  s_add_u32 s72, s72, s64
  s_mul_i32 s73, s72, 6144
  s_add_u32 s73, s73, 3072
  v_lshl_add_u32 v96, v0, 4, s73
  v_mov_b64 v[108:109], -1
  v_mov_b64 v[110:111], -1
  global_store_dwordx4 v96, v[108:111], s[28:29] offset:-3072 sc1
  global_store_dwordx4 v96, v[108:111], s[28:29] offset:-2048 sc1
  global_store_dwordx4 v96, v[108:111], s[28:29] offset:-1024 sc1
  global_store_dwordx4 v96, v[108:111], s[28:29] offset:0 sc1
  global_store_dwordx4 v96, v[108:111], s[28:29] offset:1024 sc1
  global_store_dwordx4 v96, v[108:111], s[28:29] offset:2048 sc1
  s_lshl_b32 s72, s72, 7
  s_add_u32 s72, s72, 196608
  v_lshl_add_u32 v97, v0, 2, s72
  v_mov_b32 v98, 0
  s_mov_b64 exec, 15
  global_store_dword v97, v98, s[28:29] sc1
L_noprefill:
  s_mov_b64 exec, 0xfffff
  global_load_dword v65, v67, s[4:5]
  s_mov_b64 exec, s[30:31]
  global_load_dword v65, v72, s[6:7]
  s_mov_b64 exec, -1
  v_lshlrev_b32 v1, 4, v0
  s_mul_i32 s30, s64, 6144
  s_bitcmp1_b32 s66, 1
  s_cselect_b64 s[38:39], s[10:11], s[8:9]
  s_load_dwordx8 s[20:27], s[0:1], 64
  v_and_b32 v2, 15, v0
  v_lshrrev_b32 v3, 4, v0
  s_lshr_b32 s71, s66, 3
  s_lshl_b32 s67, s65, 2
  s_add_u32 s67, s67, s71
  s_and_b32 s68, s66, 7
  s_mov_b32 s76, 0xffff0000
  s_mov_b32 s31, 0
  s_mov_b32 s75, 400000
  v_lshrrev_b32 v60, 3, v0
  v_and_b32 v61, 7, v0
  v_xor_b32 v62, v61, v3
  v_mul_u32_u24 v63, 1280, v60
  v_lshl_add_u32 v76, v62, 4, v63
  v_xor_b32 v62, 4, v62
  v_lshl_add_u32 v77, v62, 4, v63
  v_add_u32 v77, 9216, v77
  s_lshl_b32 s78, s67, 2
  s_add_u32 s78, s78, s64
  s_mul_i32 s78, s78, 20480
  s_mul_i32 s89, s64, 20480
  s_mov_b64 s[32:33], s[4:5]
  s_mov_b32 s34, 2621440
  s_mov_b32 s35, 0x20000
  s_waitcnt lgkmcnt(0)
  s_mov_b64 s[60:61], s[28:29]
  s_mov_b32 s62, 16777216
  s_mov_b32 s63, 0x20000
  s_add_u32 s44, s4, s78
  s_addc_u32 s45, s5, 0
  v_bfe_u32 v60, v0, 2, 2
  v_and_b32 v61, 3, v0
  v_and_b32 v62, 1, v3
  v_lshl_add_u32 v63, v3, 3, v60
  v_lshlrev_b32 v72, 1, v62
  v_xor_b32 v72, v72, v61
  v_mul_u32_u24 v73, 1280, v63
  v_lshl_add_u32 v72, v72, 4, v73
  v_add_u32 v138, 2048, v72
  v_add_u32 v139, 1088, v72
  v_add_u32 v140, 128, v72
  v_add_u32 v141, 7168, v72
  v_add_u32 v142, 6208, v72
  v_add_u32 v143, 5248, v72
  s_mul_i32 s73, s68, 160
  s_add_u32 s10, s78, s73
  s_and_b32 s79, s73, 0xffc0
  s_mul_i32 s73, s64, 40960
  s_add_u32 s79, s79, s73
  s_add_u32 s46, s6, s79
  s_addc_u32 s47, s7, 0
  s_sub_u32 s46, s46, 2048
  s_subb_u32 s47, s47, 0
  v_mul_u32_u24 v63, 40, v63
  v_lshl_add_u32 v63, v61, 3, v63
  s_and_b32 s74, s68, 1
  s_lshl_b32 s73, s74, 5
  s_add_u32 s73, s73, 81920
  v_add_u32 v92, s73, v63
  v_lshrrev_b32 v63, 2, v0
  v_lshlrev_b32 v63, 6, v63
  v_lshl_add_u32 v63, v61, 3, v63
  v_xor_b32 v72, s74, v62
  v_lshl_add_u32 v87, v72, 5, v63
  s_lshl_b32 s74, s74, 10
  v_xor_b32 v72, 32, v87
  v_add_u32 v88, s74, v72
  v_add_u32 v85, 107520, v87
  v_add_u32 v89, 61440, v87
  v_add_u32 v86, 107520, v88
  v_add_u32 v90, 61440, v88
  v_lshrrev_b32 v63, 1, v2
  v_lshlrev_b32 v72, 7, v2
  v_add_u32 v72, s89, v72
  v_xor_b32 v63, v3, v63
  v_lshl_add_u32 v83, v63, 4, v72
  v_xor_b32 v84, 64, v83
  v_mov_b64 v[68:69], 0
  v_mov_b64 v[70:71], 0
  v_mov_b64 v[94:95], 0
  s_mov_b32 s90, 0x3f803f80
  s_nop 0
  v_mfma_f32_32x32x4_2b_bf16 a[0:31], v[94:95], v[94:95], 0
  v_mfma_f32_32x32x4_2b_bf16 a[32:63], v[94:95], v[94:95], 0
  v_mfma_f32_32x32x4_2b_bf16 a[64:95], v[94:95], v[94:95], 0
  v_mfma_f32_32x32x4_2b_bf16 v[148:179], v[94:95], v[94:95], 0
  v_lshlrev_b32 v4, 3, v0
  v_bfe_u32 v60, v0, 2, 2
  v_and_b32 v61, 3, v0
  v_and_b32 v62, 1, v3
  s_mul_i32 s94, s64, 39936
  v_lshrrev_b32 v74, 5, v0
  v_lshlrev_b32 v63, 10, v74
  v_lshl_add_u32 v63, v60, 7, v63
  v_lshl_add_u32 v63, v61, 3, v63
  s_and_b32 s74, s64, 1
  v_xor_b32 v73, s74, v62
  v_lshl_add_u32 v63, v73, 5, v63
  v_lshrrev_b32 v73, 1, v60
  s_lshr_b32 s74, s64, 1
  v_xor_b32 v73, s74, v73
  v_lshl_add_u32 v63, v73, 6, v63
  v_add_u32 v21, s94, v63
  v_xor_b32 v22, 64, v21
  v_lshrrev_b32 v60, 3, v0
  v_and_b32 v61, 7, v0
  v_lshlrev_b32 v62, 2, v62
  v_xor_b32 v61, v61, v62
  v_mul_u32_u24 v63, 3072, v60
  v_lshl_add_u32 v20, v61, 4, v63
  s_movk_i32 s73, 1280
  v_add_u32 v60, 0, v0
  v_mul_u32_u24 v61, 6554, v60
  v_lshrrev_b32 v61, 16, v61
  v_mul_u32_u24 v62, 10, v61
  v_sub_u32 v60, v60, v62
  v_lshlrev_b32 v60, 4, v60
  v_and_b32 v62, 15, v61
  v_lshrrev_b32 v63, 4, v61
  v_lshrrev_b32 v72, 3, v62
  v_mad_u32_u24 v72, v72, 12, v62
  v_lshl_add_u32 v72, v63, 3, v72
  v_mad_u32_u24 v8, v72, s73, v60
  v_lshrrev_b32 v72, 1, v62
  v_mad_u32_u24 v72, v72, 18, v62
  v_lshl_add_u32 v72, v63, 1, v72
  v_add_u32 v72, 16, v72
  v_mad_u32_u24 v13, v72, s73, v60
  v_add_u32 v60, 64, v0
  v_mul_u32_u24 v61, 6554, v60
  v_lshrrev_b32 v61, 16, v61
  v_mul_u32_u24 v62, 10, v61
  v_sub_u32 v60, v60, v62
  v_lshlrev_b32 v60, 4, v60
  v_subrev_u32 v60, 1024, v60
  v_and_b32 v62, 15, v61
  v_lshrrev_b32 v63, 4, v61
  v_lshrrev_b32 v72, 3, v62
  v_mad_u32_u24 v72, v72, 12, v62
  v_lshl_add_u32 v72, v63, 3, v72
  v_mad_u32_u24 v9, v72, s73, v60
  v_lshrrev_b32 v72, 1, v62
  v_mad_u32_u24 v72, v72, 18, v62
  v_lshl_add_u32 v72, v63, 1, v72
  v_add_u32 v72, 16, v72
  v_mad_u32_u24 v14, v72, s73, v60
  v_add_u32 v60, 128, v0
  v_mul_u32_u24 v61, 6554, v60
  v_lshrrev_b32 v61, 16, v61
  v_mul_u32_u24 v62, 10, v61
  v_sub_u32 v60, v60, v62
  v_lshlrev_b32 v60, 4, v60
  v_subrev_u32 v60, 2048, v60
  v_and_b32 v62, 15, v61
  v_lshrrev_b32 v63, 4, v61
  v_lshrrev_b32 v72, 3, v62
  v_mad_u32_u24 v72, v72, 12, v62
  v_lshl_add_u32 v72, v63, 3, v72
  v_mad_u32_u24 v10, v72, s73, v60
  v_lshrrev_b32 v72, 1, v62
  v_mad_u32_u24 v72, v72, 18, v62
  v_lshl_add_u32 v72, v63, 1, v72
  v_add_u32 v72, 16, v72
  v_mad_u32_u24 v15, v72, s73, v60
  v_add_u32 v60, 192, v0
  v_mul_u32_u24 v61, 6554, v60
  v_lshrrev_b32 v61, 16, v61
  v_mul_u32_u24 v62, 10, v61
  v_sub_u32 v60, v60, v62
  v_lshlrev_b32 v60, 4, v60
  v_subrev_u32 v60, 3072, v60
  v_and_b32 v62, 15, v61
  v_lshrrev_b32 v63, 4, v61
  v_lshrrev_b32 v72, 3, v62
  v_mad_u32_u24 v72, v72, 12, v62
  v_lshl_add_u32 v72, v63, 3, v72
  v_mad_u32_u24 v11, v72, s73, v60
  v_lshrrev_b32 v72, 1, v62
  v_mad_u32_u24 v72, v72, 18, v62
  v_lshl_add_u32 v72, v63, 1, v72
  v_add_u32 v72, 16, v72
  v_mad_u32_u24 v16, v72, s73, v60
  v_add_u32 v60, 256, v0
  v_mul_u32_u24 v61, 6554, v60
  v_lshrrev_b32 v61, 16, v61
  v_mul_u32_u24 v62, 10, v61
  v_sub_u32 v60, v60, v62
  v_lshlrev_b32 v60, 4, v60
  v_and_b32 v62, 15, v61
  v_lshrrev_b32 v63, 4, v61
  v_lshrrev_b32 v72, 3, v62
  v_mad_u32_u24 v72, v72, 12, v62
  v_lshl_add_u32 v72, v63, 3, v72
  v_mad_u32_u24 v12, v72, s73, v60
  v_lshrrev_b32 v72, 1, v62
  v_mad_u32_u24 v72, v72, 18, v62
  v_lshl_add_u32 v72, v63, 1, v72
  v_add_u32 v72, 16, v72
  v_mad_u32_u24 v17, v72, s73, v60
  s_and_b32 s73, s64, 1
  s_lshl_b32 s73, s73, 4
  v_add_u32 v60, s73, v2
  v_lshlrev_b32 v61, 9, v3
  v_lshl_add_u32 v18, v60, 4, v61
  s_lshl_b32 s74, s74, 12
  s_add_u32 s74, s74, 98304
  v_mul_u32_u24 v60, 88, v60
  v_lshl_add_u32 v60, v3, 3, v60
  v_add_u32 v124, s74, v60
  v_mul_u32_u24 v60, 8112, v74
  v_add_u32 v125, v124, v60
  s_lshl_b32 s73, s64, 12
  s_add_u32 s73, s73, 98304
  v_and_b32 v60, 31, v0
  v_mul_u32_u24 v61, 88, v60
  v_add_u32 v61, s73, v61
  v_lshl_add_u32 v129, v74, 4, v61
  v_mad_u32_u24 v133, v74, 40, v61
  v_xor_b32 v130, 4096, v129
  v_xor_b32 v134, 4096, v133
  v_xor_b32 v131, 8192, v129
  v_xor_b32 v135, 8192, v133
  v_xor_b32 v132, 12288, v129
  v_xor_b32 v136, 12288, v133
  v_mov_b32 v5, 0xdddddddd
  v_min_u32 v60, 23, v60
  v_mul_u32_u24 v61, 384, v74
  v_lshl_add_u32 v60, v60, 4, v61
  v_add_u32 v6, 3072, v60
  v_mul_u32_u24 v60, 1280, v2
  v_lshl_add_u32 v19, v3, 3, v60
  s_xor_b32 s73, s64, 0
  s_mul_i32 s73, s73, 39936
  s_add_u32 s73, s73, 24576
  v_add_u32 v26, s73, v1
  s_xor_b32 s73, s64, 1
  s_mul_i32 s73, s73, 39936
  s_add_u32 s73, s73, 24576
  v_add_u32 v23, s73, v1
  s_xor_b32 s73, s64, 2
  s_mul_i32 s73, s73, 39936
  s_add_u32 s73, s73, 24576
  v_add_u32 v24, s73, v1
  s_xor_b32 s73, s64, 3
  s_mul_i32 s73, s73, 39936
  s_add_u32 s73, s73, 24576
  v_add_u32 v25, s73, v1
  s_lshl_b32 s92, s65, 2
  s_add_u32 s92, s92, s64
  s_mul_i32 s72, s67, 6144
  v_mov_b32 v75, 2130706432
  s_lshr_b32 s73, s64, 1
  s_lshl_b32 s73, s73, 10
  s_add_u32 s73, s73, s72
  v_and_b32 v60, 0x1ff, v18
  v_lshl_add_u32 v60, v74, 9, v60
  v_add_u32 v60, s73, v60
  s_cmp_eq_u32 s68, 0
  s_cselect_b32 vcc_lo, 0xffff, 0
  s_mov_b32 vcc_hi, vcc_lo
  v_cndmask_b32 v79, v75, v60, vcc
  s_lshl_b32 s73, s64, 7
  s_add_u32 s73, s73, s72
  v_add_u32 v60, s73, v4
  s_cmp_eq_u32 s68, 1
  s_cselect_b32 vcc_lo, 0xffff, 0
  s_mov_b32 vcc_hi, 0
  v_cndmask_b32 v80, v75, v60, vcc
  s_mul_i32 s73, s64, 768
  s_add_u32 s73, s73, s72
  s_and_b32 s74, s68, 1
  v_and_b32 v60, 2, v2
  v_bfe_u32 v61, v2, 2, 1
  v_lshlrev_b32 v61, 1, v61
  v_sub_u32 v60, v60, v61
  v_add_u32 v60, 16, v60
  v_mad_u32_u24 v60, v60, s74, v2
  v_mul_u32_u24 v61, 384, v74
  v_lshl_add_u32 v60, v60, 4, v61
  v_add_u32 v60, s73, v60
  s_cmp_eq_u32 s68, 2
  s_cselect_b32 vcc_lo, 0xffff, 0
  s_cmp_eq_u32 s68, 3
  s_cselect_b32 vcc_lo, 0xff, vcc_lo
  s_mov_b32 vcc_hi, vcc_lo
  v_cndmask_b32 v81, v75, v60, vcc
  s_cselect_b32 s42, 0xffff0000, 0
  s_mov_b32 s43, 0
  s_cmp_lt_u32 s68, 2
  s_cselect_b32 s41, 0x3ea52b5c, 1.0
  s_lshl_b32 s73, s64, 10
  s_add_u32 s73, s73, 156672
  v_mul_u32_u24 v60, 40, v2
  v_lshl_add_u32 v60, v3, 3, v60
  v_add_u32 v82, s73, v60
  v_bfe_u32 v60, v0, 2, 2
  v_lshl_add_u32 v60, v74, 3, v60
  v_mul_u32_u24 v60, 40, v60
  v_and_b32 v61, 3, v0
  v_lshl_add_u32 v60, v61, 3, v60
  v_add_u32 v91, s73, v60
  v_mov_b32 v93, 0x3f80
  s_mov_b64 s[48:49], s[16:17]
  s_mov_b32 s50, 6291456
  s_mov_b32 s51, 0x20000
  s_min_u32 s69, s66, 29
  s_mul_i32 s73, s69, 52
  s_lshr_b32 s73, s73, 8
  s_mul_i32 s74, s73, 5
  s_sub_u32 s69, s69, s74
  s_mul_i32 s5, s69, 13
  s_lshr_b32 s5, s5, 3
  s_and_b32 s74, s65, 1
  s_mul_i32 s74, s74, 5
  s_add_u32 s69, s69, s74
  s_lshr_b32 s74, s65, 1
  s_mul_i32 s74, s74, 6
  s_add_u32 s70, s73, s74
  s_mul_i32 s93, s64, 1572864
  s_lshl_b32 s73, s70, 7
  s_add_u32 s93, s93, s73
  s_cmp_lg_u32 s66, 31
  s_cbranch_scc1 L_nosignal
  s_waitcnt vmcnt(2)
  s_barrier
  s_cmp_lg_u32 s64, 0
  s_cbranch_scc1 L_nosignal
  s_lshl_b32 s73, s65, 2
  v_mov_b32 v60, s73
  v_mov_b32 v61, 1
  s_mov_b64 exec, 1
  global_store_dword v60, v61, s[26:27] sc1
  s_mov_b64 exec, -1
L_nosignal:
  s_bitcmp1_b32 s66, 2
  s_cbranch_scc1 L_nowkv
  s_add_u32 m0, s30, 81920
  v_add_u32 v73, s30, v1
  global_load_lds_dwordx4 v73, s[38:39] offset:0
  global_load_lds_dwordx4 v73, s[38:39] offset:1024
  global_load_lds_dwordx4 v73, s[38:39] offset:2048
  global_load_lds_dwordx4 v73, s[38:39] offset:3072
  s_add_u32 m0, s30, 86016
  v_add_u32 v73, 4096, v73
  global_load_lds_dwordx4 v73, s[38:39] offset:0
  global_load_lds_dwordx4 v73, s[38:39] offset:1024
  global_load_lds_dwordx4 v73, s[38:39] offset:2048
L_nowkv:
  s_add_u32 m0, s89, 0
  s_nop 0
  global_load_lds_dwordx4 v76, s[44:45] offset:0
  global_load_lds_dwordx4 v77, s[44:45] offset:1024
  s_add_u32 m0, s89, 1920
  s_nop 0
  global_load_lds_dwordx4 v76, s[44:45] offset:128
  global_load_lds_dwordx4 v77, s[44:45] offset:1152
  s_add_u32 m0, s89, 3840
  s_nop 0
  global_load_lds_dwordx4 v76, s[44:45] offset:256
  global_load_lds_dwordx4 v77, s[44:45] offset:1280
  s_add_u32 m0, s89, 5760
  s_nop 0
  global_load_lds_dwordx4 v76, s[44:45] offset:384
  global_load_lds_dwordx4 v77, s[44:45] offset:1408
  s_add_u32 m0, s89, 7680
  s_nop 0
  global_load_lds_dwordx4 v76, s[44:45] offset:512
  global_load_lds_dwordx4 v77, s[44:45] offset:1536
  s_add_u32 m0, s89, 9600
  s_waitcnt vmcnt(8)
  s_barrier
  ds_read_b128 v[180:183], v83 offset:0
  ds_read_b128 v[184:187], v84 offset:0
  global_load_lds_dwordx4 v76, s[44:45] offset:640
  global_load_lds_dwordx4 v77, s[44:45] offset:1664
  s_add_u32 m0, s89, 11520
  ds_read_b64_tr_b16 a[176:177], v92 offset:0
  ds_read_b64_tr_b16 a[178:179], v92 offset:160
  ds_read_b64_tr_b16 a[180:181], v92 offset:1280
  ds_read_b64_tr_b16 a[182:183], v92 offset:1440
  ds_read_b64_tr_b16 a[184:185], v92 offset:2560
  ds_read_b64_tr_b16 a[186:187], v92 offset:2720
  ds_read_b64_tr_b16 a[188:189], v92 offset:3840
  ds_read_b64_tr_b16 a[190:191], v92 offset:4000
  s_waitcnt vmcnt(8)
  ds_read_b128 v[188:191], v83 offset:2048
  ds_read_b128 v[192:195], v84 offset:2048
  global_load_lds_dwordx4 v76, s[44:45] offset:768
  s_waitcnt lgkmcnt(10)
  v_dot2c_f32_bf16 v68, s90, v180
  v_dot2c_f32_bf16 v70, v180, v180
  v_dot2c_f32_bf16 v69, s90, v181
  v_dot2c_f32_bf16 v71, v181, v181
  v_dot2c_f32_bf16 v68, s90, v182
  v_dot2c_f32_bf16 v70, v182, v182
  v_dot2c_f32_bf16 v69, s90, v183
  v_dot2c_f32_bf16 v71, v183, v183
  global_load_lds_dwordx4 v77, s[44:45] offset:1792
  s_add_u32 m0, s89, 13440
  ds_read_b64_tr_b16 a[192:193], v92 offset:5120
  ds_read_b64_tr_b16 a[194:195], v92 offset:5280
  ds_read_b64_tr_b16 a[196:197], v92 offset:6400
  ds_read_b64_tr_b16 a[198:199], v92 offset:6560
  v_dot2c_f32_bf16 v68, s90, v184
  v_dot2c_f32_bf16 v70, v184, v184
  v_dot2c_f32_bf16 v69, s90, v185
  v_dot2c_f32_bf16 v71, v185, v185
  v_dot2c_f32_bf16 v68, s90, v186
  v_dot2c_f32_bf16 v70, v186, v186
  v_dot2c_f32_bf16 v69, s90, v187
  v_dot2c_f32_bf16 v71, v187, v187
  s_waitcnt vmcnt(8)
  ds_read_b128 v[196:199], v83 offset:4096
  ds_read_b128 v[200:203], v84 offset:4096
  global_load_lds_dwordx4 v76, s[44:45] offset:896
  s_waitcnt lgkmcnt(6)
  v_dot2c_f32_bf16 v68, s90, v188
  v_dot2c_f32_bf16 v70, v188, v188
  v_dot2c_f32_bf16 v69, s90, v189
  v_dot2c_f32_bf16 v71, v189, v189
  v_dot2c_f32_bf16 v68, s90, v190
  v_dot2c_f32_bf16 v70, v190, v190
  v_dot2c_f32_bf16 v69, s90, v191
  v_dot2c_f32_bf16 v71, v191, v191
  global_load_lds_dwordx4 v77, s[44:45] offset:1920
  s_add_u32 m0, s89, 15360
  ds_read_b64_tr_b16 a[200:201], v92 offset:7680
  ds_read_b64_tr_b16 a[202:203], v92 offset:7840
  ds_read_b64_tr_b16 a[204:205], v92 offset:8960
  ds_read_b64_tr_b16 a[206:207], v92 offset:9120
  v_dot2c_f32_bf16 v68, s90, v192
  v_dot2c_f32_bf16 v70, v192, v192
  v_dot2c_f32_bf16 v69, s90, v193
  v_dot2c_f32_bf16 v71, v193, v193
  v_dot2c_f32_bf16 v68, s90, v194
  v_dot2c_f32_bf16 v70, v194, v194
  v_dot2c_f32_bf16 v69, s90, v195
  v_dot2c_f32_bf16 v71, v195, v195
  s_waitcnt vmcnt(8)
  ds_read_b128 v[204:207], v83 offset:6144
  ds_read_b128 v[208:211], v84 offset:6144
  global_load_lds_dwordx4 v76, s[44:45] offset:1024
  s_waitcnt lgkmcnt(6)
  v_dot2c_f32_bf16 v68, s90, v196
  v_dot2c_f32_bf16 v70, v196, v196
  v_dot2c_f32_bf16 v69, s90, v197
  v_dot2c_f32_bf16 v71, v197, v197
  v_dot2c_f32_bf16 v68, s90, v198
  v_dot2c_f32_bf16 v70, v198, v198
  v_dot2c_f32_bf16 v69, s90, v199
  v_dot2c_f32_bf16 v71, v199, v199
  global_load_lds_dwordx4 v77, s[44:45] offset:2048
  s_add_u32 m0, s89, 17280
  ds_read_b64_tr_b16 a[208:209], v92 offset:10240
  ds_read_b64_tr_b16 a[210:211], v92 offset:10400
  ds_read_b64_tr_b16 a[212:213], v92 offset:11520
  ds_read_b64_tr_b16 a[214:215], v92 offset:11680
  v_dot2c_f32_bf16 v68, s90, v200
  v_dot2c_f32_bf16 v70, v200, v200
  v_dot2c_f32_bf16 v69, s90, v201
  v_dot2c_f32_bf16 v71, v201, v201
  v_dot2c_f32_bf16 v68, s90, v202
  v_dot2c_f32_bf16 v70, v202, v202
  v_dot2c_f32_bf16 v69, s90, v203
  v_dot2c_f32_bf16 v71, v203, v203
  s_waitcnt vmcnt(8)
  ds_read_b128 v[212:215], v83 offset:8192
  ds_read_b128 v[216:219], v84 offset:8192
  global_load_lds_dwordx4 v76, s[44:45] offset:1152
  s_waitcnt lgkmcnt(6)
  v_dot2c_f32_bf16 v68, s90, v204
  v_dot2c_f32_bf16 v70, v204, v204
  v_dot2c_f32_bf16 v69, s90, v205
  v_dot2c_f32_bf16 v71, v205, v205
  v_dot2c_f32_bf16 v68, s90, v206
  v_dot2c_f32_bf16 v70, v206, v206
  v_dot2c_f32_bf16 v69, s90, v207
  v_dot2c_f32_bf16 v71, v207, v207
  global_load_lds_dwordx4 v77, s[44:45] offset:2176
  s_add_u32 m0, s30, 107520
  ds_read_b64_tr_b16 a[216:217], v92 offset:12800
  ds_read_b64_tr_b16 a[218:219], v92 offset:12960
  ds_read_b64_tr_b16 a[220:221], v92 offset:14080
  ds_read_b64_tr_b16 a[222:223], v92 offset:14240
  v_dot2c_f32_bf16 v68, s90, v208
  v_dot2c_f32_bf16 v70, v208, v208
  v_dot2c_f32_bf16 v69, s90, v209
  v_dot2c_f32_bf16 v71, v209, v209
  v_dot2c_f32_bf16 v68, s90, v210
  v_dot2c_f32_bf16 v70, v210, v210
  v_dot2c_f32_bf16 v69, s90, v211
  v_dot2c_f32_bf16 v71, v211, v211
  s_waitcnt vmcnt(8)
  ds_read_b128 v[220:223], v83 offset:10240
  ds_read_b128 v[224:227], v84 offset:10240
  global_load_lds_dwordx4 v138, s[46:47] offset:0
  s_waitcnt lgkmcnt(6)
  v_dot2c_f32_bf16 v68, s90, v212
  v_dot2c_f32_bf16 v70, v212, v212
  v_dot2c_f32_bf16 v69, s90, v213
  v_dot2c_f32_bf16 v71, v213, v213
  v_dot2c_f32_bf16 v68, s90, v214
  v_dot2c_f32_bf16 v70, v214, v214
  v_dot2c_f32_bf16 v69, s90, v215
  v_dot2c_f32_bf16 v71, v215, v215
  ds_read_b64_tr_b16 a[224:225], v92 offset:15360
  ds_read_b64_tr_b16 a[226:227], v92 offset:15520
  ds_read_b64_tr_b16 a[228:229], v92 offset:16640
  ds_read_b64_tr_b16 a[230:231], v92 offset:16800
  v_dot2c_f32_bf16 v68, s90, v216
  v_dot2c_f32_bf16 v70, v216, v216
  v_dot2c_f32_bf16 v69, s90, v217
  v_dot2c_f32_bf16 v71, v217, v217
  v_dot2c_f32_bf16 v68, s90, v218
  v_dot2c_f32_bf16 v70, v218, v218
  v_dot2c_f32_bf16 v69, s90, v219
  v_dot2c_f32_bf16 v71, v219, v219
  s_waitcnt vmcnt(7)
  ds_read_b128 v[228:231], v83 offset:12288
  ds_read_b128 v[232:235], v84 offset:12288
  global_load_lds_dwordx4 v139, s[46:47] offset:1024
  s_waitcnt lgkmcnt(6)
  v_dot2c_f32_bf16 v68, s90, v220
  v_dot2c_f32_bf16 v70, v220, v220
  v_dot2c_f32_bf16 v69, s90, v221
  v_dot2c_f32_bf16 v71, v221, v221
  v_dot2c_f32_bf16 v68, s90, v222
  v_dot2c_f32_bf16 v70, v222, v222
  v_dot2c_f32_bf16 v69, s90, v223
  v_dot2c_f32_bf16 v71, v223, v223
  ds_read_b64_tr_b16 a[232:233], v92 offset:17920
  ds_read_b64_tr_b16 a[234:235], v92 offset:18080
  ds_read_b64_tr_b16 a[236:237], v92 offset:19200
  ds_read_b64_tr_b16 a[238:239], v92 offset:19360
  v_dot2c_f32_bf16 v68, s90, v224
  v_dot2c_f32_bf16 v70, v224, v224
  v_dot2c_f32_bf16 v69, s90, v225
  v_dot2c_f32_bf16 v71, v225, v225
  v_dot2c_f32_bf16 v68, s90, v226
  v_dot2c_f32_bf16 v70, v226, v226
  v_dot2c_f32_bf16 v69, s90, v227
  v_dot2c_f32_bf16 v71, v227, v227
  s_waitcnt vmcnt(6)
  ds_read_b128 v[236:239], v83 offset:14336
  ds_read_b128 v[240:243], v84 offset:14336
  global_load_lds_dwordx4 v140, s[46:47] offset:2048
  s_add_u32 m0, s30, 110592
  s_waitcnt lgkmcnt(6)
  v_dot2c_f32_bf16 v68, s90, v228
  v_dot2c_f32_bf16 v70, v228, v228
  v_dot2c_f32_bf16 v69, s90, v229
  v_dot2c_f32_bf16 v71, v229, v229
  v_dot2c_f32_bf16 v68, s90, v230
  v_dot2c_f32_bf16 v70, v230, v230
  v_dot2c_f32_bf16 v69, s90, v231
  v_dot2c_f32_bf16 v71, v231, v231
  ds_read_b64_tr_b16 a[240:241], v92 offset:20480
  ds_read_b64_tr_b16 a[242:243], v92 offset:20640
  ds_read_b64_tr_b16 a[244:245], v92 offset:21760
  ds_read_b64_tr_b16 a[246:247], v92 offset:21920
  v_dot2c_f32_bf16 v68, s90, v232
  v_dot2c_f32_bf16 v70, v232, v232
  v_dot2c_f32_bf16 v69, s90, v233
  v_dot2c_f32_bf16 v71, v233, v233
  v_dot2c_f32_bf16 v68, s90, v234
  v_dot2c_f32_bf16 v70, v234, v234
  v_dot2c_f32_bf16 v69, s90, v235
  v_dot2c_f32_bf16 v71, v235, v235
  s_waitcnt vmcnt(5)
  ds_read_b128 v[244:247], v83 offset:16384
  ds_read_b128 v[248:251], v84 offset:16384
  global_load_lds_dwordx4 v141, s[46:47] offset:0
  s_waitcnt lgkmcnt(6)
  v_dot2c_f32_bf16 v68, s90, v236
  v_dot2c_f32_bf16 v70, v236, v236
  v_dot2c_f32_bf16 v69, s90, v237
  v_dot2c_f32_bf16 v71, v237, v237
  v_dot2c_f32_bf16 v68, s90, v238
  v_dot2c_f32_bf16 v70, v238, v238
  v_dot2c_f32_bf16 v69, s90, v239
  v_dot2c_f32_bf16 v71, v239, v239
  ds_read_b64_tr_b16 a[248:249], v92 offset:23040
  ds_read_b64_tr_b16 a[250:251], v92 offset:23200
  ds_read_b64_tr_b16 a[252:253], v92 offset:24320
  ds_read_b64_tr_b16 a[254:255], v92 offset:24480
  v_dot2c_f32_bf16 v68, s90, v240
  v_dot2c_f32_bf16 v70, v240, v240
  v_dot2c_f32_bf16 v69, s90, v241
  v_dot2c_f32_bf16 v71, v241, v241
  v_dot2c_f32_bf16 v68, s90, v242
  v_dot2c_f32_bf16 v70, v242, v242
  v_dot2c_f32_bf16 v69, s90, v243
  v_dot2c_f32_bf16 v71, v243, v243
  s_waitcnt vmcnt(4)
  ds_read_b128 v[252:255], v83 offset:18432
  ds_read_b128 v[144:147], v84 offset:18432
  global_load_lds_dwordx4 v142, s[46:47] offset:1024
  s_waitcnt lgkmcnt(6)
  v_dot2c_f32_bf16 v68, s90, v244
  v_dot2c_f32_bf16 v70, v244, v244
  v_dot2c_f32_bf16 v69, s90, v245
  v_dot2c_f32_bf16 v71, v245, v245
  v_dot2c_f32_bf16 v68, s90, v246
  v_dot2c_f32_bf16 v70, v246, v246
  v_dot2c_f32_bf16 v69, s90, v247
  v_dot2c_f32_bf16 v71, v247, v247
  v_dot2c_f32_bf16 v68, s90, v248
  v_dot2c_f32_bf16 v70, v248, v248
  v_dot2c_f32_bf16 v69, s90, v249
  v_dot2c_f32_bf16 v71, v249, v249
  v_dot2c_f32_bf16 v68, s90, v250
  v_dot2c_f32_bf16 v70, v250, v250
  v_dot2c_f32_bf16 v69, s90, v251
  v_dot2c_f32_bf16 v71, v251, v251
  s_waitcnt lgkmcnt(0)
  s_load_dwordx8 s[80:87], s[26:27], 0
  global_load_lds_dwordx4 v143, s[46:47] offset:2048
  s_add_u32 m0, s30, 132096
  s_add_u32 s46, s46, 163840
  s_addc_u32 s47, s47, 0
  v_dot2c_f32_bf16 v68, s90, v252
  v_dot2c_f32_bf16 v70, v252, v252
  v_dot2c_f32_bf16 v69, s90, v253
  v_dot2c_f32_bf16 v71, v253, v253
  v_dot2c_f32_bf16 v68, s90, v254
  v_dot2c_f32_bf16 v70, v254, v254
  v_dot2c_f32_bf16 v69, s90, v255
  v_dot2c_f32_bf16 v71, v255, v255
  global_load_lds_dwordx4 v138, s[46:47] offset:0
  v_dot2c_f32_bf16 v68, s90, v144
  v_dot2c_f32_bf16 v70, v144, v144
  v_dot2c_f32_bf16 v69, s90, v145
  v_dot2c_f32_bf16 v71, v145, v145
  v_dot2c_f32_bf16 v68, s90, v146
  v_dot2c_f32_bf16 v70, v146, v146
  v_dot2c_f32_bf16 v69, s90, v147
  v_dot2c_f32_bf16 v71, v147, v147
  s_nop 1
  v_add_f32 v68, v68, v69
  v_add_f32 v69, v70, v71
  s_nop 1
  v_permlane32_swap_b32 v68, v69
  v_add_f32 v68, v68, v69
  v_mov_b32 v69, v68
  s_nop 1
  v_permlane16_swap_b32 v68, v69
  v_add_f32 v68, v68, v69
  v_mov_b32 v69, v68
  s_movk_i32 s90, 0x3f80
  s_mov_b32 s91, 0x3f800000
  v_permlane32_swap_b32 v68, v69
  v_mul_f32 v68, 0xbacccccd, v68
  v_mul_f32 v66, 0x3acccccd, v69
  v_fma_f32 v66, -v68, v68, v66
  v_max_f32 v66, 0, v66
  v_add_f32 v66, 0x3727c5ac, v66
  v_rsq_f32 v70, v66
  v_dot2_f32_bf16 v60, v180, s90, v68
  v_dot2_f32_bf16 v61, v180, s91, v68
  v_dot2_f32_bf16 v62, v181, s90, v68
  v_dot2_f32_bf16 v63, v181, s91, v68
  v_dot2_f32_bf16 v64, v182, s90, v68
  v_dot2_f32_bf16 v65, v182, s91, v68
  v_cvt_pk_bf16_f32 v180, v60, v61
  v_dot2_f32_bf16 v60, v183, s90, v68
  v_dot2_f32_bf16 v61, v183, s91, v68
  v_cvt_pk_bf16_f32 v181, v62, v63
  v_dot2_f32_bf16 v62, v184, s90, v68
  v_dot2_f32_bf16 v63, v184, s91, v68
  v_cvt_pk_bf16_f32 v182, v64, v65
  v_dot2_f32_bf16 v64, v185, s90, v68
  v_dot2_f32_bf16 v65, v185, s91, v68
  v_cvt_pk_bf16_f32 v183, v60, v61
  v_dot2_f32_bf16 v60, v186, s90, v68
  v_dot2_f32_bf16 v61, v186, s91, v68
  v_cvt_pk_bf16_f32 v184, v62, v63
  v_dot2_f32_bf16 v62, v187, s90, v68
  v_dot2_f32_bf16 v63, v187, s91, v68
  v_cvt_pk_bf16_f32 v185, v64, v65
  v_dot2_f32_bf16 v64, v188, s90, v68
  v_dot2_f32_bf16 v65, v188, s91, v68
  v_cvt_pk_bf16_f32 v186, v60, v61
  v_dot2_f32_bf16 v60, v189, s90, v68
  v_dot2_f32_bf16 v61, v189, s91, v68
  v_cvt_pk_bf16_f32 v187, v62, v63
  v_dot2_f32_bf16 v62, v190, s90, v68
  v_dot2_f32_bf16 v63, v190, s91, v68
  v_cvt_pk_bf16_f32 v188, v64, v65
  global_load_lds_dwordx4 v139, s[46:47] offset:1024
  v_dot2_f32_bf16 v64, v191, s90, v68
  v_dot2_f32_bf16 v65, v191, s91, v68
  v_cvt_pk_bf16_f32 v189, v60, v61
  v_dot2_f32_bf16 v60, v192, s90, v68
  v_dot2_f32_bf16 v61, v192, s91, v68
  v_cvt_pk_bf16_f32 v190, v62, v63
  v_dot2_f32_bf16 v62, v193, s90, v68
  v_dot2_f32_bf16 v63, v193, s91, v68
  v_cvt_pk_bf16_f32 v191, v64, v65
  v_dot2_f32_bf16 v64, v194, s90, v68
  v_dot2_f32_bf16 v65, v194, s91, v68
  v_cvt_pk_bf16_f32 v192, v60, v61
  v_dot2_f32_bf16 v60, v195, s90, v68
  v_dot2_f32_bf16 v61, v195, s91, v68
  v_cvt_pk_bf16_f32 v193, v62, v63
  v_dot2_f32_bf16 v62, v196, s90, v68
  v_dot2_f32_bf16 v63, v196, s91, v68
  v_cvt_pk_bf16_f32 v194, v64, v65
  v_dot2_f32_bf16 v64, v197, s90, v68
  v_dot2_f32_bf16 v65, v197, s91, v68
  v_cvt_pk_bf16_f32 v195, v60, v61
  v_dot2_f32_bf16 v60, v198, s90, v68
  v_dot2_f32_bf16 v61, v198, s91, v68
  v_cvt_pk_bf16_f32 v196, v62, v63
  global_load_lds_dwordx4 v140, s[46:47] offset:2048
  s_add_u32 m0, s30, 135168
  v_dot2_f32_bf16 v62, v199, s90, v68
  v_dot2_f32_bf16 v63, v199, s91, v68
  v_cvt_pk_bf16_f32 v197, v64, v65
  v_dot2_f32_bf16 v64, v200, s90, v68
  v_dot2_f32_bf16 v65, v200, s91, v68
  v_cvt_pk_bf16_f32 v198, v60, v61
  v_dot2_f32_bf16 v60, v201, s90, v68
  v_dot2_f32_bf16 v61, v201, s91, v68
  v_cvt_pk_bf16_f32 v199, v62, v63
  v_dot2_f32_bf16 v62, v202, s90, v68
  v_dot2_f32_bf16 v63, v202, s91, v68
  v_cvt_pk_bf16_f32 v200, v64, v65
  v_dot2_f32_bf16 v64, v203, s90, v68
  v_dot2_f32_bf16 v65, v203, s91, v68
  v_cvt_pk_bf16_f32 v201, v60, v61
  v_dot2_f32_bf16 v60, v204, s90, v68
  v_dot2_f32_bf16 v61, v204, s91, v68
  v_cvt_pk_bf16_f32 v202, v62, v63
  v_dot2_f32_bf16 v62, v205, s90, v68
  v_dot2_f32_bf16 v63, v205, s91, v68
  v_cvt_pk_bf16_f32 v203, v64, v65
  v_dot2_f32_bf16 v64, v206, s90, v68
  v_dot2_f32_bf16 v65, v206, s91, v68
  v_cvt_pk_bf16_f32 v204, v60, v61
  global_load_lds_dwordx4 v141, s[46:47] offset:0
  v_dot2_f32_bf16 v60, v207, s90, v68
  v_dot2_f32_bf16 v61, v207, s91, v68
  v_cvt_pk_bf16_f32 v205, v62, v63
  v_dot2_f32_bf16 v62, v208, s90, v68
  v_dot2_f32_bf16 v63, v208, s91, v68
  v_cvt_pk_bf16_f32 v206, v64, v65
  v_dot2_f32_bf16 v64, v209, s90, v68
  v_dot2_f32_bf16 v65, v209, s91, v68
  v_cvt_pk_bf16_f32 v207, v60, v61
  v_dot2_f32_bf16 v60, v210, s90, v68
  v_dot2_f32_bf16 v61, v210, s91, v68
  v_cvt_pk_bf16_f32 v208, v62, v63
  v_dot2_f32_bf16 v62, v211, s90, v68
  v_dot2_f32_bf16 v63, v211, s91, v68
  v_cvt_pk_bf16_f32 v209, v64, v65
  v_dot2_f32_bf16 v64, v212, s90, v68
  v_dot2_f32_bf16 v65, v212, s91, v68
  v_cvt_pk_bf16_f32 v210, v60, v61
  v_dot2_f32_bf16 v60, v213, s90, v68
  v_dot2_f32_bf16 v61, v213, s91, v68
  v_cvt_pk_bf16_f32 v211, v62, v63
  v_dot2_f32_bf16 v62, v214, s90, v68
  v_dot2_f32_bf16 v63, v214, s91, v68
  v_cvt_pk_bf16_f32 v212, v64, v65
  global_load_lds_dwordx4 v142, s[46:47] offset:1024
  v_dot2_f32_bf16 v64, v215, s90, v68
  v_dot2_f32_bf16 v65, v215, s91, v68
  v_cvt_pk_bf16_f32 v213, v60, v61
  v_dot2_f32_bf16 v60, v216, s90, v68
  v_dot2_f32_bf16 v61, v216, s91, v68
  v_cvt_pk_bf16_f32 v214, v62, v63
  v_dot2_f32_bf16 v62, v217, s90, v68
  v_dot2_f32_bf16 v63, v217, s91, v68
  v_cvt_pk_bf16_f32 v215, v64, v65
  v_dot2_f32_bf16 v64, v218, s90, v68
  v_dot2_f32_bf16 v65, v218, s91, v68
  v_cvt_pk_bf16_f32 v216, v60, v61
  v_dot2_f32_bf16 v60, v219, s90, v68
  v_dot2_f32_bf16 v61, v219, s91, v68
  v_cvt_pk_bf16_f32 v217, v62, v63
  v_dot2_f32_bf16 v62, v220, s90, v68
  v_dot2_f32_bf16 v63, v220, s91, v68
  v_cvt_pk_bf16_f32 v218, v64, v65
  v_dot2_f32_bf16 v64, v221, s90, v68
  v_dot2_f32_bf16 v65, v221, s91, v68
  v_cvt_pk_bf16_f32 v219, v60, v61
  v_dot2_f32_bf16 v60, v222, s90, v68
  v_dot2_f32_bf16 v61, v222, s91, v68
  v_cvt_pk_bf16_f32 v220, v62, v63
  global_load_lds_dwordx4 v143, s[46:47] offset:2048
  s_add_u32 m0, s89, 0
  s_add_u32 s46, s46, 163840
  s_addc_u32 s47, s47, 0
  v_dot2_f32_bf16 v62, v223, s90, v68
  v_dot2_f32_bf16 v63, v223, s91, v68
  v_cvt_pk_bf16_f32 v221, v64, v65
  v_dot2_f32_bf16 v64, v224, s90, v68
  v_dot2_f32_bf16 v65, v224, s91, v68
  v_cvt_pk_bf16_f32 v222, v60, v61
  v_dot2_f32_bf16 v60, v225, s90, v68
  v_dot2_f32_bf16 v61, v225, s91, v68
  v_cvt_pk_bf16_f32 v223, v62, v63
  v_dot2_f32_bf16 v62, v226, s90, v68
  v_dot2_f32_bf16 v63, v226, s91, v68
  v_cvt_pk_bf16_f32 v224, v64, v65
  global_load_lds_dwordx4 v138, s[46:47] offset:0
  v_dot2_f32_bf16 v64, v227, s90, v68
  v_dot2_f32_bf16 v65, v227, s91, v68
  v_cvt_pk_bf16_f32 v225, v60, v61
  v_dot2_f32_bf16 v60, v228, s90, v68
  v_dot2_f32_bf16 v61, v228, s91, v68
  v_cvt_pk_bf16_f32 v226, v62, v63
  v_dot2_f32_bf16 v62, v229, s90, v68
  v_dot2_f32_bf16 v63, v229, s91, v68
  v_cvt_pk_bf16_f32 v227, v64, v65
  v_dot2_f32_bf16 v64, v230, s90, v68
  v_dot2_f32_bf16 v65, v230, s91, v68
  v_cvt_pk_bf16_f32 v228, v60, v61
  s_waitcnt lgkmcnt(0)
  s_and_b64 s[80:81], s[80:81], s[82:83]
  s_and_b64 s[84:85], s[84:85], s[86:87]
  s_and_b64 s[80:81], s[80:81], s[84:85]
  s_and_b32 s80, s80, s81
  s_cbranch_scc0 L_spin1
L_spin1_done:
  v_dot2_f32_bf16 v60, v231, s90, v68
  v_dot2_f32_bf16 v61, v231, s91, v68
  v_cvt_pk_bf16_f32 v229, v62, v63
  v_dot2_f32_bf16 v62, v232, s90, v68
  v_dot2_f32_bf16 v63, v232, s91, v68
  v_cvt_pk_bf16_f32 v230, v64, v65
  v_dot2_f32_bf16 v64, v233, s90, v68
  v_dot2_f32_bf16 v65, v233, s91, v68
  v_cvt_pk_bf16_f32 v231, v60, v61
  v_dot2_f32_bf16 v60, v234, s90, v68
  v_dot2_f32_bf16 v61, v234, s91, v68
  v_cvt_pk_bf16_f32 v232, v62, v63
  global_load_lds_dwordx4 v139, s[46:47] offset:1024
  v_dot2_f32_bf16 v62, v235, s90, v68
  v_dot2_f32_bf16 v63, v235, s91, v68
  v_cvt_pk_bf16_f32 v233, v64, v65
  v_dot2_f32_bf16 v64, v236, s90, v68
  v_dot2_f32_bf16 v65, v236, s91, v68
  v_cvt_pk_bf16_f32 v234, v60, v61
  v_dot2_f32_bf16 v60, v237, s90, v68
  v_dot2_f32_bf16 v61, v237, s91, v68
  v_cvt_pk_bf16_f32 v235, v62, v63
  v_dot2_f32_bf16 v62, v238, s90, v68
  v_dot2_f32_bf16 v63, v238, s91, v68
  v_cvt_pk_bf16_f32 v236, v64, v65
  v_dot2_f32_bf16 v64, v239, s90, v68
  v_dot2_f32_bf16 v65, v239, s91, v68
  v_cvt_pk_bf16_f32 v237, v60, v61
  v_dot2_f32_bf16 v60, v240, s90, v68
  v_dot2_f32_bf16 v61, v240, s91, v68
  v_cvt_pk_bf16_f32 v238, v62, v63
  v_dot2_f32_bf16 v62, v241, s90, v68
  v_dot2_f32_bf16 v63, v241, s91, v68
  v_cvt_pk_bf16_f32 v239, v64, v65
  v_dot2_f32_bf16 v64, v242, s90, v68
  v_dot2_f32_bf16 v65, v242, s91, v68
  v_cvt_pk_bf16_f32 v240, v60, v61
  global_load_lds_dwordx4 v140, s[46:47] offset:2048
  s_add_u32 m0, s89, 3072
  v_dot2_f32_bf16 v60, v243, s90, v68
  v_dot2_f32_bf16 v61, v243, s91, v68
  v_cvt_pk_bf16_f32 v241, v62, v63
  v_dot2_f32_bf16 v62, v244, s90, v68
  v_dot2_f32_bf16 v63, v244, s91, v68
  v_cvt_pk_bf16_f32 v242, v64, v65
  v_dot2_f32_bf16 v64, v245, s90, v68
  v_dot2_f32_bf16 v65, v245, s91, v68
  v_cvt_pk_bf16_f32 v243, v60, v61
  v_dot2_f32_bf16 v60, v246, s90, v68
  v_dot2_f32_bf16 v61, v246, s91, v68
  v_cvt_pk_bf16_f32 v244, v62, v63
  v_dot2_f32_bf16 v62, v247, s90, v68
  v_dot2_f32_bf16 v63, v247, s91, v68
  v_cvt_pk_bf16_f32 v245, v64, v65
  v_dot2_f32_bf16 v64, v248, s90, v68
  v_dot2_f32_bf16 v65, v248, s91, v68
  v_cvt_pk_bf16_f32 v246, v60, v61
  v_dot2_f32_bf16 v60, v249, s90, v68
  v_dot2_f32_bf16 v61, v249, s91, v68
  v_cvt_pk_bf16_f32 v247, v62, v63
  v_dot2_f32_bf16 v62, v250, s90, v68
  v_dot2_f32_bf16 v63, v250, s91, v68
  v_cvt_pk_bf16_f32 v248, v64, v65
  global_load_lds_dwordx4 v141, s[46:47] offset:0
  v_dot2_f32_bf16 v64, v251, s90, v68
  v_dot2_f32_bf16 v65, v251, s91, v68
  v_cvt_pk_bf16_f32 v249, v60, v61
  v_dot2_f32_bf16 v60, v252, s90, v68
  v_dot2_f32_bf16 v61, v252, s91, v68
  v_cvt_pk_bf16_f32 v250, v62, v63
  v_dot2_f32_bf16 v62, v253, s90, v68
  v_dot2_f32_bf16 v63, v253, s91, v68
  v_cvt_pk_bf16_f32 v251, v64, v65
  v_dot2_f32_bf16 v64, v254, s90, v68
  v_dot2_f32_bf16 v65, v254, s91, v68
  v_cvt_pk_bf16_f32 v252, v60, v61
  v_dot2_f32_bf16 v60, v255, s90, v68
  v_dot2_f32_bf16 v61, v255, s91, v68
  v_cvt_pk_bf16_f32 v253, v62, v63
  v_dot2_f32_bf16 v62, v144, s90, v68
  v_dot2_f32_bf16 v63, v144, s91, v68
  v_cvt_pk_bf16_f32 v254, v64, v65
  v_dot2_f32_bf16 v64, v145, s90, v68
  v_dot2_f32_bf16 v65, v145, s91, v68
  v_cvt_pk_bf16_f32 v255, v60, v61
  v_dot2_f32_bf16 v60, v146, s90, v68
  v_dot2_f32_bf16 v61, v146, s91, v68
  v_cvt_pk_bf16_f32 v144, v62, v63
  global_load_lds_dwordx4 v142, s[46:47] offset:1024
  v_dot2_f32_bf16 v62, v147, s90, v68
  v_dot2_f32_bf16 v63, v147, s91, v68
  v_cvt_pk_bf16_f32 v145, v64, v65
  v_cvt_pk_bf16_f32 v146, v60, v61
  s_nop 0
  v_cvt_pk_bf16_f32 v147, v62, v63
  v_mfma_f32_16x16x32_bf16 v[52:55], a[176:179], v[180:183], 0
  s_waitcnt vmcnt(11)
  s_barrier
  ds_read_b64_tr_b16 a[96:97], v85 offset:0
  ds_read_b64_tr_b16 a[98:99], v85 offset:3072
  v_mfma_f32_16x16x32_bf16 v[52:55], a[180:183], v[184:187], v[52:55]
  s_nop 0
  ds_read_b64_tr_b16 a[100:101], v86 offset:0
  ds_read_b64_tr_b16 a[102:103], v86 offset:3072
  v_mfma_f32_16x16x32_bf16 v[52:55], a[184:187], v[188:191], v[52:55]
  s_nop 0
  ds_read_b64_tr_b16 a[104:105], v85 offset:1024
  ds_read_b64_tr_b16 a[106:107], v85 offset:4096
  v_mfma_f32_16x16x32_bf16 v[52:55], a[188:191], v[192:195], v[52:55]
  global_load_lds_dwordx4 v143, s[46:47] offset:2048
  s_add_u32 m0, s89, 6144
  s_add_u32 s46, s46, 163840
  s_addc_u32 s47, s47, 0
  v_mfma_f32_16x16x32_bf16 v[52:55], a[192:195], v[196:199], v[52:55]
  s_nop 0
  ds_read_b64_tr_b16 a[108:109], v86 offset:1024
  ds_read_b64_tr_b16 a[110:111], v86 offset:4096
  v_mfma_f32_16x16x32_bf16 v[52:55], a[196:199], v[200:203], v[52:55]
  s_nop 0
  ds_read_b64_tr_b16 a[112:113], v85 offset:2048
  ds_read_b64_tr_b16 a[114:115], v85 offset:5120
  v_mfma_f32_16x16x32_bf16 v[52:55], a[200:203], v[204:207], v[52:55]
  s_nop 0
  ds_read_b64_tr_b16 a[116:117], v85 offset:6144
  ds_read_b64_tr_b16 a[118:119], v85 offset:9216
  v_mfma_f32_16x16x32_bf16 v[52:55], a[204:207], v[208:211], v[52:55]
  s_nop 0
  ds_read_b64_tr_b16 a[120:121], v86 offset:6144
  ds_read_b64_tr_b16 a[122:123], v86 offset:9216
  v_mfma_f32_16x16x32_bf16 v[52:55], a[208:211], v[212:215], v[52:55]
  s_nop 0
  ds_read_b64_tr_b16 a[124:125], v85 offset:7168
  ds_read_b64_tr_b16 a[126:127], v85 offset:10240
  v_mfma_f32_16x16x32_bf16 v[52:55], a[212:215], v[216:219], v[52:55]
  s_nop 0
  ds_read_b64_tr_b16 a[128:129], v86 offset:7168
  ds_read_b64_tr_b16 a[130:131], v86 offset:10240
  v_mfma_f32_16x16x32_bf16 v[52:55], a[216:219], v[220:223], v[52:55]
  global_load_lds_dwordx4 v138, s[46:47] offset:0
  v_mfma_f32_16x16x32_bf16 v[52:55], a[220:223], v[224:227], v[52:55]
  s_nop 0
  ds_read_b64_tr_b16 a[132:133], v85 offset:8192
  ds_read_b64_tr_b16 a[134:135], v85 offset:11264
  v_mfma_f32_16x16x32_bf16 v[52:55], a[224:227], v[228:231], v[52:55]
  s_nop 0
  ds_read_b64_tr_b16 a[136:137], v85 offset:12288
  ds_read_b64_tr_b16 a[138:139], v85 offset:15360
  v_mfma_f32_16x16x32_bf16 v[52:55], a[228:231], v[232:235], v[52:55]
  s_nop 0
  ds_read_b64_tr_b16 a[140:141], v86 offset:12288
  ds_read_b64_tr_b16 a[142:143], v86 offset:15360
  v_mfma_f32_16x16x32_bf16 v[52:55], a[232:235], v[236:239], v[52:55]
  s_nop 0
  ds_read_b64_tr_b16 a[144:145], v85 offset:13312
  ds_read_b64_tr_b16 a[146:147], v85 offset:16384
  v_mfma_f32_16x16x32_bf16 v[52:55], a[236:239], v[240:243], v[52:55]
  s_nop 0
  ds_read_b64_tr_b16 a[148:149], v86 offset:13312
  ds_read_b64_tr_b16 a[150:151], v86 offset:16384
  v_mfma_f32_16x16x32_bf16 v[52:55], a[240:243], v[244:247], v[52:55]
  s_nop 0
  ds_read_b64_tr_b16 a[152:153], v85 offset:14336
  ds_read_b64_tr_b16 a[154:155], v85 offset:17408
  v_mfma_f32_16x16x32_bf16 v[52:55], a[244:247], v[248:251], v[52:55]
  global_load_lds_dwordx4 v139, s[46:47] offset:1024
  v_mfma_f32_16x16x32_bf16 v[52:55], a[248:251], v[252:255], v[52:55]
  s_nop 0
  ds_read_b64_tr_b16 a[156:157], v85 offset:18432
  ds_read_b64_tr_b16 a[158:159], v85 offset:21504
  v_mfma_f32_16x16x32_bf16 v[52:55], a[252:255], v[144:147], v[52:55]
  s_nop 0
  ds_read_b64_tr_b16 a[160:161], v86 offset:18432
  ds_read_b64_tr_b16 a[162:163], v86 offset:21504
  s_waitcnt lgkmcnt(15)
  v_mfma_f32_16x16x32_bf16 v[32:35], a[96:99], v[180:183], 0
  v_mul_f32 v66, s41, v70
  v_mfma_f32_16x16x32_bf16 v[36:39], a[100:103], v[180:183], 0
  global_load_lds_dwordx4 v140, s[46:47] offset:2048
  s_add_u32 m0, s89, 9216
  v_mfma_f32_16x16x32_bf16 v[40:43], a[104:107], v[180:183], 0
  v_mul_f32 v52, v52, v66
  v_mul_f32 v53, v53, v66
  v_mfma_f32_16x16x32_bf16 v[44:47], a[108:111], v[180:183], 0
  v_mul_f32 v54, v54, v66
  v_mul_f32 v55, v55, v66
  v_mfma_f32_16x16x32_bf16 v[48:51], a[112:115], v[180:183], 0
  v_cvt_pk_bf16_f32 v60, v52, v53
  v_cvt_pk_bf16_f32 v61, v54, v55
  v_mfma_f32_16x16x32_bf16 v[32:35], a[116:119], v[184:187], v[32:35]
  v_cndmask_b32 v60, v60, v93, s[42:43]
  v_cndmask_b32 v61, v61, v93, s[42:43]
  v_mfma_f32_16x16x32_bf16 v[36:39], a[120:123], v[184:187], v[36:39]
  ds_write_b64 v82, v[60:61]
  v_mfma_f32_16x16x32_bf16 v[40:43], a[124:127], v[184:187], v[40:43]
  ds_read_b64_tr_b16 v[56:57], v91
  ds_read_b64_tr_b16 v[58:59], v91 offset:160
  v_mfma_f32_16x16x32_bf16 v[44:47], a[128:131], v[184:187], v[44:47]
  s_waitcnt lgkmcnt(15)
  v_permlane16_swap_b32 v60, v62
  v_permlane16_swap_b32 v61, v63
  v_mfma_f32_16x16x32_bf16 v[48:51], a[132:135], v[184:187], v[48:51]
  v_min_u32 v60, -2, v60
  buffer_store_dwordx4 v[60:63], v79, s[60:63], 0 offen sc1
  v_mfma_f32_16x16x32_bf16 v[32:35], a[136:139], v[188:191], v[32:35]
  s_waitcnt lgkmcnt(13)
  buffer_store_dwordx2 v[60:61], v80, s[60:63], 0 offen offset:2048 sc1
  ds_read_b64_tr_b16 a[164:165], v85 offset:19456
  ds_read_b64_tr_b16 a[166:167], v85 offset:22528
  v_mfma_f32_16x16x32_bf16 v[36:39], a[140:143], v[188:191], v[36:39]
  s_waitcnt lgkmcnt(13)
  ds_read_b64_tr_b16 a[168:169], v86 offset:19456
  ds_read_b64_tr_b16 a[170:171], v86 offset:22528
  v_mfma_f32_16x16x32_bf16 v[40:43], a[144:147], v[188:191], v[40:43]
  s_waitcnt lgkmcnt(13)
  s_waitcnt lgkmcnt(4)
  v_min_u32 v56, -2, v56
  buffer_store_dwordx4 v[56:59], v81, s[60:63], 0 offen offset:3072 sc1
  ds_read_b64_tr_b16 a[172:173], v85 offset:20480
  ds_read_b64_tr_b16 a[174:175], v85 offset:23552
  v_mfma_f32_16x16x32_bf16 v[44:47], a[148:151], v[188:191], v[44:47]
  global_load_lds_dwordx4 v141, s[46:47] offset:0
  s_waitcnt vmcnt(13)
  s_barrier
  ds_read_b64_tr_b16 a[96:97], v85 offset:24576
  ds_read_b64_tr_b16 a[98:99], v85 offset:27648
  v_mfma_f32_16x16x32_bf16 v[48:51], a[152:155], v[188:191], v[48:51]
  s_nop 0
  ds_read_b64_tr_b16 a[100:101], v86 offset:24576
  ds_read_b64_tr_b16 a[102:103], v86 offset:27648
  v_mfma_f32_16x16x32_bf16 v[32:35], a[156:159], v[192:195], v[32:35]
  s_nop 0
  ds_read_b64_tr_b16 a[104:105], v85 offset:25600
  ds_read_b64_tr_b16 a[106:107], v85 offset:28672
  v_mfma_f32_16x16x32_bf16 v[36:39], a[160:163], v[192:195], v[36:39]
  s_waitcnt lgkmcnt(10)
  ds_read_b64_tr_b16 a[108:109], v86 offset:25600
  ds_read_b64_tr_b16 a[110:111], v86 offset:28672
  v_mfma_f32_16x16x32_bf16 v[40:43], a[164:167], v[192:195], v[40:43]
  s_waitcnt lgkmcnt(10)
  global_load_lds_dwordx4 v142, s[46:47] offset:1024
  ds_read_b64_tr_b16 a[112:113], v85 offset:26624
  ds_read_b64_tr_b16 a[114:115], v85 offset:29696
  v_mfma_f32_16x16x32_bf16 v[44:47], a[168:171], v[192:195], v[44:47]
  s_waitcnt lgkmcnt(10)
  ds_read_b64_tr_b16 a[116:117], v85 offset:30720
  ds_read_b64_tr_b16 a[118:119], v85 offset:33792
  v_mfma_f32_16x16x32_bf16 v[48:51], a[172:175], v[192:195], v[48:51]
  s_waitcnt lgkmcnt(10)
  ds_read_b64_tr_b16 a[120:121], v86 offset:30720
  ds_read_b64_tr_b16 a[122:123], v86 offset:33792
  v_mfma_f32_16x16x32_bf16 v[32:35], a[96:99], v[196:199], v[32:35]
  s_waitcnt lgkmcnt(10)
  ds_read_b64_tr_b16 a[124:125], v85 offset:31744
  ds_read_b64_tr_b16 a[126:127], v85 offset:34816
  v_mfma_f32_16x16x32_bf16 v[36:39], a[100:103], v[196:199], v[36:39]
  s_waitcnt lgkmcnt(10)
  global_load_lds_dwordx4 v143, s[46:47] offset:2048
  s_add_u32 m0, s89, 12288
  s_add_u32 s46, s46, 163840
  s_addc_u32 s47, s47, 0
  ds_read_b64_tr_b16 a[128:129], v86 offset:31744
  ds_read_b64_tr_b16 a[130:131], v86 offset:34816
  v_mfma_f32_16x16x32_bf16 v[40:43], a[104:107], v[196:199], v[40:43]
  s_waitcnt lgkmcnt(10)
  ds_read_b64_tr_b16 a[132:133], v85 offset:32768
  ds_read_b64_tr_b16 a[134:135], v85 offset:35840
  v_mfma_f32_16x16x32_bf16 v[44:47], a[108:111], v[196:199], v[44:47]
  s_waitcnt lgkmcnt(10)
  ds_read_b64_tr_b16 a[136:137], v85 offset:36864
  ds_read_b64_tr_b16 a[138:139], v85 offset:39936
  v_mfma_f32_16x16x32_bf16 v[48:51], a[112:115], v[196:199], v[48:51]
  s_waitcnt lgkmcnt(10)
  ds_read_b64_tr_b16 a[140:141], v86 offset:36864
  ds_read_b64_tr_b16 a[142:143], v86 offset:39936
  v_mfma_f32_16x16x32_bf16 v[32:35], a[116:119], v[200:203], v[32:35]
  s_waitcnt lgkmcnt(10)
  global_load_lds_dwordx4 v138, s[46:47] offset:0
  ds_read_b64_tr_b16 a[144:145], v85 offset:37888
  ds_read_b64_tr_b16 a[146:147], v85 offset:40960
  v_mfma_f32_16x16x32_bf16 v[36:39], a[120:123], v[200:203], v[36:39]
  s_waitcnt lgkmcnt(10)
  ds_read_b64_tr_b16 a[148:149], v86 offset:37888
  ds_read_b64_tr_b16 a[150:151], v86 offset:40960
  v_mfma_f32_16x16x32_bf16 v[40:43], a[124:127], v[200:203], v[40:43]
  s_waitcnt lgkmcnt(10)
  ds_read_b64_tr_b16 a[152:153], v85 offset:38912
  ds_read_b64_tr_b16 a[154:155], v85 offset:41984
  v_mfma_f32_16x16x32_bf16 v[44:47], a[128:131], v[200:203], v[44:47]
  s_waitcnt lgkmcnt(10)
  ds_read_b64_tr_b16 a[156:157], v85 offset:43008
  ds_read_b64_tr_b16 a[158:159], v85 offset:46080
  v_mfma_f32_16x16x32_bf16 v[48:51], a[132:135], v[200:203], v[48:51]
  s_waitcnt lgkmcnt(10)
  global_load_lds_dwordx4 v139, s[46:47] offset:1024
  ds_read_b64_tr_b16 a[160:161], v86 offset:43008
  ds_read_b64_tr_b16 a[162:163], v86 offset:46080
  v_mfma_f32_16x16x32_bf16 v[32:35], a[136:139], v[204:207], v[32:35]
  s_waitcnt lgkmcnt(10)
  ds_read_b64_tr_b16 a[164:165], v85 offset:44032
  ds_read_b64_tr_b16 a[166:167], v85 offset:47104
  v_mfma_f32_16x16x32_bf16 v[36:39], a[140:143], v[204:207], v[36:39]
  s_waitcnt lgkmcnt(10)
  ds_read_b64_tr_b16 a[168:169], v86 offset:44032
  ds_read_b64_tr_b16 a[170:171], v86 offset:47104
  v_mfma_f32_16x16x32_bf16 v[40:43], a[144:147], v[204:207], v[40:43]
  s_waitcnt lgkmcnt(10)
  ds_read_b64_tr_b16 a[172:173], v85 offset:45056
  ds_read_b64_tr_b16 a[174:175], v85 offset:48128
  v_mfma_f32_16x16x32_bf16 v[44:47], a[148:151], v[204:207], v[44:47]
  s_waitcnt lgkmcnt(10)
  global_load_lds_dwordx4 v140, s[46:47] offset:2048
  s_add_u32 m0, s89, 15360
  s_waitcnt vmcnt(12)
  s_barrier
  ds_read_b64_tr_b16 a[96:97], v87 offset:0
  ds_read_b64_tr_b16 a[98:99], v87 offset:3072
  v_mfma_f32_16x16x32_bf16 v[48:51], a[152:155], v[204:207], v[48:51]
  s_waitcnt lgkmcnt(10)
  ds_read_b64_tr_b16 a[100:101], v88 offset:0
  ds_read_b64_tr_b16 a[102:103], v88 offset:3072
  v_mfma_f32_16x16x32_bf16 v[32:35], a[156:159], v[208:211], v[32:35]
  s_waitcnt lgkmcnt(10)
  ds_read_b64_tr_b16 a[104:105], v87 offset:1024
  ds_read_b64_tr_b16 a[106:107], v87 offset:4096
  v_mfma_f32_16x16x32_bf16 v[36:39], a[160:163], v[208:211], v[36:39]
  s_waitcnt lgkmcnt(10)
  ds_read_b64_tr_b16 a[108:109], v88 offset:1024
  ds_read_b64_tr_b16 a[110:111], v88 offset:4096
  v_mfma_f32_16x16x32_bf16 v[40:43], a[164:167], v[208:211], v[40:43]
  s_waitcnt lgkmcnt(10)
  global_load_lds_dwordx4 v141, s[46:47] offset:0
  ds_read_b64_tr_b16 a[112:113], v87 offset:2048
  ds_read_b64_tr_b16 a[114:115], v87 offset:5120
  v_mfma_f32_16x16x32_bf16 v[44:47], a[168:171], v[208:211], v[44:47]
  s_waitcnt lgkmcnt(10)
  ds_read_b64_tr_b16 a[116:117], v87 offset:20480
  ds_read_b64_tr_b16 a[118:119], v87 offset:23552
  v_mfma_f32_16x16x32_bf16 v[48:51], a[172:175], v[208:211], v[48:51]
  s_waitcnt lgkmcnt(10)
  ds_read_b64_tr_b16 a[120:121], v88 offset:20480
  ds_read_b64_tr_b16 a[122:123], v88 offset:23552
  v_mfma_f32_16x16x32_bf16 v[32:35], a[96:99], v[212:215], v[32:35]
  s_waitcnt lgkmcnt(10)
  ds_read_b64_tr_b16 a[124:125], v87 offset:21504
  ds_read_b64_tr_b16 a[126:127], v87 offset:24576
  v_mfma_f32_16x16x32_bf16 v[36:39], a[100:103], v[212:215], v[36:39]
  s_waitcnt lgkmcnt(10)
  global_load_lds_dwordx4 v142, s[46:47] offset:1024
  ds_read_b64_tr_b16 a[128:129], v88 offset:21504
  ds_read_b64_tr_b16 a[130:131], v88 offset:24576
  v_mfma_f32_16x16x32_bf16 v[40:43], a[104:107], v[212:215], v[40:43]
  s_waitcnt lgkmcnt(10)
  ds_read_b64_tr_b16 a[132:133], v87 offset:22528
  ds_read_b64_tr_b16 a[134:135], v87 offset:25600
  v_mfma_f32_16x16x32_bf16 v[44:47], a[108:111], v[212:215], v[44:47]
  s_waitcnt lgkmcnt(10)
  ds_read_b64_tr_b16 a[136:137], v87 offset:40960
  ds_read_b64_tr_b16 a[138:139], v87 offset:44032
  v_mfma_f32_16x16x32_bf16 v[48:51], a[112:115], v[212:215], v[48:51]
  s_waitcnt lgkmcnt(10)
  ds_read_b64_tr_b16 a[140:141], v88 offset:40960
  ds_read_b64_tr_b16 a[142:143], v88 offset:44032
  v_mfma_f32_16x16x32_bf16 v[32:35], a[116:119], v[216:219], v[32:35]
  s_waitcnt lgkmcnt(10)
  global_load_lds_dwordx4 v143, s[46:47] offset:2048
  ds_read_b64_tr_b16 a[144:145], v87 offset:41984
  ds_read_b64_tr_b16 a[146:147], v87 offset:45056
  v_mfma_f32_16x16x32_bf16 v[36:39], a[120:123], v[216:219], v[36:39]
  s_waitcnt lgkmcnt(10)
  ds_read_b64_tr_b16 a[148:149], v88 offset:41984
  ds_read_b64_tr_b16 a[150:151], v88 offset:45056
  v_mfma_f32_16x16x32_bf16 v[40:43], a[124:127], v[216:219], v[40:43]
  s_waitcnt lgkmcnt(10)
  ds_read_b64_tr_b16 a[152:153], v87 offset:43008
  ds_read_b64_tr_b16 a[154:155], v87 offset:46080
  v_mfma_f32_16x16x32_bf16 v[44:47], a[128:131], v[216:219], v[44:47]
  s_waitcnt lgkmcnt(10)
  ds_read_b64_tr_b16 a[156:157], v89 offset:0
  ds_read_b64_tr_b16 a[158:159], v89 offset:3072
  v_mfma_f32_16x16x32_bf16 v[48:51], a[132:135], v[216:219], v[48:51]
  s_waitcnt lgkmcnt(10)
  ds_read_b64_tr_b16 a[160:161], v90 offset:0
  ds_read_b64_tr_b16 a[162:163], v90 offset:3072
  v_mfma_f32_16x16x32_bf16 v[32:35], a[136:139], v[220:223], v[32:35]
  s_waitcnt lgkmcnt(10)
  ds_read_b64_tr_b16 a[164:165], v89 offset:1024
  ds_read_b64_tr_b16 a[166:167], v89 offset:4096
  v_mfma_f32_16x16x32_bf16 v[36:39], a[140:143], v[220:223], v[36:39]
  s_waitcnt lgkmcnt(10)
  ds_read_b64_tr_b16 a[168:169], v90 offset:1024
  ds_read_b64_tr_b16 a[170:171], v90 offset:4096
  v_mfma_f32_16x16x32_bf16 v[40:43], a[144:147], v[220:223], v[40:43]
  s_waitcnt lgkmcnt(10)
  ds_read_b64_tr_b16 a[172:173], v89 offset:2048
  ds_read_b64_tr_b16 a[174:175], v89 offset:5120
  v_mfma_f32_16x16x32_bf16 v[44:47], a[148:151], v[220:223], v[44:47]
  s_waitcnt lgkmcnt(10)
  s_waitcnt vmcnt(6)
  s_barrier
  ds_read_b64_tr_b16 a[96:97], v87 offset:6144
  ds_read_b64_tr_b16 a[98:99], v87 offset:9216
  v_mfma_f32_16x16x32_bf16 v[48:51], a[152:155], v[220:223], v[48:51]
  s_waitcnt lgkmcnt(10)
  ds_read_b64_tr_b16 a[100:101], v88 offset:6144
  ds_read_b64_tr_b16 a[102:103], v88 offset:9216
  v_mfma_f32_16x16x32_bf16 v[32:35], a[156:159], v[224:227], v[32:35]
  s_waitcnt lgkmcnt(10)
  ds_read_b64_tr_b16 a[104:105], v87 offset:7168
  ds_read_b64_tr_b16 a[106:107], v87 offset:10240
  v_mfma_f32_16x16x32_bf16 v[36:39], a[160:163], v[224:227], v[36:39]
  s_waitcnt lgkmcnt(10)
  ds_read_b64_tr_b16 a[108:109], v88 offset:7168
  ds_read_b64_tr_b16 a[110:111], v88 offset:10240
  v_mfma_f32_16x16x32_bf16 v[40:43], a[164:167], v[224:227], v[40:43]
  s_waitcnt lgkmcnt(10)
  ds_read_b64_tr_b16 a[112:113], v87 offset:8192
  ds_read_b64_tr_b16 a[114:115], v87 offset:11264
  v_mfma_f32_16x16x32_bf16 v[44:47], a[168:171], v[224:227], v[44:47]
  s_waitcnt lgkmcnt(10)
  ds_read_b64_tr_b16 a[116:117], v87 offset:26624
  ds_read_b64_tr_b16 a[118:119], v87 offset:29696
  v_mfma_f32_16x16x32_bf16 v[48:51], a[172:175], v[224:227], v[48:51]
  s_waitcnt lgkmcnt(10)
  ds_read_b64_tr_b16 a[120:121], v88 offset:26624
  ds_read_b64_tr_b16 a[122:123], v88 offset:29696
  v_mfma_f32_16x16x32_bf16 v[32:35], a[96:99], v[228:231], v[32:35]
  s_waitcnt lgkmcnt(10)
  ds_read_b64_tr_b16 a[124:125], v87 offset:27648
  ds_read_b64_tr_b16 a[126:127], v87 offset:30720
  v_mfma_f32_16x16x32_bf16 v[36:39], a[100:103], v[228:231], v[36:39]
  s_waitcnt lgkmcnt(10)
  ds_read_b64_tr_b16 a[128:129], v88 offset:27648
  ds_read_b64_tr_b16 a[130:131], v88 offset:30720
  v_mfma_f32_16x16x32_bf16 v[40:43], a[104:107], v[228:231], v[40:43]
  s_waitcnt lgkmcnt(10)
  ds_read_b64_tr_b16 a[132:133], v87 offset:28672
  ds_read_b64_tr_b16 a[134:135], v87 offset:31744
  v_mfma_f32_16x16x32_bf16 v[44:47], a[108:111], v[228:231], v[44:47]
  s_waitcnt lgkmcnt(10)
  ds_read_b64_tr_b16 a[136:137], v87 offset:47104
  ds_read_b64_tr_b16 a[138:139], v87 offset:50176
  v_mfma_f32_16x16x32_bf16 v[48:51], a[112:115], v[228:231], v[48:51]
  s_waitcnt lgkmcnt(10)
  ds_read_b64_tr_b16 a[140:141], v88 offset:47104
  ds_read_b64_tr_b16 a[142:143], v88 offset:50176
  v_mfma_f32_16x16x32_bf16 v[32:35], a[116:119], v[232:235], v[32:35]
  s_waitcnt lgkmcnt(10)
  ds_read_b64_tr_b16 a[144:145], v87 offset:48128
  ds_read_b64_tr_b16 a[146:147], v87 offset:51200
  v_mfma_f32_16x16x32_bf16 v[36:39], a[120:123], v[232:235], v[36:39]
  s_waitcnt lgkmcnt(10)
  ds_read_b64_tr_b16 a[148:149], v88 offset:48128
  ds_read_b64_tr_b16 a[150:151], v88 offset:51200
  v_mfma_f32_16x16x32_bf16 v[40:43], a[124:127], v[232:235], v[40:43]
  s_waitcnt lgkmcnt(10)
  ds_read_b64_tr_b16 a[152:153], v87 offset:49152
  ds_read_b64_tr_b16 a[154:155], v87 offset:52224
  v_mfma_f32_16x16x32_bf16 v[44:47], a[128:131], v[232:235], v[44:47]
  s_waitcnt lgkmcnt(10)
  ds_read_b64_tr_b16 a[156:157], v89 offset:6144
  ds_read_b64_tr_b16 a[158:159], v89 offset:9216
  v_mfma_f32_16x16x32_bf16 v[48:51], a[132:135], v[232:235], v[48:51]
  s_waitcnt lgkmcnt(10)
  ds_read_b64_tr_b16 a[160:161], v90 offset:6144
  ds_read_b64_tr_b16 a[162:163], v90 offset:9216
  v_mfma_f32_16x16x32_bf16 v[32:35], a[136:139], v[236:239], v[32:35]
  s_waitcnt lgkmcnt(10)
  ds_read_b64_tr_b16 a[164:165], v89 offset:7168
  ds_read_b64_tr_b16 a[166:167], v89 offset:10240
  v_mfma_f32_16x16x32_bf16 v[36:39], a[140:143], v[236:239], v[36:39]
  s_waitcnt lgkmcnt(10)
  ds_read_b64_tr_b16 a[168:169], v90 offset:7168
  ds_read_b64_tr_b16 a[170:171], v90 offset:10240
  v_mfma_f32_16x16x32_bf16 v[40:43], a[144:147], v[236:239], v[40:43]
  s_waitcnt lgkmcnt(10)
  ds_read_b64_tr_b16 a[172:173], v89 offset:8192
  ds_read_b64_tr_b16 a[174:175], v89 offset:11264
  v_mfma_f32_16x16x32_bf16 v[44:47], a[148:151], v[236:239], v[44:47]
  s_waitcnt lgkmcnt(10)
  s_waitcnt vmcnt(0)
  s_barrier
  ds_read_b64_tr_b16 a[96:97], v87 offset:12288
  ds_read_b64_tr_b16 a[98:99], v87 offset:15360
  v_mfma_f32_16x16x32_bf16 v[48:51], a[152:155], v[236:239], v[48:51]
  s_waitcnt lgkmcnt(10)
  ds_read_b64_tr_b16 a[100:101], v87 offset:32768
  ds_read_b64_tr_b16 a[102:103], v87 offset:35840
  v_mfma_f32_16x16x32_bf16 v[32:35], a[156:159], v[240:243], v[32:35]
  s_waitcnt lgkmcnt(10)
  ds_read_b64_tr_b16 a[104:105], v87 offset:53248
  ds_read_b64_tr_b16 a[106:107], v87 offset:56320
  v_mfma_f32_16x16x32_bf16 v[36:39], a[160:163], v[240:243], v[36:39]
  s_waitcnt lgkmcnt(10)
  s_add_u32 s77, s92, 0
  s_and_b32 s77, s77, 31
  s_mul_i32 s77, s77, 6144
  s_add_u32 s14, s28, s77
  s_addc_u32 s15, s29, 0
  ds_read_b64_tr_b16 a[108:109], v89 offset:12288
  ds_read_b64_tr_b16 a[110:111], v89 offset:15360
  v_mfma_f32_16x16x32_bf16 v[40:43], a[164:167], v[240:243], v[40:43]
  s_waitcnt lgkmcnt(10)
  ds_read_b64_tr_b16 a[112:113], v88 offset:12288
  ds_read_b64_tr_b16 a[114:115], v88 offset:15360
  v_mfma_f32_16x16x32_bf16 v[44:47], a[168:171], v[240:243], v[44:47]
  s_waitcnt lgkmcnt(10)
  global_load_dwordx2 v[104:105], v4, s[14:15] offset:2048 sc1
  ds_read_b64_tr_b16 a[116:117], v88 offset:32768
  ds_read_b64_tr_b16 a[118:119], v88 offset:35840
  v_mfma_f32_16x16x32_bf16 v[48:51], a[172:175], v[240:243], v[48:51]
  s_waitcnt lgkmcnt(10)
  ds_read_b64_tr_b16 a[120:121], v88 offset:53248
  ds_read_b64_tr_b16 a[122:123], v88 offset:56320
  v_mfma_f32_16x16x32_bf16 v[32:35], a[96:99], v[244:247], v[32:35]
  s_waitcnt lgkmcnt(10)
  global_load_dwordx4 v[96:99], v1, s[14:15] offset:0 sc1
  ds_read_b64_tr_b16 a[124:125], v90 offset:12288
  ds_read_b64_tr_b16 a[126:127], v90 offset:15360
  v_mfma_f32_16x16x32_bf16 v[32:35], a[100:103], v[248:251], v[32:35]
  s_waitcnt lgkmcnt(10)
  ds_read_b64_tr_b16 a[128:129], v87 offset:13312
  ds_read_b64_tr_b16 a[130:131], v87 offset:16384
  v_mfma_f32_16x16x32_bf16 v[32:35], a[104:107], v[252:255], v[32:35]
  s_waitcnt lgkmcnt(10)
  global_load_dwordx4 v[100:103], v1, s[14:15] offset:1024 sc1
  ds_read_b64_tr_b16 a[132:133], v87 offset:33792
  ds_read_b64_tr_b16 a[134:135], v87 offset:36864
  v_mfma_f32_16x16x32_bf16 v[32:35], a[108:111], v[144:147], v[32:35]
  s_waitcnt lgkmcnt(10)
  ds_read_b64_tr_b16 a[136:137], v87 offset:54272
  ds_read_b64_tr_b16 a[138:139], v87 offset:57344
  v_mfma_f32_16x16x32_bf16 v[36:39], a[112:115], v[244:247], v[36:39]
  s_waitcnt lgkmcnt(10)
  global_load_dwordx4 v[106:109], v6, s[14:15] offset:0 sc1
  ds_read_b64_tr_b16 a[140:141], v89 offset:13312
  ds_read_b64_tr_b16 a[142:143], v89 offset:16384
  v_mfma_f32_16x16x32_bf16 v[36:39], a[116:119], v[248:251], v[36:39]
  s_waitcnt lgkmcnt(10)
  ds_read_b64_tr_b16 a[144:145], v88 offset:13312
  ds_read_b64_tr_b16 a[146:147], v88 offset:16384
  v_mfma_f32_16x16x32_bf16 v[36:39], a[120:123], v[252:255], v[36:39]
  s_waitcnt lgkmcnt(10)
  global_load_dwordx4 v[110:113], v6, s[14:15] offset:768 sc1
  ds_read_b64_tr_b16 a[148:149], v88 offset:33792
  ds_read_b64_tr_b16 a[150:151], v88 offset:36864
  v_mfma_f32_16x16x32_bf16 v[36:39], a[124:127], v[144:147], v[36:39]
  s_waitcnt lgkmcnt(10)
  ds_read_b64_tr_b16 a[152:153], v88 offset:54272
  ds_read_b64_tr_b16 a[154:155], v88 offset:57344
  v_mfma_f32_16x16x32_bf16 v[40:43], a[128:131], v[244:247], v[40:43]
  s_waitcnt lgkmcnt(10)
  global_load_dwordx4 v[114:117], v6, s[14:15] offset:1536 sc1
  ds_read_b64_tr_b16 a[156:157], v90 offset:13312
  ds_read_b64_tr_b16 a[158:159], v90 offset:16384
  v_mfma_f32_16x16x32_bf16 v[40:43], a[132:135], v[248:251], v[40:43]
  s_waitcnt lgkmcnt(10)
  ds_read_b64_tr_b16 a[160:161], v87 offset:14336
  ds_read_b64_tr_b16 a[162:163], v87 offset:17408
  v_mfma_f32_16x16x32_bf16 v[40:43], a[136:139], v[252:255], v[40:43]
  s_waitcnt lgkmcnt(10)
  global_load_dwordx4 v[118:121], v6, s[14:15] offset:2304 sc1
  ds_read_b64_tr_b16 a[164:165], v87 offset:34816
  ds_read_b64_tr_b16 a[166:167], v87 offset:37888
  v_mfma_f32_16x16x32_bf16 v[40:43], a[140:143], v[144:147], v[40:43]
  s_waitcnt lgkmcnt(10)
  ds_read_b64_tr_b16 a[168:169], v87 offset:55296
  ds_read_b64_tr_b16 a[170:171], v87 offset:58368
  v_mfma_f32_16x16x32_bf16 v[44:47], a[144:147], v[244:247], v[44:47]
  s_waitcnt lgkmcnt(10)
  ds_read_b64_tr_b16 a[172:173], v89 offset:14336
  ds_read_b64_tr_b16 a[174:175], v89 offset:17408
  v_mfma_f32_16x16x32_bf16 v[44:47], a[148:151], v[248:251], v[44:47]
  s_waitcnt lgkmcnt(10)
  v_mul_f32 v32, v32, v70
  v_mul_f32 v33, v33, v70
  v_mul_f32 v34, v34, v70
  v_mfma_f32_16x16x32_bf16 v[44:47], a[152:155], v[252:255], v[44:47]
  s_waitcnt lgkmcnt(8)
  v_mul_f32 v35, v35, v70
  v_cvt_pk_bf16_f32 v32, v32, v33
  v_cvt_pk_bf16_f32 v33, v34, v35
  v_mfma_f32_16x16x32_bf16 v[44:47], a[156:159], v[144:147], v[44:47]
  s_waitcnt lgkmcnt(6)
  ds_write_b64 v124, v[32:33] offset:0
  v_mul_f32 v36, v36, v70
  v_mul_f32 v37, v37, v70
  v_mfma_f32_16x16x32_bf16 v[48:51], a[160:163], v[244:247], v[48:51]
  s_waitcnt lgkmcnt(5)
  v_mul_f32 v38, v38, v70
  v_mul_f32 v39, v39, v70
  v_cvt_pk_bf16_f32 v36, v36, v37
  v_mfma_f32_16x16x32_bf16 v[48:51], a[164:167], v[248:251], v[48:51]
  s_waitcnt lgkmcnt(3)
  v_cvt_pk_bf16_f32 v37, v38, v39
  ds_write_b64 v124, v[36:37] offset:32
  v_mul_f32 v40, v40, v70
  v_mfma_f32_16x16x32_bf16 v[48:51], a[168:171], v[252:255], v[48:51]
  s_waitcnt lgkmcnt(2)
  v_mul_f32 v41, v41, v70
  v_mul_f32 v42, v42, v70
  v_mul_f32 v43, v43, v70
  v_mfma_f32_16x16x32_bf16 v[48:51], a[172:175], v[144:147], v[48:51]
  v_cvt_pk_bf16_f32 v40, v40, v41
  v_cvt_pk_bf16_f32 v41, v42, v43
  ds_write_b64 v125, v[40:41] offset:64
  v_mul_f32 v44, v44, v70
  v_mul_f32 v45, v45, v70
  v_mul_f32 v46, v46, v70
  v_mul_f32 v47, v47, v70
  v_cvt_pk_bf16_f32 v44, v44, v45
  v_cvt_pk_bf16_f32 v45, v46, v47
  ds_write_b64 v124, v[44:45] offset:8208
  v_mul_f32 v48, v48, v70
  v_mul_f32 v49, v49, v70
  v_mul_f32 v50, v50, v70
  v_mul_f32 v51, v51, v70
  v_cvt_pk_bf16_f32 v48, v48, v49
  v_cvt_pk_bf16_f32 v49, v50, v51
  ds_write_b64 v124, v[48:49] offset:8240
  s_waitcnt lgkmcnt(0)
  s_barrier
  ds_read_b64 a[114:115], v134 offset:32
  ds_read2_b64 a[106:109], v130 offset0:0 offset1:1
  ds_read2_b64 a[110:113], v130 offset0:5 offset1:6
  ds_read_b64 a[124:125], v135 offset:32
  ds_read2_b64 a[116:119], v131 offset0:0 offset1:1
  ds_read2_b64 a[120:123], v131 offset0:5 offset1:6
  ds_read_b64 a[134:135], v136 offset:32
  ds_read2_b64 a[126:129], v132 offset0:0 offset1:1
  ds_read2_b64 a[130:133], v132 offset0:5 offset1:6
  ds_read_b64 a[104:105], v133 offset:32
  ds_read2_b64 a[96:99], v129 offset0:0 offset1:1
  ds_read2_b64 a[100:103], v129 offset0:5 offset1:6
  s_waitcnt vmcnt(0)
  v_max3_u32 v60, v96, v100, v104
  v_max3_u32 v60, v60, v106, v110
  v_max3_u32 v60, v60, v114, v118
  v_cmp_eq_u32 vcc, -1, v60
  s_cbranch_vccnz L_rtykv0_2
L_okkv0_1:
  s_waitcnt lgkmcnt(9)
  v_mfma_f32_32x32x4_2b_bf16 v[32:63], v[104:105], a[114:115], 0 cbsz:1 abid:0
  s_add_u32 s77, s92, 4
  s_and_b32 s77, s77, 31
  s_mul_i32 s77, s77, 6144
  s_add_u32 s14, s28, s77
  s_addc_u32 s15, s29, 0
  s_mul_i32 s72, s5, 196608
  s_add_u32 s72, s72, s93
  s_add_u32 s42, s16, s72
  s_addc_u32 s43, s17, 0
  s_sub_u32 s44, s42, 1572864
  s_subb_u32 s45, s43, 0
  v_add_u32 v180, 23552, v20
  v_add_u32 v181, 47104, v20
  v_add_u32 v182, 70656, v20
  s_nop 3
  v_mfma_f32_32x32x16_bf16 v[32:47], v[96:99], a[106:109], v[32:47]
  v_mfma_f32_32x32x16_bf16 v[48:63], v[96:99], a[110:113], v[48:63]
  s_mul_i32 s72, s2, 28672
  s_mul_i32 s73, s64, 7168
  s_add_u32 s72, s72, s73
  s_add_u32 s72, s72, 1051648
  s_add_u32 s40, s28, s72
  s_addc_u32 s41, s29, 0
  v_mov_b64 v[28:29], -1
  v_mov_b64 v[30:31], -1
  s_waitcnt lgkmcnt(0)
  s_nop 1
  v_exp_f32 v32, v32
  v_exp_f32 v33, v33
  global_load_dwordx2 v[130:131], v4, s[14:15] offset:2048 sc1
  v_exp_f32 v34, v34
  v_exp_f32 v35, v35
  v_exp_f32 v36, v36
  v_mfma_f32_32x32x4_2b_bf16 v[64:95], v[104:105], a[114:115], 0 cbsz:1 abid:1
  v_exp_f32 v37, v37
  v_exp_f32 v38, v38
  v_exp_f32 v39, v39
  v_exp_f32 v40, v40
  v_exp_f32 v41, v41
  v_exp_f32 v42, v42
  v_exp_f32 v43, v43
  v_exp_f32 v44, v44
  v_smfmac_f32_32x32x32_bf16 a[0:15], v[106:109], v[32:39], v5
  global_load_dwordx4 v[122:125], v1, s[14:15] offset:0 sc1
  v_exp_f32 v45, v45
  v_exp_f32 v46, v46
  v_exp_f32 v47, v47
  v_exp_f32 v48, v48
  v_exp_f32 v49, v49
  v_smfmac_f32_32x32x32_bf16 a[0:15], v[110:113], v[40:47], v5
  global_load_dwordx4 v[126:129], v1, s[14:15] offset:1024 sc1
  v_exp_f32 v50, v50
  v_exp_f32 v51, v51
  v_exp_f32 v52, v52
  v_mfma_f32_32x32x16_bf16 v[64:79], v[100:103], a[106:109], v[64:79]
  global_load_dwordx4 v[132:135], v6, s[14:15] offset:0 sc1
  v_exp_f32 v53, v53
  v_exp_f32 v54, v54
  v_exp_f32 v55, v55
  v_mfma_f32_32x32x16_bf16 v[80:95], v[100:103], a[110:113], v[80:95]
  global_load_dwordx4 v[136:139], v6, s[14:15] offset:768 sc1
  v_exp_f32 v56, v56
  v_exp_f32 v57, v57
  v_exp_f32 v58, v58
  v_smfmac_f32_32x32x32_bf16 a[16:31], v[106:109], v[48:55], v5
  global_load_dwordx4 v[140:143], v6, s[14:15] offset:1536 sc1
  v_exp_f32 v59, v59
  v_exp_f32 v60, v60
  v_exp_f32 v61, v61
  v_exp_f32 v62, v62
  v_exp_f32 v63, v63
  v_exp_f32 v64, v64
  v_exp_f32 v65, v65
  v_smfmac_f32_32x32x32_bf16 a[16:31], v[110:113], v[56:63], v5
  global_load_dwordx4 v[144:147], v6, s[14:15] offset:2304 sc1
  v_exp_f32 v66, v66
  v_exp_f32 v67, v67
  v_exp_f32 v68, v68
  v_mfma_f32_32x32x4_2b_bf16 v[32:63], v[104:105], a[124:125], 0 cbsz:1 abid:0
  v_exp_f32 v69, v69
  v_exp_f32 v70, v70
  v_exp_f32 v71, v71
  v_exp_f32 v72, v72
  v_exp_f32 v73, v73
  v_exp_f32 v74, v74
  v_exp_f32 v75, v75
  v_exp_f32 v76, v76
  v_smfmac_f32_32x32x32_bf16 a[0:15], v[114:117], v[64:71], v5
  s_barrier
  v_exp_f32 v77, v77
  v_exp_f32 v78, v78
  v_exp_f32 v79, v79
  v_exp_f32 v80, v80
  v_exp_f32 v81, v81
  v_smfmac_f32_32x32x32_bf16 a[0:15], v[118:121], v[72:79], v5
  s_cmp_ge_u32 s5, 8
  s_cselect_b64 s[36:37], s[44:45], s[42:43]
  v_exp_f32 v82, v82
  v_exp_f32 v83, v83
  v_exp_f32 v84, v84
  v_mfma_f32_32x32x16_bf16 v[32:47], v[96:99], a[116:119], v[32:47]
  v_exp_f32 v85, v85
  v_exp_f32 v86, v86
  v_exp_f32 v87, v87
  v_mfma_f32_32x32x16_bf16 v[48:63], v[96:99], a[120:123], v[48:63]
  v_exp_f32 v88, v88
  v_exp_f32 v89, v89
  v_exp_f32 v90, v90
  v_smfmac_f32_32x32x32_bf16 a[16:31], v[114:117], v[80:87], v5
  s_add_u32 s36, s36, 0
  s_addc_u32 s37, s37, 0
  v_exp_f32 v91, v91
  v_exp_f32 v92, v92
  v_exp_f32 v93, v93
  v_exp_f32 v94, v94
  v_exp_f32 v95, v95
  v_exp_f32 v32, v32
  v_exp_f32 v33, v33
  v_smfmac_f32_32x32x32_bf16 a[16:31], v[118:121], v[88:95], v5
  s_add_u32 m0, s94, 0
  v_exp_f32 v34, v34
  v_exp_f32 v35, v35
  v_exp_f32 v36, v36
  v_mfma_f32_32x32x4_2b_bf16 v[64:95], v[104:105], a[124:125], 0 cbsz:1 abid:1
  v_exp_f32 v37, v37
  v_exp_f32 v38, v38
  v_exp_f32 v39, v39
  v_exp_f32 v40, v40
  v_exp_f32 v41, v41
  v_exp_f32 v42, v42
  v_exp_f32 v43, v43
  v_exp_f32 v44, v44
  v_smfmac_f32_32x32x32_bf16 a[32:47], v[106:109], v[32:39], v5
  global_load_lds_dwordx4 v20, s[36:37] offset:0
  v_exp_f32 v45, v45
  v_exp_f32 v46, v46
  v_exp_f32 v47, v47
  v_exp_f32 v48, v48
  v_exp_f32 v49, v49
  v_smfmac_f32_32x32x32_bf16 a[32:47], v[110:113], v[40:47], v5
  global_load_lds_dwordx4 v180, s[36:37] offset:1024
  v_exp_f32 v50, v50
  v_exp_f32 v51, v51
  v_exp_f32 v52, v52
  v_mfma_f32_32x32x16_bf16 v[64:79], v[100:103], a[116:119], v[64:79]
  global_load_lds_dwordx4 v181, s[36:37] offset:2048
  v_exp_f32 v53, v53
  v_exp_f32 v54, v54
  v_exp_f32 v55, v55
  v_mfma_f32_32x32x16_bf16 v[80:95], v[100:103], a[120:123], v[80:95]
  global_load_lds_dwordx4 v182, s[36:37] offset:3072
  v_exp_f32 v56, v56
  v_exp_f32 v57, v57
  v_exp_f32 v58, v58
  v_smfmac_f32_32x32x32_bf16 a[48:63], v[106:109], v[48:55], v5
  s_and_b32 s6, s67, 3
  s_lshl_b32 s72, s6, 2
  v_exp_f32 v59, v59
  v_exp_f32 v60, v60
  v_exp_f32 v61, v61
  v_exp_f32 v62, v62
  v_exp_f32 v63, v63
  v_exp_f32 v64, v64
  v_exp_f32 v65, v65
  v_smfmac_f32_32x32x32_bf16 a[48:63], v[110:113], v[56:63], v5
  s_add_u32 s72, s72, s64
  s_mul_i32 s72, s72, 51200
  v_exp_f32 v66, v66
  v_exp_f32 v67, v67
  v_exp_f32 v68, v68
  v_mfma_f32_32x32x4_2b_bf16 v[32:63], v[104:105], a[134:135], 0 cbsz:1 abid:0
  v_exp_f32 v69, v69
  v_exp_f32 v70, v70
  v_exp_f32 v71, v71
  v_exp_f32 v72, v72
  v_exp_f32 v73, v73
  v_exp_f32 v74, v74
  v_exp_f32 v75, v75
  v_exp_f32 v76, v76
  v_smfmac_f32_32x32x32_bf16 a[32:47], v[114:117], v[64:71], v5
  s_mul_i32 s79, s68, 160
  s_add_u32 s72, s79, s72
  v_exp_f32 v77, v77
  v_exp_f32 v78, v78
  v_exp_f32 v79, v79
  v_exp_f32 v80, v80
  v_exp_f32 v81, v81
  v_smfmac_f32_32x32x32_bf16 a[32:47], v[118:121], v[72:79], v5
  s_add_u32 s100, s12, s72
  s_addc_u32 s101, s13, 0
  v_exp_f32 v82, v82
  v_exp_f32 v83, v83
  v_exp_f32 v84, v84
  v_mfma_f32_32x32x16_bf16 v[32:47], v[96:99], a[126:129], v[32:47]
  v_exp_f32 v85, v85
  v_exp_f32 v86, v86
  v_exp_f32 v87, v87
  v_mfma_f32_32x32x16_bf16 v[48:63], v[96:99], a[130:133], v[48:63]
  v_exp_f32 v88, v88
  v_exp_f32 v89, v89
  v_exp_f32 v90, v90
  v_smfmac_f32_32x32x32_bf16 a[48:63], v[114:117], v[80:87], v5
  s_sub_u32 s46, s100, 819200
  s_subb_u32 s47, s101, 0
  v_exp_f32 v91, v91
  v_exp_f32 v92, v92
  v_exp_f32 v93, v93
  v_exp_f32 v94, v94
  v_exp_f32 v95, v95
  v_exp_f32 v32, v32
  v_exp_f32 v33, v33
  v_smfmac_f32_32x32x32_bf16 a[48:63], v[118:121], v[88:95], v5
  s_add_u32 s36, s36, 98304
  s_addc_u32 s37, s37, 0
  v_exp_f32 v34, v34
  v_exp_f32 v35, v35
  v_exp_f32 v36, v36
  v_mfma_f32_32x32x4_2b_bf16 v[64:95], v[104:105], a[134:135], 0 cbsz:1 abid:1
  v_exp_f32 v37, v37
  v_exp_f32 v38, v38
  v_exp_f32 v39, v39
  v_exp_f32 v40, v40
  v_exp_f32 v41, v41
  v_exp_f32 v42, v42
  v_exp_f32 v43, v43
  v_exp_f32 v44, v44
  v_smfmac_f32_32x32x32_bf16 a[64:79], v[106:109], v[32:39], v5
  s_add_u32 m0, s94, 4096
  v_exp_f32 v45, v45
  v_exp_f32 v46, v46
  v_exp_f32 v47, v47
  v_exp_f32 v48, v48
  v_exp_f32 v49, v49
  v_smfmac_f32_32x32x32_bf16 a[64:79], v[110:113], v[40:47], v5
  global_load_lds_dwordx4 v20, s[36:37] offset:0
  v_exp_f32 v50, v50
  v_exp_f32 v51, v51
  v_exp_f32 v52, v52
  v_mfma_f32_32x32x16_bf16 v[64:79], v[100:103], a[126:129], v[64:79]
  global_load_lds_dwordx4 v180, s[36:37] offset:1024
  v_exp_f32 v53, v53
  v_exp_f32 v54, v54
  v_exp_f32 v55, v55
  v_mfma_f32_32x32x16_bf16 v[80:95], v[100:103], a[130:133], v[80:95]
  global_load_lds_dwordx4 v181, s[36:37] offset:2048
  v_exp_f32 v56, v56
  v_exp_f32 v57, v57
  v_exp_f32 v58, v58
  v_smfmac_f32_32x32x32_bf16 a[80:95], v[106:109], v[48:55], v5
  global_load_lds_dwordx4 v182, s[36:37] offset:3072
  v_exp_f32 v59, v59
  v_exp_f32 v60, v60
  v_exp_f32 v61, v61
  v_exp_f32 v62, v62
  v_exp_f32 v63, v63
  v_exp_f32 v64, v64
  v_exp_f32 v65, v65
  v_smfmac_f32_32x32x32_bf16 a[80:95], v[110:113], v[56:63], v5
  s_mul_i32 s73, s64, 204800
  s_add_u32 s79, s79, s73
  v_exp_f32 v66, v66
  v_exp_f32 v67, v67
  v_exp_f32 v68, v68
  v_mfma_f32_32x32x4_2b_bf16 v[32:63], v[104:105], a[104:105], 0 cbsz:1 abid:0
  v_exp_f32 v69, v69
  v_exp_f32 v70, v70
  v_exp_f32 v71, v71
  v_exp_f32 v72, v72
  v_exp_f32 v73, v73
  v_exp_f32 v74, v74
  v_exp_f32 v75, v75
  v_exp_f32 v76, v76
  v_smfmac_f32_32x32x32_bf16 a[64:79], v[114:117], v[64:71], v5
  s_getreg_b32 s8, hwreg(HW_REG_XCC_ID, 0, 3)
  s_lshl_b32 s8, s8, 2
  v_exp_f32 v77, v77
  v_exp_f32 v78, v78
  v_exp_f32 v79, v79
  v_exp_f32 v80, v80
  v_exp_f32 v81, v81
  v_smfmac_f32_32x32x32_bf16 a[64:79], v[118:121], v[72:79], v5
  s_mul_i32 s4, s64, 1572864
  s_lshl_b32 s72, s67, 7
  v_exp_f32 v82, v82
  v_exp_f32 v83, v83
  v_exp_f32 v84, v84
  v_mfma_f32_32x32x16_bf16 v[32:47], v[96:99], a[96:99], v[32:47]
  v_exp_f32 v85, v85
  v_exp_f32 v86, v86
  v_exp_f32 v87, v87
  v_mfma_f32_32x32x16_bf16 v[48:63], v[96:99], a[100:103], v[48:63]
  v_exp_f32 v88, v88
  v_exp_f32 v89, v89
  v_exp_f32 v90, v90
  v_smfmac_f32_32x32x32_bf16 a[80:95], v[114:117], v[80:87], v5
  s_add_u32 s4, s4, s72
  s_mul_i32 s78, s68, 196608
  v_exp_f32 v91, v91
  v_exp_f32 v92, v92
  v_exp_f32 v93, v93
  v_exp_f32 v94, v94
  v_exp_f32 v95, v95
  v_exp_f32 v32, v32
  v_exp_f32 v33, v33
  v_smfmac_f32_32x32x32_bf16 a[80:95], v[118:121], v[88:95], v5
  s_add_u32 s78, s78, s4
  s_mov_b64 s[52:53], s[20:21]
  v_exp_f32 v34, v34
  v_exp_f32 v35, v35
  v_exp_f32 v36, v36
  v_mfma_f32_32x32x4_2b_bf16 v[64:95], v[104:105], a[104:105], 0 cbsz:1 abid:1
  v_exp_f32 v37, v37
  v_exp_f32 v38, v38
  v_exp_f32 v39, v39
  v_exp_f32 v40, v40
  v_exp_f32 v41, v41
  v_exp_f32 v42, v42
  v_exp_f32 v43, v43
  v_exp_f32 v44, v44
  v_smfmac_f32_32x32x32_bf16 v[148:163], v[106:109], v[32:39], v5
  s_mov_b32 s54, 6291456
  s_mov_b32 s55, 0x20000
  v_exp_f32 v45, v45
  v_exp_f32 v46, v46
  v_exp_f32 v47, v47
  v_exp_f32 v48, v48
  v_exp_f32 v49, v49
  v_smfmac_f32_32x32x32_bf16 v[148:163], v[110:113], v[40:47], v5
  v_exp_f32 v50, v50
  v_exp_f32 v51, v51
  v_exp_f32 v52, v52
  v_mfma_f32_32x32x16_bf16 v[64:79], v[100:103], a[96:99], v[64:79]
  v_exp_f32 v53, v53
  v_exp_f32 v54, v54
  v_exp_f32 v55, v55
  v_mfma_f32_32x32x16_bf16 v[80:95], v[100:103], a[100:103], v[80:95]
  v_exp_f32 v56, v56
  v_exp_f32 v57, v57
  v_exp_f32 v58, v58
  v_smfmac_f32_32x32x32_bf16 v[164:179], v[106:109], v[48:55], v5
  s_waitcnt vmcnt(8)
  v_max3_u32 v27, v122, v126, v130
  v_max3_u32 v27, v27, v132, v136
  v_max3_u32 v27, v27, v140, v144
  v_cmp_eq_u32 vcc, -1, v27
  v_exp_f32 v59, v59
  v_exp_f32 v60, v60
  v_exp_f32 v61, v61
  v_exp_f32 v62, v62
  v_exp_f32 v63, v63
  v_exp_f32 v64, v64
  v_exp_f32 v65, v65
  v_smfmac_f32_32x32x32_bf16 v[164:179], v[110:113], v[56:63], v5
  s_cbranch_vccnz L_rtykv1_4
L_okkv1_3:
  v_exp_f32 v66, v66
  v_exp_f32 v67, v67
  v_exp_f32 v68, v68
  v_mfma_f32_32x32x4_2b_bf16 v[32:63], v[130:131], a[114:115], 0 cbsz:1 abid:0
  v_exp_f32 v69, v69
  v_exp_f32 v70, v70
  v_exp_f32 v71, v71
  v_exp_f32 v72, v72
  v_exp_f32 v73, v73
  v_exp_f32 v74, v74
  v_exp_f32 v75, v75
  v_exp_f32 v76, v76
  v_smfmac_f32_32x32x32_bf16 v[148:163], v[114:117], v[64:71], v5
  s_add_u32 s77, s92, 8
  s_and_b32 s77, s77, 31
  v_exp_f32 v77, v77
  v_exp_f32 v78, v78
  v_exp_f32 v79, v79
  v_exp_f32 v80, v80
  v_exp_f32 v81, v81
  v_smfmac_f32_32x32x32_bf16 v[148:163], v[118:121], v[72:79], v5
  s_mul_i32 s77, s77, 6144
  v_exp_f32 v82, v82
  v_exp_f32 v83, v83
  v_exp_f32 v84, v84
  v_mfma_f32_32x32x16_bf16 v[32:47], v[122:125], a[106:109], v[32:47]
  s_mul_i32 s74, s67, 81920
  v_exp_f32 v85, v85
  v_exp_f32 v86, v86
  v_exp_f32 v87, v87
  v_mfma_f32_32x32x16_bf16 v[48:63], v[122:125], a[110:113], v[48:63]
  s_add_u32 s74, s74, 1048576
  v_exp_f32 v88, v88
  v_exp_f32 v89, v89
  v_exp_f32 v90, v90
  v_smfmac_f32_32x32x32_bf16 v[164:179], v[114:117], v[80:87], v5
  s_add_u32 s14, s28, s77
  s_addc_u32 s15, s29, 0
  v_exp_f32 v91, v91
  v_exp_f32 v92, v92
  v_exp_f32 v93, v93
  v_exp_f32 v94, v94
  v_exp_f32 v95, v95
  v_exp_f32 v32, v32
  v_exp_f32 v33, v33
  v_smfmac_f32_32x32x32_bf16 v[164:179], v[118:121], v[88:95], v5
  global_load_dwordx2 v[104:105], v4, s[14:15] offset:2048 sc1
  v_exp_f32 v34, v34
  v_exp_f32 v35, v35
  v_exp_f32 v36, v36
  v_mfma_f32_32x32x4_2b_bf16 v[64:95], v[130:131], a[114:115], 0 cbsz:1 abid:1
  v_exp_f32 v37, v37
  v_exp_f32 v38, v38
  v_exp_f32 v39, v39
  v_exp_f32 v40, v40
  v_exp_f32 v41, v41
  v_exp_f32 v42, v42
  v_exp_f32 v43, v43
  v_exp_f32 v44, v44
  v_smfmac_f32_32x32x32_bf16 a[0:15], v[132:135], v[32:39], v5
  global_load_dwordx4 v[96:99], v1, s[14:15] offset:0 sc1
  v_exp_f32 v45, v45
  v_exp_f32 v46, v46
  v_exp_f32 v47, v47
  v_exp_f32 v48, v48
  v_exp_f32 v49, v49
  v_smfmac_f32_32x32x32_bf16 a[0:15], v[136:139], v[40:47], v5
  global_load_dwordx4 v[100:103], v1, s[14:15] offset:1024 sc1
  v_exp_f32 v50, v50
  v_exp_f32 v51, v51
  v_exp_f32 v52, v52
  v_mfma_f32_32x32x16_bf16 v[64:79], v[126:129], a[106:109], v[64:79]
  global_load_dwordx4 v[106:109], v6, s[14:15] offset:0 sc1
  v_exp_f32 v53, v53
  v_exp_f32 v54, v54
  v_exp_f32 v55, v55
  v_mfma_f32_32x32x16_bf16 v[80:95], v[126:129], a[110:113], v[80:95]
  global_load_dwordx4 v[110:113], v6, s[14:15] offset:768 sc1
  v_exp_f32 v56, v56
  v_exp_f32 v57, v57
  v_exp_f32 v58, v58
  v_smfmac_f32_32x32x32_bf16 a[16:31], v[132:135], v[48:55], v5
  global_load_dwordx4 v[114:117], v6, s[14:15] offset:1536 sc1
  v_exp_f32 v59, v59
  v_exp_f32 v60, v60
  v_exp_f32 v61, v61
  v_exp_f32 v62, v62
  v_exp_f32 v63, v63
  v_exp_f32 v64, v64
  v_exp_f32 v65, v65
  v_smfmac_f32_32x32x32_bf16 a[16:31], v[136:139], v[56:63], v5
  global_load_dwordx4 v[118:121], v6, s[14:15] offset:2304 sc1
  v_exp_f32 v66, v66
  v_exp_f32 v67, v67
  v_exp_f32 v68, v68
  v_mfma_f32_32x32x4_2b_bf16 v[32:63], v[130:131], a[124:125], 0 cbsz:1 abid:0
  v_exp_f32 v69, v69
  v_exp_f32 v70, v70
  v_exp_f32 v71, v71
  v_exp_f32 v72, v72
  v_exp_f32 v73, v73
  v_exp_f32 v74, v74
  v_exp_f32 v75, v75
  v_exp_f32 v76, v76
  v_smfmac_f32_32x32x32_bf16 a[0:15], v[140:143], v[64:71], v5
  s_cmp_ge_u32 s5, 7
  s_cselect_b64 s[36:37], s[44:45], s[42:43]
  v_exp_f32 v77, v77
  v_exp_f32 v78, v78
  v_exp_f32 v79, v79
  v_exp_f32 v80, v80
  v_exp_f32 v81, v81
  v_smfmac_f32_32x32x32_bf16 a[0:15], v[144:147], v[72:79], v5
  s_add_u32 s36, s36, 196608
  s_addc_u32 s37, s37, 0
  v_exp_f32 v82, v82
  v_exp_f32 v83, v83
  v_exp_f32 v84, v84
  v_mfma_f32_32x32x16_bf16 v[32:47], v[122:125], a[116:119], v[32:47]
  s_add_u32 m0, s94, 8192
  v_exp_f32 v85, v85
  v_exp_f32 v86, v86
  v_exp_f32 v87, v87
  v_mfma_f32_32x32x16_bf16 v[48:63], v[122:125], a[120:123], v[48:63]
  global_load_lds_dwordx4 v20, s[36:37] offset:0
  v_exp_f32 v88, v88
  v_exp_f32 v89, v89
  v_exp_f32 v90, v90
  v_smfmac_f32_32x32x32_bf16 a[16:31], v[140:143], v[80:87], v5
  global_load_lds_dwordx4 v180, s[36:37] offset:1024
  v_exp_f32 v91, v91
  v_exp_f32 v92, v92
  v_exp_f32 v93, v93
  v_exp_f32 v94, v94
  v_exp_f32 v95, v95
  v_exp_f32 v32, v32
  v_exp_f32 v33, v33
  v_smfmac_f32_32x32x32_bf16 a[16:31], v[144:147], v[88:95], v5
  global_load_lds_dwordx4 v181, s[36:37] offset:2048
  v_exp_f32 v34, v34
  v_exp_f32 v35, v35
  v_exp_f32 v36, v36
  v_mfma_f32_32x32x4_2b_bf16 v[64:95], v[130:131], a[124:125], 0 cbsz:1 abid:1
  v_exp_f32 v37, v37
  v_exp_f32 v38, v38
  v_exp_f32 v39, v39
  v_exp_f32 v40, v40
  v_exp_f32 v41, v41
  v_exp_f32 v42, v42
  v_exp_f32 v43, v43
  v_exp_f32 v44, v44
  v_smfmac_f32_32x32x32_bf16 a[32:47], v[132:135], v[32:39], v5
  global_load_lds_dwordx4 v182, s[36:37] offset:3072
  v_exp_f32 v45, v45
  v_exp_f32 v46, v46
  v_exp_f32 v47, v47
  v_exp_f32 v48, v48
  v_exp_f32 v49, v49
  v_smfmac_f32_32x32x32_bf16 a[32:47], v[136:139], v[40:47], v5
  s_and_b32 s72, s64, 1
  s_lshl_b32 s72, s72, 4
  v_exp_f32 v50, v50
  v_exp_f32 v51, v51
  v_exp_f32 v52, v52
  v_mfma_f32_32x32x16_bf16 v[64:79], v[126:129], a[116:119], v[64:79]
  s_lshr_b32 s73, s64, 1
  v_exp_f32 v53, v53
  v_exp_f32 v54, v54
  v_exp_f32 v55, v55
  v_mfma_f32_32x32x16_bf16 v[80:95], v[126:129], a[120:123], v[80:95]
  s_add_u32 s72, s72, s73
  v_exp_f32 v56, v56
  v_exp_f32 v57, v57
  v_exp_f32 v58, v58
  v_smfmac_f32_32x32x32_bf16 a[48:63], v[132:135], v[48:55], v5
  s_lshl_b32 s80, s68, 1
  s_add_u32 s72, s72, s80
  v_exp_f32 v59, v59
  v_exp_f32 v60, v60
  v_exp_f32 v61, v61
  v_exp_f32 v62, v62
  v_exp_f32 v63, v63
  v_exp_f32 v64, v64
  v_exp_f32 v65, v65
  v_smfmac_f32_32x32x32_bf16 a[48:63], v[136:139], v[56:63], v5
  s_lshl_b32 s80, s72, 11
  s_add_u32 s80, s80, s74
  v_exp_f32 v66, v66
  v_exp_f32 v67, v67
  v_exp_f32 v68, v68
  v_mfma_f32_32x32x4_2b_bf16 v[32:63], v[130:131], a[134:135], 0 cbsz:1 abid:0
  v_exp_f32 v69, v69
  v_exp_f32 v70, v70
  v_exp_f32 v71, v71
  v_exp_f32 v72, v72
  v_exp_f32 v73, v73
  v_exp_f32 v74, v74
  v_exp_f32 v75, v75
  v_exp_f32 v76, v76
  v_smfmac_f32_32x32x32_bf16 a[32:47], v[140:143], v[64:71], v5
  s_lshl_b32 s81, s72, 9
  s_add_u32 s81, s81, s74
  v_exp_f32 v77, v77
  v_exp_f32 v78, v78
  v_exp_f32 v79, v79
  v_exp_f32 v80, v80
  v_exp_f32 v81, v81
  v_smfmac_f32_32x32x32_bf16 a[32:47], v[144:147], v[72:79], v5
  s_add_u32 s81, s81, 65536
  s_lshl_b32 s89, s73, 13
  v_exp_f32 v82, v82
  v_exp_f32 v83, v83
  v_exp_f32 v84, v84
  v_mfma_f32_32x32x16_bf16 v[32:47], v[122:125], a[126:129], v[32:47]
  s_add_u32 s89, s89, s74
  v_exp_f32 v85, v85
  v_exp_f32 v86, v86
  v_exp_f32 v87, v87
  v_mfma_f32_32x32x16_bf16 v[48:63], v[122:125], a[130:133], v[48:63]
  s_add_u32 s89, s89, 65536
  v_exp_f32 v88, v88
  v_exp_f32 v89, v89
  v_exp_f32 v90, v90
  v_smfmac_f32_32x32x32_bf16 a[48:63], v[140:143], v[80:87], v5
  s_lshl_b32 s73, s73, 15
  s_add_u32 s74, s74, s73
  v_exp_f32 v91, v91
  v_exp_f32 v92, v92
  v_exp_f32 v93, v93
  v_exp_f32 v94, v94
  v_exp_f32 v95, v95
  v_exp_f32 v32, v32
  v_exp_f32 v33, v33
  v_smfmac_f32_32x32x32_bf16 a[48:63], v[144:147], v[88:95], v5
  s_add_u32 s36, s36, 98304
  s_addc_u32 s37, s37, 0
  v_exp_f32 v34, v34
  v_exp_f32 v35, v35
  v_exp_f32 v36, v36
  v_mfma_f32_32x32x4_2b_bf16 v[64:95], v[130:131], a[134:135], 0 cbsz:1 abid:1
  v_exp_f32 v37, v37
  v_exp_f32 v38, v38
  v_exp_f32 v39, v39
  v_exp_f32 v40, v40
  v_exp_f32 v41, v41
  v_exp_f32 v42, v42
  v_exp_f32 v43, v43
  v_exp_f32 v44, v44
  v_smfmac_f32_32x32x32_bf16 a[64:79], v[132:135], v[32:39], v5
  s_add_u32 m0, s94, 25600
  v_exp_f32 v45, v45
  v_exp_f32 v46, v46
  v_exp_f32 v47, v47
  v_exp_f32 v48, v48
  v_exp_f32 v49, v49
  v_smfmac_f32_32x32x32_bf16 a[64:79], v[136:139], v[40:47], v5
  global_load_lds_dwordx4 v20, s[36:37] offset:0
  v_exp_f32 v50, v50
  v_exp_f32 v51, v51
  v_exp_f32 v52, v52
  v_mfma_f32_32x32x16_bf16 v[64:79], v[126:129], a[126:129], v[64:79]
  global_load_lds_dwordx4 v180, s[36:37] offset:1024
  v_exp_f32 v53, v53
  v_exp_f32 v54, v54
  v_exp_f32 v55, v55
  v_mfma_f32_32x32x16_bf16 v[80:95], v[126:129], a[130:133], v[80:95]
  global_load_lds_dwordx4 v181, s[36:37] offset:2048
  v_exp_f32 v56, v56
  v_exp_f32 v57, v57
  v_exp_f32 v58, v58
  v_smfmac_f32_32x32x32_bf16 a[80:95], v[132:135], v[48:55], v5
  global_load_lds_dwordx4 v182, s[36:37] offset:3072
  v_exp_f32 v59, v59
  v_exp_f32 v60, v60
  v_exp_f32 v61, v61
  v_exp_f32 v62, v62
  v_exp_f32 v63, v63
  v_exp_f32 v64, v64
  v_exp_f32 v65, v65
  v_smfmac_f32_32x32x32_bf16 a[80:95], v[136:139], v[56:63], v5
  s_add_u32 s72, s6, 0
  s_and_b32 s72, s72, 3
  v_exp_f32 v66, v66
  v_exp_f32 v67, v67
  v_exp_f32 v68, v68
  v_mfma_f32_32x32x4_2b_bf16 v[32:63], v[130:131], a[104:105], 0 cbsz:1 abid:0
  v_exp_f32 v69, v69
  v_exp_f32 v70, v70
  v_exp_f32 v71, v71
  v_exp_f32 v72, v72
  v_exp_f32 v73, v73
  v_exp_f32 v74, v74
  v_exp_f32 v75, v75
  v_exp_f32 v76, v76
  v_smfmac_f32_32x32x32_bf16 a[64:79], v[140:143], v[64:71], v5
  s_lshl_b32 s72, s72, 13
  s_add_u32 s82, s72, s74
  v_exp_f32 v77, v77
  v_exp_f32 v78, v78
  v_exp_f32 v79, v79
  v_exp_f32 v80, v80
  v_exp_f32 v81, v81
  v_smfmac_f32_32x32x32_bf16 a[64:79], v[144:147], v[72:79], v5
  s_add_u32 s72, s6, 1
  s_and_b32 s72, s72, 3
  v_exp_f32 v82, v82
  v_exp_f32 v83, v83
  v_exp_f32 v84, v84
  v_mfma_f32_32x32x16_bf16 v[32:47], v[122:125], a[96:99], v[32:47]
  s_lshl_b32 s72, s72, 13
  v_exp_f32 v85, v85
  v_exp_f32 v86, v86
  v_exp_f32 v87, v87
  v_mfma_f32_32x32x16_bf16 v[48:63], v[122:125], a[100:103], v[48:63]
  s_add_u32 s83, s72, s74
  v_exp_f32 v88, v88
  v_exp_f32 v89, v89
  v_exp_f32 v90, v90
  v_smfmac_f32_32x32x32_bf16 a[80:95], v[140:143], v[80:87], v5
  s_add_u32 s72, s6, 2
  s_and_b32 s72, s72, 3
  v_exp_f32 v91, v91
  v_exp_f32 v92, v92
  v_exp_f32 v93, v93
  v_exp_f32 v94, v94
  v_exp_f32 v95, v95
  v_exp_f32 v32, v32
  v_exp_f32 v33, v33
  v_smfmac_f32_32x32x32_bf16 a[80:95], v[144:147], v[88:95], v5
  s_lshl_b32 s72, s72, 13
  s_add_u32 s87, s72, s74
  v_exp_f32 v34, v34
  v_exp_f32 v35, v35
  v_exp_f32 v36, v36
  v_mfma_f32_32x32x4_2b_bf16 v[64:95], v[130:131], a[104:105], 0 cbsz:1 abid:1
  v_exp_f32 v37, v37
  v_exp_f32 v38, v38
  v_exp_f32 v39, v39
  v_exp_f32 v40, v40
  v_exp_f32 v41, v41
  v_exp_f32 v42, v42
  v_exp_f32 v43, v43
  v_exp_f32 v44, v44
  v_smfmac_f32_32x32x32_bf16 v[148:163], v[132:135], v[32:39], v5
  s_add_u32 s72, s6, 3
  s_and_b32 s72, s72, 3
  v_exp_f32 v45, v45
  v_exp_f32 v46, v46
  v_exp_f32 v47, v47
  v_exp_f32 v48, v48
  v_exp_f32 v49, v49
  v_smfmac_f32_32x32x32_bf16 v[148:163], v[136:139], v[40:47], v5
  s_lshl_b32 s72, s72, 13
  s_add_u32 s95, s72, s74
  v_exp_f32 v50, v50
  v_exp_f32 v51, v51
  v_exp_f32 v52, v52
  v_mfma_f32_32x32x16_bf16 v[64:79], v[126:129], a[96:99], v[64:79]
  s_lshl_b32 s72, s67, 2
  v_exp_f32 v53, v53
  v_exp_f32 v54, v54
  v_exp_f32 v55, v55
  v_mfma_f32_32x32x16_bf16 v[80:95], v[126:129], a[100:103], v[80:95]
  s_add_u32 s72, s72, s64
  v_exp_f32 v56, v56
  v_exp_f32 v57, v57
  v_exp_f32 v58, v58
  v_smfmac_f32_32x32x32_bf16 v[164:179], v[132:135], v[48:55], v5
  s_waitcnt vmcnt(8)
  v_max3_u32 v27, v96, v100, v104
  v_max3_u32 v27, v27, v106, v110
  v_max3_u32 v27, v27, v114, v118
  v_cmp_eq_u32 vcc, -1, v27
  v_exp_f32 v59, v59
  v_exp_f32 v60, v60
  v_exp_f32 v61, v61
  v_exp_f32 v62, v62
  v_exp_f32 v63, v63
  v_exp_f32 v64, v64
  v_exp_f32 v65, v65
  v_smfmac_f32_32x32x32_bf16 v[164:179], v[136:139], v[56:63], v5
  s_cbranch_vccnz L_rtykv2_6
L_okkv2_5:
  v_exp_f32 v66, v66
  v_exp_f32 v67, v67
  v_exp_f32 v68, v68
  v_mfma_f32_32x32x4_2b_bf16 v[32:63], v[104:105], a[114:115], 0 cbsz:1 abid:0
  v_exp_f32 v69, v69
  v_exp_f32 v70, v70
  v_exp_f32 v71, v71
  v_exp_f32 v72, v72
  v_exp_f32 v73, v73
  v_exp_f32 v74, v74
  v_exp_f32 v75, v75
  v_exp_f32 v76, v76
  v_smfmac_f32_32x32x32_bf16 v[148:163], v[140:143], v[64:71], v5
  s_add_u32 s77, s92, 12
  s_and_b32 s77, s77, 31
  v_exp_f32 v77, v77
  v_exp_f32 v78, v78
  v_exp_f32 v79, v79
  v_exp_f32 v80, v80
  v_exp_f32 v81, v81
  v_smfmac_f32_32x32x32_bf16 v[148:163], v[144:147], v[72:79], v5
  s_mul_i32 s77, s77, 6144
  v_exp_f32 v82, v82
  v_exp_f32 v83, v83
  v_exp_f32 v84, v84
  v_mfma_f32_32x32x16_bf16 v[32:47], v[96:99], a[106:109], v[32:47]
  s_lshl_b32 s72, s72, 10
  v_exp_f32 v85, v85
  v_exp_f32 v86, v86
  v_exp_f32 v87, v87
  v_mfma_f32_32x32x16_bf16 v[48:63], v[96:99], a[110:113], v[48:63]
  s_add_u32 s84, s72, 3670016
  v_exp_f32 v88, v88
  v_exp_f32 v89, v89
  v_exp_f32 v90, v90
  v_smfmac_f32_32x32x32_bf16 v[164:179], v[140:143], v[80:87], v5
  s_add_u32 s14, s28, s77
  s_addc_u32 s15, s29, 0
  v_exp_f32 v91, v91
  v_exp_f32 v92, v92
  v_exp_f32 v93, v93
  v_exp_f32 v94, v94
  v_exp_f32 v95, v95
  v_exp_f32 v32, v32
  v_exp_f32 v33, v33
  v_smfmac_f32_32x32x32_bf16 v[164:179], v[144:147], v[88:95], v5
  global_load_dwordx2 v[130:131], v4, s[14:15] offset:2048 sc1
  v_exp_f32 v34, v34
  v_exp_f32 v35, v35
  v_exp_f32 v36, v36
  v_mfma_f32_32x32x4_2b_bf16 v[64:95], v[104:105], a[114:115], 0 cbsz:1 abid:1
  v_exp_f32 v37, v37
  v_exp_f32 v38, v38
  v_exp_f32 v39, v39
  v_exp_f32 v40, v40
  v_exp_f32 v41, v41
  v_exp_f32 v42, v42
  v_exp_f32 v43, v43
  v_exp_f32 v44, v44
  v_smfmac_f32_32x32x32_bf16 a[0:15], v[106:109], v[32:39], v5
  global_load_dwordx4 v[122:125], v1, s[14:15] offset:0 sc1
  v_exp_f32 v45, v45
  v_exp_f32 v46, v46
  v_exp_f32 v47, v47
  v_exp_f32 v48, v48
  v_exp_f32 v49, v49
  v_smfmac_f32_32x32x32_bf16 a[0:15], v[110:113], v[40:47], v5
  global_load_dwordx4 v[126:129], v1, s[14:15] offset:1024 sc1
  v_exp_f32 v50, v50
  v_exp_f32 v51, v51
  v_exp_f32 v52, v52
  v_mfma_f32_32x32x16_bf16 v[64:79], v[100:103], a[106:109], v[64:79]
  global_load_dwordx4 v[132:135], v6, s[14:15] offset:0 sc1
  v_exp_f32 v53, v53
  v_exp_f32 v54, v54
  v_exp_f32 v55, v55
  v_mfma_f32_32x32x16_bf16 v[80:95], v[100:103], a[110:113], v[80:95]
  global_load_dwordx4 v[136:139], v6, s[14:15] offset:768 sc1
  v_exp_f32 v56, v56
  v_exp_f32 v57, v57
  v_exp_f32 v58, v58
  v_smfmac_f32_32x32x32_bf16 a[16:31], v[106:109], v[48:55], v5
  global_load_dwordx4 v[140:143], v6, s[14:15] offset:1536 sc1
  v_exp_f32 v59, v59
  v_exp_f32 v60, v60
  v_exp_f32 v61, v61
  v_exp_f32 v62, v62
  v_exp_f32 v63, v63
  v_exp_f32 v64, v64
  v_exp_f32 v65, v65
  v_smfmac_f32_32x32x32_bf16 a[16:31], v[110:113], v[56:63], v5
  global_load_dwordx4 v[144:147], v6, s[14:15] offset:2304 sc1
  v_exp_f32 v66, v66
  v_exp_f32 v67, v67
  v_exp_f32 v68, v68
  v_mfma_f32_32x32x4_2b_bf16 v[32:63], v[104:105], a[124:125], 0 cbsz:1 abid:0
  v_exp_f32 v69, v69
  v_exp_f32 v70, v70
  v_exp_f32 v71, v71
  v_exp_f32 v72, v72
  v_exp_f32 v73, v73
  v_exp_f32 v74, v74
  v_exp_f32 v75, v75
  v_exp_f32 v76, v76
  v_smfmac_f32_32x32x32_bf16 a[0:15], v[114:117], v[64:71], v5
  s_cmp_ge_u32 s5, 6
  s_cselect_b64 s[36:37], s[44:45], s[42:43]
  v_exp_f32 v77, v77
  v_exp_f32 v78, v78
  v_exp_f32 v79, v79
  v_exp_f32 v80, v80
  v_exp_f32 v81, v81
  v_smfmac_f32_32x32x32_bf16 a[0:15], v[118:121], v[72:79], v5
  s_add_u32 s36, s36, 393216
  s_addc_u32 s37, s37, 0
  v_exp_f32 v82, v82
  v_exp_f32 v83, v83
  v_exp_f32 v84, v84
  v_mfma_f32_32x32x16_bf16 v[32:47], v[96:99], a[116:119], v[32:47]
  s_add_u32 m0, s94, 31744
  v_exp_f32 v85, v85
  v_exp_f32 v86, v86
  v_exp_f32 v87, v87
  v_mfma_f32_32x32x16_bf16 v[48:63], v[96:99], a[120:123], v[48:63]
  global_load_lds_dwordx4 v20, s[36:37] offset:0
  v_exp_f32 v88, v88
  v_exp_f32 v89, v89
  v_exp_f32 v90, v90
  v_smfmac_f32_32x32x32_bf16 a[16:31], v[114:117], v[80:87], v5
  global_store_dwordx4 v1, v[28:31], s[40:41] offset:-3072 sc1
  global_load_lds_dwordx4 v180, s[36:37] offset:1024
  v_exp_f32 v91, v91
  v_exp_f32 v92, v92
  v_exp_f32 v93, v93
  v_exp_f32 v94, v94
  v_exp_f32 v95, v95
  v_exp_f32 v32, v32
  v_exp_f32 v33, v33
  v_smfmac_f32_32x32x32_bf16 a[16:31], v[118:121], v[88:95], v5
  global_load_lds_dwordx4 v181, s[36:37] offset:2048
  v_exp_f32 v34, v34
  v_exp_f32 v35, v35
  v_exp_f32 v36, v36
  v_mfma_f32_32x32x4_2b_bf16 v[64:95], v[104:105], a[124:125], 0 cbsz:1 abid:1
  v_exp_f32 v37, v37
  v_exp_f32 v38, v38
  v_exp_f32 v39, v39
  v_exp_f32 v40, v40
  v_exp_f32 v41, v41
  v_exp_f32 v42, v42
  v_exp_f32 v43, v43
  v_exp_f32 v44, v44
  v_smfmac_f32_32x32x32_bf16 a[32:47], v[106:109], v[32:39], v5
  global_load_lds_dwordx4 v182, s[36:37] offset:3072
  v_exp_f32 v45, v45
  v_exp_f32 v46, v46
  v_exp_f32 v47, v47
  v_exp_f32 v48, v48
  v_exp_f32 v49, v49
  v_smfmac_f32_32x32x32_bf16 a[32:47], v[110:113], v[40:47], v5
  ds_read_b64_tr_b16 a[136:137], v21 offset:0
  ds_read_b64_tr_b16 a[138:139], v21 offset:512
  v_exp_f32 v50, v50
  v_exp_f32 v51, v51
  v_exp_f32 v52, v52
  v_mfma_f32_32x32x16_bf16 v[64:79], v[100:103], a[116:119], v[64:79]
  ds_read_b64_tr_b16 a[140:141], v22 offset:0
  ds_read_b64_tr_b16 a[142:143], v22 offset:512
  v_exp_f32 v53, v53
  v_exp_f32 v54, v54
  v_exp_f32 v55, v55
  v_mfma_f32_32x32x16_bf16 v[80:95], v[100:103], a[120:123], v[80:95]
  ds_read_b64_tr_b16 a[144:145], v21 offset:2048
  ds_read_b64_tr_b16 a[146:147], v21 offset:2560
  v_exp_f32 v56, v56
  v_exp_f32 v57, v57
  v_exp_f32 v58, v58
  v_smfmac_f32_32x32x32_bf16 a[48:63], v[106:109], v[48:55], v5
  ds_read_b64_tr_b16 a[148:149], v22 offset:2048
  ds_read_b64_tr_b16 a[150:151], v22 offset:2560
  v_exp_f32 v59, v59
  v_exp_f32 v60, v60
  v_exp_f32 v61, v61
  v_exp_f32 v62, v62
  v_exp_f32 v63, v63
  v_exp_f32 v64, v64
  v_exp_f32 v65, v65
  v_smfmac_f32_32x32x32_bf16 a[48:63], v[110:113], v[56:63], v5
  s_add_u32 s36, s36, 98304
  s_addc_u32 s37, s37, 0
  v_exp_f32 v66, v66
  v_exp_f32 v67, v67
  v_exp_f32 v68, v68
  v_mfma_f32_32x32x4_2b_bf16 v[32:63], v[104:105], a[134:135], 0 cbsz:1 abid:0
  v_exp_f32 v69, v69
  v_exp_f32 v70, v70
  v_exp_f32 v71, v71
  v_exp_f32 v72, v72
  v_exp_f32 v73, v73
  v_exp_f32 v74, v74
  v_exp_f32 v75, v75
  v_exp_f32 v76, v76
  v_smfmac_f32_32x32x32_bf16 a[32:47], v[114:117], v[64:71], v5
  s_add_u32 m0, s94, 35840
  v_exp_f32 v77, v77
  v_exp_f32 v78, v78
  v_exp_f32 v79, v79
  v_exp_f32 v80, v80
  v_exp_f32 v81, v81
  v_smfmac_f32_32x32x32_bf16 a[32:47], v[118:121], v[72:79], v5
  global_load_lds_dwordx4 v20, s[36:37] offset:0
  v_exp_f32 v82, v82
  v_exp_f32 v83, v83
  v_exp_f32 v84, v84
  v_mfma_f32_32x32x16_bf16 v[32:47], v[96:99], a[126:129], v[32:47]
  global_load_lds_dwordx4 v180, s[36:37] offset:1024
  v_exp_f32 v85, v85
  v_exp_f32 v86, v86
  v_exp_f32 v87, v87
  v_mfma_f32_32x32x16_bf16 v[48:63], v[96:99], a[130:133], v[48:63]
  global_load_lds_dwordx4 v181, s[36:37] offset:2048
  v_exp_f32 v88, v88
  v_exp_f32 v89, v89
  v_exp_f32 v90, v90
  v_smfmac_f32_32x32x32_bf16 a[48:63], v[114:117], v[80:87], v5
  global_store_dwordx4 v1, v[28:31], s[40:41] offset:-2048 sc1
  global_load_lds_dwordx4 v182, s[36:37] offset:3072
  v_exp_f32 v91, v91
  v_exp_f32 v92, v92
  v_exp_f32 v93, v93
  v_exp_f32 v94, v94
  v_exp_f32 v95, v95
  v_exp_f32 v32, v32
  v_exp_f32 v33, v33
  v_smfmac_f32_32x32x32_bf16 a[48:63], v[118:121], v[88:95], v5
  ds_read_b64_tr_b16 a[152:153], v21 offset:4096
  ds_read_b64_tr_b16 a[154:155], v21 offset:4608
  v_exp_f32 v34, v34
  v_exp_f32 v35, v35
  v_exp_f32 v36, v36
  v_mfma_f32_32x32x4_2b_bf16 v[64:95], v[104:105], a[134:135], 0 cbsz:1 abid:1
  v_exp_f32 v37, v37
  v_exp_f32 v38, v38
  v_exp_f32 v39, v39
  v_exp_f32 v40, v40
  v_exp_f32 v41, v41
  v_exp_f32 v42, v42
  v_exp_f32 v43, v43
  v_exp_f32 v44, v44
  v_smfmac_f32_32x32x32_bf16 a[64:79], v[106:109], v[32:39], v5
  ds_read_b64_tr_b16 a[156:157], v22 offset:4096
  ds_read_b64_tr_b16 a[158:159], v22 offset:4608
  v_exp_f32 v45, v45
  v_exp_f32 v46, v46
  v_exp_f32 v47, v47
  v_exp_f32 v48, v48
  v_exp_f32 v49, v49
  v_smfmac_f32_32x32x32_bf16 a[64:79], v[110:113], v[40:47], v5
  ds_read_b64_tr_b16 a[160:161], v21 offset:6144
  ds_read_b64_tr_b16 a[162:163], v21 offset:6656
  v_exp_f32 v50, v50
  v_exp_f32 v51, v51
  v_exp_f32 v52, v52
  v_mfma_f32_32x32x16_bf16 v[64:79], v[100:103], a[126:129], v[64:79]
  ds_read_b64_tr_b16 a[164:165], v22 offset:6144
  ds_read_b64_tr_b16 a[166:167], v22 offset:6656
  v_exp_f32 v53, v53
  v_exp_f32 v54, v54
  v_exp_f32 v55, v55
  v_mfma_f32_32x32x16_bf16 v[80:95], v[100:103], a[130:133], v[80:95]
  s_add_u32 s86, s72, 3801088
  v_exp_f32 v56, v56
  v_exp_f32 v57, v57
  v_exp_f32 v58, v58
  v_smfmac_f32_32x32x32_bf16 a[80:95], v[106:109], v[48:55], v5
  s_cmp_ge_u32 s5, 5
  s_cselect_b64 s[36:37], s[44:45], s[42:43]
  v_exp_f32 v59, v59
  v_exp_f32 v60, v60
  v_exp_f32 v61, v61
  v_exp_f32 v62, v62
  v_exp_f32 v63, v63
  v_exp_f32 v64, v64
  v_exp_f32 v65, v65
  v_smfmac_f32_32x32x32_bf16 a[80:95], v[110:113], v[56:63], v5
  s_add_u32 s36, s36, 589824
  s_addc_u32 s37, s37, 0
  v_exp_f32 v66, v66
  v_exp_f32 v67, v67
  v_exp_f32 v68, v68
  v_mfma_f32_32x32x4_2b_bf16 v[32:63], v[104:105], a[104:105], 0 cbsz:1 abid:0
  v_exp_f32 v69, v69
  v_exp_f32 v70, v70
  v_exp_f32 v71, v71
  v_exp_f32 v72, v72
  v_exp_f32 v73, v73
  v_exp_f32 v74, v74
  v_exp_f32 v75, v75
  v_exp_f32 v76, v76
  v_smfmac_f32_32x32x32_bf16 a[64:79], v[114:117], v[64:71], v5
  s_waitcnt lgkmcnt(8)
  s_add_u32 m0, s94, 0
  v_exp_f32 v77, v77
  v_exp_f32 v78, v78
  v_exp_f32 v79, v79
  v_exp_f32 v80, v80
  v_exp_f32 v81, v81
  v_smfmac_f32_32x32x32_bf16 a[64:79], v[118:121], v[72:79], v5
  global_load_lds_dwordx4 v20, s[36:37] offset:0
  v_exp_f32 v82, v82
  v_exp_f32 v83, v83
  v_exp_f32 v84, v84
  v_mfma_f32_32x32x16_bf16 v[32:47], v[96:99], a[96:99], v[32:47]
  global_load_lds_dwordx4 v180, s[36:37] offset:1024
  v_exp_f32 v85, v85
  v_exp_f32 v86, v86
  v_exp_f32 v87, v87
  v_mfma_f32_32x32x16_bf16 v[48:63], v[96:99], a[100:103], v[48:63]
  global_load_lds_dwordx4 v181, s[36:37] offset:2048
  v_exp_f32 v88, v88
  v_exp_f32 v89, v89
  v_exp_f32 v90, v90
  v_smfmac_f32_32x32x32_bf16 a[80:95], v[114:117], v[80:87], v5
  global_store_dwordx4 v1, v[28:31], s[40:41] offset:-1024 sc1
  global_load_lds_dwordx4 v182, s[36:37] offset:3072
  v_exp_f32 v91, v91
  v_exp_f32 v92, v92
  v_exp_f32 v93, v93
  v_exp_f32 v94, v94
  v_exp_f32 v95, v95
  v_exp_f32 v32, v32
  v_exp_f32 v33, v33
  v_smfmac_f32_32x32x32_bf16 a[80:95], v[118:121], v[88:95], v5
  s_lshr_b32 s73, s68, 2
  s_mul_i32 s73, s73, 240
  v_exp_f32 v34, v34
  v_exp_f32 v35, v35
  v_exp_f32 v36, v36
  v_mfma_f32_32x32x4_2b_bf16 v[64:95], v[104:105], a[104:105], 0 cbsz:1 abid:1
  v_exp_f32 v37, v37
  v_exp_f32 v38, v38
  v_exp_f32 v39, v39
  v_exp_f32 v40, v40
  v_exp_f32 v41, v41
  v_exp_f32 v42, v42
  v_exp_f32 v43, v43
  v_exp_f32 v44, v44
  v_smfmac_f32_32x32x32_bf16 v[148:163], v[106:109], v[32:39], v5
  s_lshl_b32 s85, s68, 2
  s_add_u32 s85, s85, s73
  v_exp_f32 v45, v45
  v_exp_f32 v46, v46
  v_exp_f32 v47, v47
  v_exp_f32 v48, v48
  v_exp_f32 v49, v49
  v_smfmac_f32_32x32x32_bf16 v[148:163], v[110:113], v[40:47], v5
  s_add_u32 s85, s85, s84
  s_lshr_b32 s30, s72, 5
  v_exp_f32 v50, v50
  v_exp_f32 v51, v51
  v_exp_f32 v52, v52
  v_mfma_f32_32x32x16_bf16 v[64:79], v[100:103], a[96:99], v[64:79]
  s_lshl_b32 s72, s70, 2
  v_exp_f32 v53, v53
  v_exp_f32 v54, v54
  v_exp_f32 v55, v55
  v_mfma_f32_32x32x16_bf16 v[80:95], v[100:103], a[100:103], v[80:95]
  s_add_u32 s72, s72, s64
  v_exp_f32 v56, v56
  v_exp_f32 v57, v57
  v_exp_f32 v58, v58
  v_smfmac_f32_32x32x32_bf16 v[164:179], v[106:109], v[48:55], v5
  s_waitcnt vmcnt(15)
  v_max3_u32 v27, v122, v126, v130
  v_max3_u32 v27, v27, v132, v136
  v_max3_u32 v27, v27, v140, v144
  v_cmp_eq_u32 vcc, -1, v27
  v_exp_f32 v59, v59
  v_exp_f32 v60, v60
  v_exp_f32 v61, v61
  v_exp_f32 v62, v62
  v_exp_f32 v63, v63
  v_exp_f32 v64, v64
  v_exp_f32 v65, v65
  v_smfmac_f32_32x32x32_bf16 v[164:179], v[110:113], v[56:63], v5
  s_cbranch_vccnz L_rtykv3_8
L_okkv3_7:
  v_exp_f32 v66, v66
  v_exp_f32 v67, v67
  v_exp_f32 v68, v68
  v_mfma_f32_32x32x4_2b_bf16 v[32:63], v[130:131], a[114:115], 0 cbsz:1 abid:0
  v_exp_f32 v69, v69
  v_exp_f32 v70, v70
  v_exp_f32 v71, v71
  v_exp_f32 v72, v72
  v_exp_f32 v73, v73
  v_exp_f32 v74, v74
  v_exp_f32 v75, v75
  v_exp_f32 v76, v76
  v_smfmac_f32_32x32x32_bf16 v[148:163], v[114:117], v[64:71], v5
  s_add_u32 s77, s92, 16
  s_and_b32 s77, s77, 31
  v_exp_f32 v77, v77
  v_exp_f32 v78, v78
  v_exp_f32 v79, v79
  v_exp_f32 v80, v80
  v_exp_f32 v81, v81
  v_smfmac_f32_32x32x32_bf16 v[148:163], v[118:121], v[72:79], v5
  s_mul_i32 s77, s77, 6144
  v_exp_f32 v82, v82
  v_exp_f32 v83, v83
  v_exp_f32 v84, v84
  v_mfma_f32_32x32x16_bf16 v[32:47], v[122:125], a[106:109], v[32:47]
  s_lshl_b32 s90, s72, 5
  v_exp_f32 v85, v85
  v_exp_f32 v86, v86
  v_exp_f32 v87, v87
  v_mfma_f32_32x32x16_bf16 v[48:63], v[122:125], a[110:113], v[48:63]
  s_mov_b64 s[56:57], s[24:25]
  v_exp_f32 v88, v88
  v_exp_f32 v89, v89
  v_exp_f32 v90, v90
  v_smfmac_f32_32x32x32_bf16 v[164:179], v[114:117], v[80:87], v5
  s_add_u32 s14, s28, s77
  s_addc_u32 s15, s29, 0
  v_exp_f32 v91, v91
  v_exp_f32 v92, v92
  v_exp_f32 v93, v93
  v_exp_f32 v94, v94
  v_exp_f32 v95, v95
  v_exp_f32 v32, v32
  v_exp_f32 v33, v33
  v_smfmac_f32_32x32x32_bf16 v[164:179], v[118:121], v[88:95], v5
  global_load_dwordx2 v[104:105], v4, s[14:15] offset:2048 sc1
  v_exp_f32 v34, v34
  v_exp_f32 v35, v35
  v_exp_f32 v36, v36
  v_mfma_f32_32x32x4_2b_bf16 v[64:95], v[130:131], a[114:115], 0 cbsz:1 abid:1
  v_exp_f32 v37, v37
  v_exp_f32 v38, v38
  v_exp_f32 v39, v39
  v_exp_f32 v40, v40
  v_exp_f32 v41, v41
  v_exp_f32 v42, v42
  v_exp_f32 v43, v43
  v_exp_f32 v44, v44
  v_smfmac_f32_32x32x32_bf16 a[0:15], v[132:135], v[32:39], v5
  global_load_dwordx4 v[96:99], v1, s[14:15] offset:0 sc1
  v_exp_f32 v45, v45
  v_exp_f32 v46, v46
  v_exp_f32 v47, v47
  v_exp_f32 v48, v48
  v_exp_f32 v49, v49
  v_smfmac_f32_32x32x32_bf16 a[0:15], v[136:139], v[40:47], v5
  global_load_dwordx4 v[100:103], v1, s[14:15] offset:1024 sc1
  v_exp_f32 v50, v50
  v_exp_f32 v51, v51
  v_exp_f32 v52, v52
  v_mfma_f32_32x32x16_bf16 v[64:79], v[126:129], a[106:109], v[64:79]
  global_load_dwordx4 v[106:109], v6, s[14:15] offset:0 sc1
  v_exp_f32 v53, v53
  v_exp_f32 v54, v54
  v_exp_f32 v55, v55
  v_mfma_f32_32x32x16_bf16 v[80:95], v[126:129], a[110:113], v[80:95]
  global_load_dwordx4 v[110:113], v6, s[14:15] offset:768 sc1
  v_exp_f32 v56, v56
  v_exp_f32 v57, v57
  v_exp_f32 v58, v58
  v_smfmac_f32_32x32x32_bf16 a[16:31], v[132:135], v[48:55], v5
  global_load_dwordx4 v[114:117], v6, s[14:15] offset:1536 sc1
  v_exp_f32 v59, v59
  v_exp_f32 v60, v60
  v_exp_f32 v61, v61
  v_exp_f32 v62, v62
  v_exp_f32 v63, v63
  v_exp_f32 v64, v64
  v_exp_f32 v65, v65
  v_smfmac_f32_32x32x32_bf16 a[16:31], v[136:139], v[56:63], v5
  global_load_dwordx4 v[118:121], v6, s[14:15] offset:2304 sc1
  v_exp_f32 v66, v66
  v_exp_f32 v67, v67
  v_exp_f32 v68, v68
  v_mfma_f32_32x32x4_2b_bf16 v[32:63], v[130:131], a[124:125], 0 cbsz:1 abid:0
  v_exp_f32 v69, v69
  v_exp_f32 v70, v70
  v_exp_f32 v71, v71
  v_exp_f32 v72, v72
  v_exp_f32 v73, v73
  v_exp_f32 v74, v74
  v_exp_f32 v75, v75
  v_exp_f32 v76, v76
  v_smfmac_f32_32x32x32_bf16 a[0:15], v[140:143], v[64:71], v5
  ds_read_b64_tr_b16 a[168:169], v21 offset:8192
  ds_read_b64_tr_b16 a[170:171], v21 offset:8704
  v_exp_f32 v77, v77
  v_exp_f32 v78, v78
  v_exp_f32 v79, v79
  v_exp_f32 v80, v80
  v_exp_f32 v81, v81
  v_smfmac_f32_32x32x32_bf16 a[0:15], v[144:147], v[72:79], v5
  ds_read_b64_tr_b16 a[172:173], v22 offset:8192
  ds_read_b64_tr_b16 a[174:175], v22 offset:8704
  v_exp_f32 v82, v82
  v_exp_f32 v83, v83
  v_exp_f32 v84, v84
  v_mfma_f32_32x32x16_bf16 v[32:47], v[122:125], a[116:119], v[32:47]
  ds_read_b64_tr_b16 a[176:177], v21 offset:10240
  ds_read_b64_tr_b16 a[178:179], v21 offset:10752
  v_exp_f32 v85, v85
  v_exp_f32 v86, v86
  v_exp_f32 v87, v87
  v_mfma_f32_32x32x16_bf16 v[48:63], v[122:125], a[120:123], v[48:63]
  ds_read_b64_tr_b16 a[180:181], v22 offset:10240
  ds_read_b64_tr_b16 a[182:183], v22 offset:10752
  v_exp_f32 v88, v88
  v_exp_f32 v89, v89
  v_exp_f32 v90, v90
  v_smfmac_f32_32x32x32_bf16 a[16:31], v[140:143], v[80:87], v5
  global_store_dwordx4 v1, v[28:31], s[40:41] offset:0 sc1
  s_add_u32 s36, s36, 98304
  s_addc_u32 s37, s37, 0
  v_exp_f32 v91, v91
  v_exp_f32 v92, v92
  v_exp_f32 v93, v93
  v_exp_f32 v94, v94
  v_exp_f32 v95, v95
  v_exp_f32 v32, v32
  v_exp_f32 v33, v33
  v_smfmac_f32_32x32x32_bf16 a[16:31], v[144:147], v[88:95], v5
  s_waitcnt lgkmcnt(8)
  s_add_u32 m0, s94, 4096
  v_exp_f32 v34, v34
  v_exp_f32 v35, v35
  v_exp_f32 v36, v36
  v_mfma_f32_32x32x4_2b_bf16 v[64:95], v[130:131], a[124:125], 0 cbsz:1 abid:1
  v_exp_f32 v37, v37
  v_exp_f32 v38, v38
  v_exp_f32 v39, v39
  v_exp_f32 v40, v40
  v_exp_f32 v41, v41
  v_exp_f32 v42, v42
  v_exp_f32 v43, v43
  v_exp_f32 v44, v44
  v_smfmac_f32_32x32x32_bf16 a[32:47], v[132:135], v[32:39], v5
  global_load_lds_dwordx4 v20, s[36:37] offset:0
  v_exp_f32 v45, v45
  v_exp_f32 v46, v46
  v_exp_f32 v47, v47
  v_exp_f32 v48, v48
  v_exp_f32 v49, v49
  v_smfmac_f32_32x32x32_bf16 a[32:47], v[136:139], v[40:47], v5
  global_load_lds_dwordx4 v180, s[36:37] offset:1024
  v_exp_f32 v50, v50
  v_exp_f32 v51, v51
  v_exp_f32 v52, v52
  v_mfma_f32_32x32x16_bf16 v[64:79], v[126:129], a[116:119], v[64:79]
  global_load_lds_dwordx4 v181, s[36:37] offset:2048
  v_exp_f32 v53, v53
  v_exp_f32 v54, v54
  v_exp_f32 v55, v55
  v_mfma_f32_32x32x16_bf16 v[80:95], v[126:129], a[120:123], v[80:95]
  global_load_lds_dwordx4 v182, s[36:37] offset:3072
  v_exp_f32 v56, v56
  v_exp_f32 v57, v57
  v_exp_f32 v58, v58
  v_smfmac_f32_32x32x32_bf16 a[48:63], v[132:135], v[48:55], v5
  ds_read_b64_tr_b16 a[184:185], v21 offset:25600
  ds_read_b64_tr_b16 a[186:187], v21 offset:26112
  v_exp_f32 v59, v59
  v_exp_f32 v60, v60
  v_exp_f32 v61, v61
  v_exp_f32 v62, v62
  v_exp_f32 v63, v63
  v_exp_f32 v64, v64
  v_exp_f32 v65, v65
  v_smfmac_f32_32x32x32_bf16 a[48:63], v[136:139], v[56:63], v5
  ds_read_b64_tr_b16 a[188:189], v22 offset:25600
  ds_read_b64_tr_b16 a[190:191], v22 offset:26112
  v_exp_f32 v66, v66
  v_exp_f32 v67, v67
  v_exp_f32 v68, v68
  v_mfma_f32_32x32x4_2b_bf16 v[32:63], v[130:131], a[134:135], 0 cbsz:1 abid:0
  v_exp_f32 v69, v69
  v_exp_f32 v70, v70
  v_exp_f32 v71, v71
  v_exp_f32 v72, v72
  v_exp_f32 v73, v73
  v_exp_f32 v74, v74
  v_exp_f32 v75, v75
  v_exp_f32 v76, v76
  v_smfmac_f32_32x32x32_bf16 a[32:47], v[140:143], v[64:71], v5
  ds_read_b64_tr_b16 a[192:193], v21 offset:27648
  ds_read_b64_tr_b16 a[194:195], v21 offset:28160
  v_exp_f32 v77, v77
  v_exp_f32 v78, v78
  v_exp_f32 v79, v79
  v_exp_f32 v80, v80
  v_exp_f32 v81, v81
  v_smfmac_f32_32x32x32_bf16 a[32:47], v[144:147], v[72:79], v5
  ds_read_b64_tr_b16 a[196:197], v22 offset:27648
  ds_read_b64_tr_b16 a[198:199], v22 offset:28160
  v_exp_f32 v82, v82
  v_exp_f32 v83, v83
  v_exp_f32 v84, v84
  v_mfma_f32_32x32x16_bf16 v[32:47], v[122:125], a[126:129], v[32:47]
  s_mov_b32 s58, 2621440
  v_exp_f32 v85, v85
  v_exp_f32 v86, v86
  v_exp_f32 v87, v87
  v_mfma_f32_32x32x16_bf16 v[48:63], v[122:125], a[130:133], v[48:63]
  s_mov_b32 s59, 0x20000
  v_exp_f32 v88, v88
  v_exp_f32 v89, v89
  v_exp_f32 v90, v90
  v_smfmac_f32_32x32x32_bf16 a[48:63], v[140:143], v[80:87], v5
  global_store_dwordx4 v1, v[28:31], s[40:41] offset:1024 sc1
  s_cmp_ge_u32 s5, 4
  s_cselect_b64 s[36:37], s[44:45], s[42:43]
  v_exp_f32 v91, v91
  v_exp_f32 v92, v92
  v_exp_f32 v93, v93
  v_exp_f32 v94, v94
  v_exp_f32 v95, v95
  v_exp_f32 v32, v32
  v_exp_f32 v33, v33
  v_smfmac_f32_32x32x32_bf16 a[48:63], v[144:147], v[88:95], v5
  s_add_u32 s36, s36, 786432
  s_addc_u32 s37, s37, 0
  v_exp_f32 v34, v34
  v_exp_f32 v35, v35
  v_exp_f32 v36, v36
  v_mfma_f32_32x32x4_2b_bf16 v[64:95], v[130:131], a[134:135], 0 cbsz:1 abid:1
  v_exp_f32 v37, v37
  v_exp_f32 v38, v38
  v_exp_f32 v39, v39
  v_exp_f32 v40, v40
  v_exp_f32 v41, v41
  v_exp_f32 v42, v42
  v_exp_f32 v43, v43
  v_exp_f32 v44, v44
  v_smfmac_f32_32x32x32_bf16 a[64:79], v[132:135], v[32:39], v5
  s_waitcnt lgkmcnt(8)
  s_add_u32 m0, s94, 8192
  v_exp_f32 v45, v45
  v_exp_f32 v46, v46
  v_exp_f32 v47, v47
  v_exp_f32 v48, v48
  v_exp_f32 v49, v49
  v_smfmac_f32_32x32x32_bf16 a[64:79], v[136:139], v[40:47], v5
  global_load_lds_dwordx4 v20, s[36:37] offset:0
  v_exp_f32 v50, v50
  v_exp_f32 v51, v51
  v_exp_f32 v52, v52
  v_mfma_f32_32x32x16_bf16 v[64:79], v[126:129], a[126:129], v[64:79]
  global_load_lds_dwordx4 v180, s[36:37] offset:1024
  v_exp_f32 v53, v53
  v_exp_f32 v54, v54
  v_exp_f32 v55, v55
  v_mfma_f32_32x32x16_bf16 v[80:95], v[126:129], a[130:133], v[80:95]
  global_load_lds_dwordx4 v181, s[36:37] offset:2048
  v_exp_f32 v56, v56
  v_exp_f32 v57, v57
  v_exp_f32 v58, v58
  v_smfmac_f32_32x32x32_bf16 a[80:95], v[132:135], v[48:55], v5
  global_load_lds_dwordx4 v182, s[36:37] offset:3072
  v_exp_f32 v59, v59
  v_exp_f32 v60, v60
  v_exp_f32 v61, v61
  v_exp_f32 v62, v62
  v_exp_f32 v63, v63
  v_exp_f32 v64, v64
  v_exp_f32 v65, v65
  v_smfmac_f32_32x32x32_bf16 a[80:95], v[136:139], v[56:63], v5
  s_waitcnt vmcnt(29)
  ds_read_b64_tr_b16 a[200:201], v21 offset:31744
  ds_read_b64_tr_b16 a[202:203], v21 offset:32256
  v_exp_f32 v66, v66
  v_exp_f32 v67, v67
  v_exp_f32 v68, v68
  v_mfma_f32_32x32x4_2b_bf16 v[32:63], v[130:131], a[104:105], 0 cbsz:1 abid:0
  v_exp_f32 v69, v69
  v_exp_f32 v70, v70
  v_exp_f32 v71, v71
  v_exp_f32 v72, v72
  v_exp_f32 v73, v73
  v_exp_f32 v74, v74
  v_exp_f32 v75, v75
  v_exp_f32 v76, v76
  v_smfmac_f32_32x32x32_bf16 a[64:79], v[140:143], v[64:71], v5
  ds_read_b64_tr_b16 a[204:205], v22 offset:31744
  ds_read_b64_tr_b16 a[206:207], v22 offset:32256
  v_exp_f32 v77, v77
  v_exp_f32 v78, v78
  v_exp_f32 v79, v79
  v_exp_f32 v80, v80
  v_exp_f32 v81, v81
  v_smfmac_f32_32x32x32_bf16 a[64:79], v[144:147], v[72:79], v5
  s_waitcnt vmcnt(27)
  ds_read_b64_tr_b16 a[208:209], v21 offset:33792
  ds_read_b64_tr_b16 a[210:211], v21 offset:34304
  v_exp_f32 v82, v82
  v_exp_f32 v83, v83
  v_exp_f32 v84, v84
  v_mfma_f32_32x32x16_bf16 v[32:47], v[122:125], a[96:99], v[32:47]
  ds_read_b64_tr_b16 a[212:213], v22 offset:33792
  ds_read_b64_tr_b16 a[214:215], v22 offset:34304
  v_exp_f32 v85, v85
  v_exp_f32 v86, v86
  v_exp_f32 v87, v87
  v_mfma_f32_32x32x16_bf16 v[48:63], v[122:125], a[100:103], v[48:63]
  s_add_u32 s11, s5, 7
  v_exp_f32 v88, v88
  v_exp_f32 v89, v89
  v_exp_f32 v90, v90
  v_smfmac_f32_32x32x32_bf16 a[80:95], v[140:143], v[80:87], v5
  global_store_dwordx4 v1, v[28:31], s[40:41] offset:2048 sc1
  s_add_u32 s36, s36, 98304
  s_addc_u32 s37, s37, 0
  v_exp_f32 v91, v91
  v_exp_f32 v92, v92
  v_exp_f32 v93, v93
  v_exp_f32 v94, v94
  v_exp_f32 v95, v95
  v_exp_f32 v32, v32
  v_exp_f32 v33, v33
  v_smfmac_f32_32x32x32_bf16 a[80:95], v[144:147], v[88:95], v5
  s_waitcnt lgkmcnt(8)
  s_add_u32 m0, s94, 25600
  v_exp_f32 v34, v34
  v_exp_f32 v35, v35
  v_exp_f32 v36, v36
  v_mfma_f32_32x32x4_2b_bf16 v[64:95], v[130:131], a[104:105], 0 cbsz:1 abid:1
  v_exp_f32 v37, v37
  v_exp_f32 v38, v38
  v_exp_f32 v39, v39
  v_exp_f32 v40, v40
  v_exp_f32 v41, v41
  v_exp_f32 v42, v42
  v_exp_f32 v43, v43
  v_exp_f32 v44, v44
  v_smfmac_f32_32x32x32_bf16 v[148:163], v[132:135], v[32:39], v5
  global_load_lds_dwordx4 v20, s[36:37] offset:0
  v_exp_f32 v45, v45
  v_exp_f32 v46, v46
  v_exp_f32 v47, v47
  v_exp_f32 v48, v48
  v_exp_f32 v49, v49
  v_smfmac_f32_32x32x32_bf16 v[148:163], v[136:139], v[40:47], v5
  global_load_lds_dwordx4 v180, s[36:37] offset:1024
  v_exp_f32 v50, v50
  v_exp_f32 v51, v51
  v_exp_f32 v52, v52
  v_mfma_f32_32x32x16_bf16 v[64:79], v[126:129], a[96:99], v[64:79]
  global_load_lds_dwordx4 v181, s[36:37] offset:2048
  v_exp_f32 v53, v53
  v_exp_f32 v54, v54
  v_exp_f32 v55, v55
  v_mfma_f32_32x32x16_bf16 v[80:95], v[126:129], a[100:103], v[80:95]
  global_load_lds_dwordx4 v182, s[36:37] offset:3072
  v_exp_f32 v56, v56
  v_exp_f32 v57, v57
  v_exp_f32 v58, v58
  v_smfmac_f32_32x32x32_bf16 v[164:179], v[132:135], v[48:55], v5
  s_waitcnt vmcnt(15)
  v_max3_u32 v27, v96, v100, v104
  v_max3_u32 v27, v27, v106, v110
  v_max3_u32 v27, v27, v114, v118
  v_cmp_eq_u32 vcc, -1, v27
  v_exp_f32 v59, v59
  v_exp_f32 v60, v60
  v_exp_f32 v61, v61
  v_exp_f32 v62, v62
  v_exp_f32 v63, v63
  v_exp_f32 v64, v64
  v_exp_f32 v65, v65
  v_smfmac_f32_32x32x32_bf16 v[164:179], v[136:139], v[56:63], v5
  s_cbranch_vccnz L_rtykv4_10
L_okkv4_9:
  v_exp_f32 v66, v66
  v_exp_f32 v67, v67
  v_exp_f32 v68, v68
  v_mfma_f32_32x32x4_2b_bf16 v[32:63], v[104:105], a[114:115], 0 cbsz:1 abid:0
  v_exp_f32 v69, v69
  v_exp_f32 v70, v70
  v_exp_f32 v71, v71
  v_exp_f32 v72, v72
  v_exp_f32 v73, v73
  v_exp_f32 v74, v74
  v_exp_f32 v75, v75
  v_exp_f32 v76, v76
  v_smfmac_f32_32x32x32_bf16 v[148:163], v[140:143], v[64:71], v5
  s_add_u32 s77, s92, 20
  s_and_b32 s77, s77, 31
  v_exp_f32 v77, v77
  v_exp_f32 v78, v78
  v_exp_f32 v79, v79
  v_exp_f32 v80, v80
  v_exp_f32 v81, v81
  v_smfmac_f32_32x32x32_bf16 v[148:163], v[144:147], v[72:79], v5
  s_mul_i32 s77, s77, 6144
  v_exp_f32 v82, v82
  v_exp_f32 v83, v83
  v_exp_f32 v84, v84
  v_mfma_f32_32x32x16_bf16 v[32:47], v[96:99], a[106:109], v[32:47]
  s_and_b32 s11, s11, 7
  v_exp_f32 v85, v85
  v_exp_f32 v86, v86
  v_exp_f32 v87, v87
  v_mfma_f32_32x32x16_bf16 v[48:63], v[96:99], a[110:113], v[48:63]
  s_mul_i32 s11, s11, 196608
  v_exp_f32 v88, v88
  v_exp_f32 v89, v89
  v_exp_f32 v90, v90
  v_smfmac_f32_32x32x32_bf16 v[164:179], v[140:143], v[80:87], v5
  s_add_u32 s14, s28, s77
  s_addc_u32 s15, s29, 0
  v_exp_f32 v91, v91
  v_exp_f32 v92, v92
  v_exp_f32 v93, v93
  v_exp_f32 v94, v94
  v_exp_f32 v95, v95
  v_exp_f32 v32, v32
  v_exp_f32 v33, v33
  v_smfmac_f32_32x32x32_bf16 v[164:179], v[144:147], v[88:95], v5
  global_load_dwordx2 v[130:131], v4, s[14:15] offset:2048 sc1
  v_exp_f32 v34, v34
  v_exp_f32 v35, v35
  v_exp_f32 v36, v36
  v_mfma_f32_32x32x4_2b_bf16 v[64:95], v[104:105], a[114:115], 0 cbsz:1 abid:1
  v_exp_f32 v37, v37
  v_exp_f32 v38, v38
  v_exp_f32 v39, v39
  v_exp_f32 v40, v40
  v_exp_f32 v41, v41
  v_exp_f32 v42, v42
  v_exp_f32 v43, v43
  v_exp_f32 v44, v44
  v_smfmac_f32_32x32x32_bf16 a[0:15], v[106:109], v[32:39], v5
  global_load_dwordx4 v[122:125], v1, s[14:15] offset:0 sc1
  v_exp_f32 v45, v45
  v_exp_f32 v46, v46
  v_exp_f32 v47, v47
  v_exp_f32 v48, v48
  v_exp_f32 v49, v49
  v_smfmac_f32_32x32x32_bf16 a[0:15], v[110:113], v[40:47], v5
  global_load_dwordx4 v[126:129], v1, s[14:15] offset:1024 sc1
  v_exp_f32 v50, v50
  v_exp_f32 v51, v51
  v_exp_f32 v52, v52
  v_mfma_f32_32x32x16_bf16 v[64:79], v[100:103], a[106:109], v[64:79]
  global_load_dwordx4 v[132:135], v6, s[14:15] offset:0 sc1
  v_exp_f32 v53, v53
  v_exp_f32 v54, v54
  v_exp_f32 v55, v55
  v_mfma_f32_32x32x16_bf16 v[80:95], v[100:103], a[110:113], v[80:95]
  global_load_dwordx4 v[136:139], v6, s[14:15] offset:768 sc1
  v_exp_f32 v56, v56
  v_exp_f32 v57, v57
  v_exp_f32 v58, v58
  v_smfmac_f32_32x32x32_bf16 a[16:31], v[106:109], v[48:55], v5
  global_load_dwordx4 v[140:143], v6, s[14:15] offset:1536 sc1
  v_exp_f32 v59, v59
  v_exp_f32 v60, v60
  v_exp_f32 v61, v61
  v_exp_f32 v62, v62
  v_exp_f32 v63, v63
  v_exp_f32 v64, v64
  v_exp_f32 v65, v65
  v_smfmac_f32_32x32x32_bf16 a[16:31], v[110:113], v[56:63], v5
  global_load_dwordx4 v[144:147], v6, s[14:15] offset:2304 sc1
  v_exp_f32 v66, v66
  v_exp_f32 v67, v67
  v_exp_f32 v68, v68
  v_mfma_f32_32x32x4_2b_bf16 v[32:63], v[104:105], a[124:125], 0 cbsz:1 abid:0
  v_exp_f32 v69, v69
  v_exp_f32 v70, v70
  v_exp_f32 v71, v71
  v_exp_f32 v72, v72
  v_exp_f32 v73, v73
  v_exp_f32 v74, v74
  v_exp_f32 v75, v75
  v_exp_f32 v76, v76
  v_smfmac_f32_32x32x32_bf16 a[0:15], v[114:117], v[64:71], v5
  s_cmp_ge_u32 s6, 1
  s_cselect_b64 s[38:39], s[46:47], s[100:101]
  v_exp_f32 v77, v77
  v_exp_f32 v78, v78
  v_exp_f32 v79, v79
  v_exp_f32 v80, v80
  v_exp_f32 v81, v81
  v_smfmac_f32_32x32x32_bf16 a[0:15], v[118:121], v[72:79], v5
  s_add_u32 s38, s38, 614400
  s_addc_u32 s39, s39, 0
  v_exp_f32 v82, v82
  v_exp_f32 v83, v83
  v_exp_f32 v84, v84
  v_mfma_f32_32x32x16_bf16 v[32:47], v[96:99], a[116:119], v[32:47]
  s_add_u32 m0, s94, 15360
  v_exp_f32 v85, v85
  v_exp_f32 v86, v86
  v_exp_f32 v87, v87
  v_mfma_f32_32x32x16_bf16 v[48:63], v[96:99], a[120:123], v[48:63]
  global_load_lds_dwordx4 v8, s[38:39] offset:0
  v_exp_f32 v88, v88
  v_exp_f32 v89, v89
  v_exp_f32 v90, v90
  v_smfmac_f32_32x32x32_bf16 a[16:31], v[114:117], v[80:87], v5
  global_store_dwordx4 v1, v[28:31], s[40:41] offset:3072 sc1
  global_load_lds_dwordx4 v9, s[38:39] offset:1024
  v_exp_f32 v91, v91
  v_exp_f32 v92, v92
  v_exp_f32 v93, v93
  v_exp_f32 v94, v94
  v_exp_f32 v95, v95
  v_exp_f32 v32, v32
  v_exp_f32 v33, v33
  v_smfmac_f32_32x32x32_bf16 a[16:31], v[118:121], v[88:95], v5
  global_load_lds_dwordx4 v10, s[38:39] offset:2048
  v_exp_f32 v34, v34
  v_exp_f32 v35, v35
  v_exp_f32 v36, v36
  v_mfma_f32_32x32x4_2b_bf16 v[64:95], v[104:105], a[124:125], 0 cbsz:1 abid:1
  v_exp_f32 v37, v37
  v_exp_f32 v38, v38
  v_exp_f32 v39, v39
  v_exp_f32 v40, v40
  v_exp_f32 v41, v41
  v_exp_f32 v42, v42
  v_exp_f32 v43, v43
  v_exp_f32 v44, v44
  v_smfmac_f32_32x32x32_bf16 a[32:47], v[106:109], v[32:39], v5
  global_load_lds_dwordx4 v11, s[38:39] offset:3072
  v_exp_f32 v45, v45
  v_exp_f32 v46, v46
  v_exp_f32 v47, v47
  v_exp_f32 v48, v48
  v_exp_f32 v49, v49
  v_smfmac_f32_32x32x32_bf16 a[32:47], v[110:113], v[40:47], v5
  s_add_u32 m0, s94, 19456
  v_exp_f32 v50, v50
  v_exp_f32 v51, v51
  v_exp_f32 v52, v52
  v_mfma_f32_32x32x16_bf16 v[64:79], v[100:103], a[116:119], v[64:79]
  global_load_lds_dwordx4 v12, s[38:39] offset:0
  v_exp_f32 v53, v53
  v_exp_f32 v54, v54
  v_exp_f32 v55, v55
  v_mfma_f32_32x32x16_bf16 v[80:95], v[100:103], a[120:123], v[80:95]
  ds_read_b64_tr_b16 a[216:217], v21 offset:35840
  ds_read_b64_tr_b16 a[218:219], v21 offset:36352
  v_exp_f32 v56, v56
  v_exp_f32 v57, v57
  v_exp_f32 v58, v58
  v_smfmac_f32_32x32x32_bf16 a[48:63], v[106:109], v[48:55], v5
  ds_read_b64_tr_b16 a[220:221], v22 offset:35840
  ds_read_b64_tr_b16 a[222:223], v22 offset:36352
  v_exp_f32 v59, v59
  v_exp_f32 v60, v60
  v_exp_f32 v61, v61
  v_exp_f32 v62, v62
  v_exp_f32 v63, v63
  v_exp_f32 v64, v64
  v_exp_f32 v65, v65
  v_smfmac_f32_32x32x32_bf16 a[48:63], v[110:113], v[56:63], v5
  ds_read_b64_tr_b16 a[224:225], v21 offset:37888
  ds_read_b64_tr_b16 a[226:227], v21 offset:38400
  v_exp_f32 v66, v66
  v_exp_f32 v67, v67
  v_exp_f32 v68, v68
  v_mfma_f32_32x32x4_2b_bf16 v[32:63], v[104:105], a[134:135], 0 cbsz:1 abid:0
  v_exp_f32 v69, v69
  v_exp_f32 v70, v70
  v_exp_f32 v71, v71
  v_exp_f32 v72, v72
  v_exp_f32 v73, v73
  v_exp_f32 v74, v74
  v_exp_f32 v75, v75
  v_exp_f32 v76, v76
  v_smfmac_f32_32x32x32_bf16 a[32:47], v[114:117], v[64:71], v5
  ds_read_b64_tr_b16 a[228:229], v22 offset:37888
  ds_read_b64_tr_b16 a[230:231], v22 offset:38400
  v_exp_f32 v77, v77
  v_exp_f32 v78, v78
  v_exp_f32 v79, v79
  v_exp_f32 v80, v80
  v_exp_f32 v81, v81
  v_smfmac_f32_32x32x32_bf16 a[32:47], v[118:121], v[72:79], v5
  s_cmp_ge_u32 s5, 3
  s_cselect_b64 s[36:37], s[44:45], s[42:43]
  v_exp_f32 v82, v82
  v_exp_f32 v83, v83
  v_exp_f32 v84, v84
  v_mfma_f32_32x32x16_bf16 v[32:47], v[96:99], a[126:129], v[32:47]
  s_add_u32 s11, s11, s93
  v_exp_f32 v85, v85
  v_exp_f32 v86, v86
  v_exp_f32 v87, v87
  v_mfma_f32_32x32x16_bf16 v[48:63], v[96:99], a[130:133], v[48:63]
  v_exp_f32 v88, v88
  v_exp_f32 v89, v89
  v_exp_f32 v90, v90
  v_smfmac_f32_32x32x32_bf16 a[48:63], v[114:117], v[80:87], v5
  s_add_u32 s36, s36, 983040
  s_addc_u32 s37, s37, 0
  v_exp_f32 v91, v91
  v_exp_f32 v92, v92
  v_exp_f32 v93, v93
  v_exp_f32 v94, v94
  v_exp_f32 v95, v95
  v_exp_f32 v32, v32
  v_exp_f32 v33, v33
  v_smfmac_f32_32x32x32_bf16 a[48:63], v[118:121], v[88:95], v5
  s_waitcnt lgkmcnt(8)
  s_add_u32 m0, s94, 31744
  v_exp_f32 v34, v34
  v_exp_f32 v35, v35
  v_exp_f32 v36, v36
  v_mfma_f32_32x32x4_2b_bf16 v[64:95], v[104:105], a[134:135], 0 cbsz:1 abid:1
  v_exp_f32 v37, v37
  v_exp_f32 v38, v38
  v_exp_f32 v39, v39
  v_exp_f32 v40, v40
  v_exp_f32 v41, v41
  v_exp_f32 v42, v42
  v_exp_f32 v43, v43
  v_exp_f32 v44, v44
  v_smfmac_f32_32x32x32_bf16 a[64:79], v[106:109], v[32:39], v5
  global_load_lds_dwordx4 v20, s[36:37] offset:0
  v_lshlrev_b32 v27, 12, v0
  s_add_u32 s71, s78, 0
  s_mov_b64 exec, 0xfff
  buffer_load_dword v183, v27, s[52:55], s71 offen
  s_mov_b64 exec, -1
  v_exp_f32 v45, v45
  v_exp_f32 v46, v46
  v_exp_f32 v47, v47
  v_exp_f32 v48, v48
  v_exp_f32 v49, v49
  v_smfmac_f32_32x32x32_bf16 a[64:79], v[110:113], v[40:47], v5
  global_load_lds_dwordx4 v180, s[36:37] offset:1024
  v_exp_f32 v50, v50
  v_exp_f32 v51, v51
  v_exp_f32 v52, v52
  v_mfma_f32_32x32x16_bf16 v[64:79], v[100:103], a[126:129], v[64:79]
  global_load_lds_dwordx4 v181, s[36:37] offset:2048
  v_exp_f32 v53, v53
  v_exp_f32 v54, v54
  v_exp_f32 v55, v55
  v_mfma_f32_32x32x16_bf16 v[80:95], v[100:103], a[130:133], v[80:95]
  global_load_lds_dwordx4 v182, s[36:37] offset:3072
  v_exp_f32 v56, v56
  v_exp_f32 v57, v57
  v_exp_f32 v58, v58
  v_smfmac_f32_32x32x32_bf16 a[80:95], v[106:109], v[48:55], v5
  ds_read_b64_tr_b16 a[232:233], v21 offset:0
  ds_read_b64_tr_b16 a[234:235], v21 offset:512
  v_exp_f32 v59, v59
  v_exp_f32 v60, v60
  v_exp_f32 v61, v61
  v_exp_f32 v62, v62
  v_exp_f32 v63, v63
  v_exp_f32 v64, v64
  v_exp_f32 v65, v65
  v_smfmac_f32_32x32x32_bf16 a[80:95], v[110:113], v[56:63], v5
  ds_read_b64_tr_b16 a[236:237], v22 offset:0
  ds_read_b64_tr_b16 a[238:239], v22 offset:512
  v_exp_f32 v66, v66
  v_exp_f32 v67, v67
  v_exp_f32 v68, v68
  v_mfma_f32_32x32x4_2b_bf16 v[32:63], v[104:105], a[104:105], 0 cbsz:1 abid:0
  v_exp_f32 v69, v69
  v_exp_f32 v70, v70
  v_exp_f32 v71, v71
  v_exp_f32 v72, v72
  v_exp_f32 v73, v73
  v_exp_f32 v74, v74
  v_exp_f32 v75, v75
  v_exp_f32 v76, v76
  v_smfmac_f32_32x32x32_bf16 a[64:79], v[114:117], v[64:71], v5
  ds_read_b64_tr_b16 a[240:241], v21 offset:2048
  ds_read_b64_tr_b16 a[242:243], v21 offset:2560
  v_exp_f32 v77, v77
  v_exp_f32 v78, v78
  v_exp_f32 v79, v79
  v_exp_f32 v80, v80
  v_exp_f32 v81, v81
  v_smfmac_f32_32x32x32_bf16 a[64:79], v[118:121], v[72:79], v5
  ds_read_b64_tr_b16 a[244:245], v22 offset:2048
  ds_read_b64_tr_b16 a[246:247], v22 offset:2560
  v_exp_f32 v82, v82
  v_exp_f32 v83, v83
  v_exp_f32 v84, v84
  v_mfma_f32_32x32x16_bf16 v[32:47], v[96:99], a[96:99], v[32:47]
  v_exp_f32 v85, v85
  v_exp_f32 v86, v86
  v_exp_f32 v87, v87
  v_mfma_f32_32x32x16_bf16 v[48:63], v[96:99], a[100:103], v[48:63]
  v_exp_f32 v88, v88
  v_exp_f32 v89, v89
  v_exp_f32 v90, v90
  v_smfmac_f32_32x32x32_bf16 a[80:95], v[114:117], v[80:87], v5
  s_add_u32 s36, s36, 98304
  s_addc_u32 s37, s37, 0
  v_exp_f32 v91, v91
  v_exp_f32 v92, v92
  v_exp_f32 v93, v93
  v_exp_f32 v94, v94
  v_exp_f32 v95, v95
  v_exp_f32 v32, v32
  v_exp_f32 v33, v33
  v_smfmac_f32_32x32x32_bf16 a[80:95], v[118:121], v[88:95], v5
  s_waitcnt lgkmcnt(8)
  s_add_u32 m0, s94, 35840
  v_exp_f32 v34, v34
  v_exp_f32 v35, v35
  v_exp_f32 v36, v36
  v_mfma_f32_32x32x4_2b_bf16 v[64:95], v[104:105], a[104:105], 0 cbsz:1 abid:1
  v_exp_f32 v37, v37
  v_exp_f32 v38, v38
  v_exp_f32 v39, v39
  v_exp_f32 v40, v40
  v_exp_f32 v41, v41
  v_exp_f32 v42, v42
  v_exp_f32 v43, v43
  v_exp_f32 v44, v44
  v_smfmac_f32_32x32x32_bf16 v[148:163], v[106:109], v[32:39], v5
  global_load_lds_dwordx4 v20, s[36:37] offset:0
  v_exp_f32 v45, v45
  v_exp_f32 v46, v46
  v_exp_f32 v47, v47
  v_exp_f32 v48, v48
  v_exp_f32 v49, v49
  v_smfmac_f32_32x32x32_bf16 v[148:163], v[110:113], v[40:47], v5
  global_load_lds_dwordx4 v180, s[36:37] offset:1024
  v_exp_f32 v50, v50
  v_exp_f32 v51, v51
  v_exp_f32 v52, v52
  v_mfma_f32_32x32x16_bf16 v[64:79], v[100:103], a[96:99], v[64:79]
  global_load_lds_dwordx4 v181, s[36:37] offset:2048
  v_exp_f32 v53, v53
  v_exp_f32 v54, v54
  v_exp_f32 v55, v55
  v_mfma_f32_32x32x16_bf16 v[80:95], v[100:103], a[100:103], v[80:95]
  global_load_lds_dwordx4 v182, s[36:37] offset:3072
  v_exp_f32 v56, v56
  v_exp_f32 v57, v57
  v_exp_f32 v58, v58
  v_smfmac_f32_32x32x32_bf16 v[164:179], v[106:109], v[48:55], v5
  s_waitcnt vmcnt(15)
  v_max3_u32 v27, v122, v126, v130
  v_max3_u32 v27, v27, v132, v136
  v_max3_u32 v27, v27, v140, v144
  v_cmp_eq_u32 vcc, -1, v27
  v_exp_f32 v59, v59
  v_exp_f32 v60, v60
  v_exp_f32 v61, v61
  v_exp_f32 v62, v62
  v_exp_f32 v63, v63
  v_exp_f32 v64, v64
  v_exp_f32 v65, v65
  v_smfmac_f32_32x32x32_bf16 v[164:179], v[110:113], v[56:63], v5
  s_cbranch_vccnz L_rtykv5_12
L_okkv5_11:
  v_exp_f32 v66, v66
  v_exp_f32 v67, v67
  v_exp_f32 v68, v68
  v_mfma_f32_32x32x4_2b_bf16 v[32:63], v[130:131], a[114:115], 0 cbsz:1 abid:0
  v_exp_f32 v69, v69
  v_exp_f32 v70, v70
  v_exp_f32 v71, v71
  v_exp_f32 v72, v72
  v_exp_f32 v73, v73
  v_exp_f32 v74, v74
  v_exp_f32 v75, v75
  v_exp_f32 v76, v76
  v_smfmac_f32_32x32x32_bf16 v[148:163], v[114:117], v[64:71], v5
  s_add_u32 s77, s92, 24
  s_and_b32 s77, s77, 31
  v_exp_f32 v77, v77
  v_exp_f32 v78, v78
  v_exp_f32 v79, v79
  v_exp_f32 v80, v80
  v_exp_f32 v81, v81
  v_smfmac_f32_32x32x32_bf16 v[148:163], v[118:121], v[72:79], v5
  s_mul_i32 s77, s77, 6144
  v_exp_f32 v82, v82
  v_exp_f32 v83, v83
  v_exp_f32 v84, v84
  v_mfma_f32_32x32x16_bf16 v[32:47], v[122:125], a[106:109], v[32:47]
  v_exp_f32 v85, v85
  v_exp_f32 v86, v86
  v_exp_f32 v87, v87
  v_mfma_f32_32x32x16_bf16 v[48:63], v[122:125], a[110:113], v[48:63]
  v_exp_f32 v88, v88
  v_exp_f32 v89, v89
  v_exp_f32 v90, v90
  v_smfmac_f32_32x32x32_bf16 v[164:179], v[114:117], v[80:87], v5
  s_add_u32 s14, s28, s77
  s_addc_u32 s15, s29, 0
  v_exp_f32 v91, v91
  v_exp_f32 v92, v92
  v_exp_f32 v93, v93
  v_exp_f32 v94, v94
  v_exp_f32 v95, v95
  v_exp_f32 v32, v32
  v_exp_f32 v33, v33
  v_smfmac_f32_32x32x32_bf16 v[164:179], v[118:121], v[88:95], v5
  global_load_dwordx2 v[104:105], v4, s[14:15] offset:2048 sc1
  v_exp_f32 v34, v34
  v_exp_f32 v35, v35
  v_exp_f32 v36, v36
  v_mfma_f32_32x32x4_2b_bf16 v[64:95], v[130:131], a[114:115], 0 cbsz:1 abid:1
  v_exp_f32 v37, v37
  v_exp_f32 v38, v38
  v_exp_f32 v39, v39
  v_exp_f32 v40, v40
  v_exp_f32 v41, v41
  v_exp_f32 v42, v42
  v_exp_f32 v43, v43
  v_exp_f32 v44, v44
  v_smfmac_f32_32x32x32_bf16 a[0:15], v[132:135], v[32:39], v5
  global_load_dwordx4 v[96:99], v1, s[14:15] offset:0 sc1
  v_exp_f32 v45, v45
  v_exp_f32 v46, v46
  v_exp_f32 v47, v47
  v_exp_f32 v48, v48
  v_exp_f32 v49, v49
  v_smfmac_f32_32x32x32_bf16 a[0:15], v[136:139], v[40:47], v5
  global_load_dwordx4 v[100:103], v1, s[14:15] offset:1024 sc1
  v_exp_f32 v50, v50
  v_exp_f32 v51, v51
  v_exp_f32 v52, v52
  v_mfma_f32_32x32x16_bf16 v[64:79], v[126:129], a[106:109], v[64:79]
  global_load_dwordx4 v[106:109], v6, s[14:15] offset:0 sc1
  v_exp_f32 v53, v53
  v_exp_f32 v54, v54
  v_exp_f32 v55, v55
  v_mfma_f32_32x32x16_bf16 v[80:95], v[126:129], a[110:113], v[80:95]
  global_load_dwordx4 v[110:113], v6, s[14:15] offset:768 sc1
  v_exp_f32 v56, v56
  v_exp_f32 v57, v57
  v_exp_f32 v58, v58
  v_smfmac_f32_32x32x32_bf16 a[16:31], v[132:135], v[48:55], v5
  global_load_dwordx4 v[114:117], v6, s[14:15] offset:1536 sc1
  v_exp_f32 v59, v59
  v_exp_f32 v60, v60
  v_exp_f32 v61, v61
  v_exp_f32 v62, v62
  v_exp_f32 v63, v63
  v_exp_f32 v64, v64
  v_exp_f32 v65, v65
  v_smfmac_f32_32x32x32_bf16 a[16:31], v[136:139], v[56:63], v5
  global_load_dwordx4 v[118:121], v6, s[14:15] offset:2304 sc1
  v_exp_f32 v66, v66
  v_exp_f32 v67, v67
  v_exp_f32 v68, v68
  v_mfma_f32_32x32x4_2b_bf16 v[32:63], v[130:131], a[124:125], 0 cbsz:1 abid:0
  v_exp_f32 v69, v69
  v_exp_f32 v70, v70
  v_exp_f32 v71, v71
  v_exp_f32 v72, v72
  v_exp_f32 v73, v73
  v_exp_f32 v74, v74
  v_exp_f32 v75, v75
  v_exp_f32 v76, v76
  v_smfmac_f32_32x32x32_bf16 a[0:15], v[140:143], v[64:71], v5
  s_add_u32 s38, s12, s79
  s_addc_u32 s39, s13, 0
  v_lshlrev_b32 v27, 12, v0
  s_add_u32 s71, s78, 49152
  s_mov_b64 exec, 0xfff
  buffer_load_dword v183, v27, s[52:55], s71 offen
  s_mov_b64 exec, -1
  v_exp_f32 v77, v77
  v_exp_f32 v78, v78
  v_exp_f32 v79, v79
  v_exp_f32 v80, v80
  v_exp_f32 v81, v81
  v_smfmac_f32_32x32x32_bf16 a[0:15], v[144:147], v[72:79], v5
  s_add_u32 m0, s94, 20480
  v_exp_f32 v82, v82
  v_exp_f32 v83, v83
  v_exp_f32 v84, v84
  v_mfma_f32_32x32x16_bf16 v[32:47], v[122:125], a[116:119], v[32:47]
  global_load_lds_dwordx4 v13, s[38:39] offset:0
  v_exp_f32 v85, v85
  v_exp_f32 v86, v86
  v_exp_f32 v87, v87
  v_mfma_f32_32x32x16_bf16 v[48:63], v[122:125], a[120:123], v[48:63]
  global_load_lds_dwordx4 v14, s[38:39] offset:1024
  v_exp_f32 v88, v88
  v_exp_f32 v89, v89
  v_exp_f32 v90, v90
  v_smfmac_f32_32x32x32_bf16 a[16:31], v[140:143], v[80:87], v5
  global_load_lds_dwordx4 v15, s[38:39] offset:2048
  v_exp_f32 v91, v91
  v_exp_f32 v92, v92
  v_exp_f32 v93, v93
  v_exp_f32 v94, v94
  v_exp_f32 v95, v95
  v_exp_f32 v32, v32
  v_exp_f32 v33, v33
  v_smfmac_f32_32x32x32_bf16 a[16:31], v[144:147], v[88:95], v5
  global_load_lds_dwordx4 v16, s[38:39] offset:3072
  v_exp_f32 v34, v34
  v_exp_f32 v35, v35
  v_exp_f32 v36, v36
  v_mfma_f32_32x32x4_2b_bf16 v[64:95], v[130:131], a[124:125], 0 cbsz:1 abid:1
  v_exp_f32 v37, v37
  v_exp_f32 v38, v38
  v_exp_f32 v39, v39
  v_exp_f32 v40, v40
  v_exp_f32 v41, v41
  v_exp_f32 v42, v42
  v_exp_f32 v43, v43
  v_exp_f32 v44, v44
  v_smfmac_f32_32x32x32_bf16 a[32:47], v[132:135], v[32:39], v5
  s_add_u32 m0, s94, 24576
  v_exp_f32 v45, v45
  v_exp_f32 v46, v46
  v_exp_f32 v47, v47
  v_exp_f32 v48, v48
  v_exp_f32 v49, v49
  v_smfmac_f32_32x32x32_bf16 a[32:47], v[136:139], v[40:47], v5
  global_load_lds_dwordx4 v17, s[38:39] offset:0
  v_exp_f32 v50, v50
  v_exp_f32 v51, v51
  v_exp_f32 v52, v52
  v_mfma_f32_32x32x16_bf16 v[64:79], v[126:129], a[116:119], v[64:79]
  ds_read_b64_tr_b16 a[248:249], v21 offset:4096
  ds_read_b64_tr_b16 a[250:251], v21 offset:4608
  v_exp_f32 v53, v53
  v_exp_f32 v54, v54
  v_exp_f32 v55, v55
  v_mfma_f32_32x32x16_bf16 v[80:95], v[126:129], a[120:123], v[80:95]
  ds_read_b64_tr_b16 a[252:253], v22 offset:4096
  ds_read_b64_tr_b16 a[254:255], v22 offset:4608
  v_exp_f32 v56, v56
  v_exp_f32 v57, v57
  v_exp_f32 v58, v58
  v_smfmac_f32_32x32x32_bf16 a[48:63], v[132:135], v[48:55], v5
  ds_read_b64_tr_b16 v[184:185], v21 offset:6144
  ds_read_b64_tr_b16 v[186:187], v21 offset:6656
  v_exp_f32 v59, v59
  v_exp_f32 v60, v60
  v_exp_f32 v61, v61
  v_exp_f32 v62, v62
  v_exp_f32 v63, v63
  v_exp_f32 v64, v64
  v_exp_f32 v65, v65
  v_smfmac_f32_32x32x32_bf16 a[48:63], v[136:139], v[56:63], v5
  ds_read_b64_tr_b16 v[188:189], v22 offset:6144
  ds_read_b64_tr_b16 v[190:191], v22 offset:6656
  v_exp_f32 v66, v66
  v_exp_f32 v67, v67
  v_exp_f32 v68, v68
  v_mfma_f32_32x32x4_2b_bf16 v[32:63], v[130:131], a[134:135], 0 cbsz:1 abid:0
  v_exp_f32 v69, v69
  v_exp_f32 v70, v70
  v_exp_f32 v71, v71
  v_exp_f32 v72, v72
  v_exp_f32 v73, v73
  v_exp_f32 v74, v74
  v_exp_f32 v75, v75
  v_exp_f32 v76, v76
  v_smfmac_f32_32x32x32_bf16 a[32:47], v[140:143], v[64:71], v5
  ds_read_b64_tr_b16 v[192:193], v21 offset:8192
  ds_read_b64_tr_b16 v[194:195], v21 offset:8704
  v_exp_f32 v77, v77
  v_exp_f32 v78, v78
  v_exp_f32 v79, v79
  v_exp_f32 v80, v80
  v_exp_f32 v81, v81
  v_smfmac_f32_32x32x32_bf16 a[32:47], v[144:147], v[72:79], v5
  ds_read_b64_tr_b16 v[196:197], v22 offset:8192
  ds_read_b64_tr_b16 v[198:199], v22 offset:8704
  v_exp_f32 v82, v82
  v_exp_f32 v83, v83
  v_exp_f32 v84, v84
  v_mfma_f32_32x32x16_bf16 v[32:47], v[122:125], a[126:129], v[32:47]
  ds_read_b64_tr_b16 v[200:201], v21 offset:10240
  ds_read_b64_tr_b16 v[202:203], v21 offset:10752
  v_exp_f32 v85, v85
  v_exp_f32 v86, v86
  v_exp_f32 v87, v87
  v_mfma_f32_32x32x16_bf16 v[48:63], v[122:125], a[130:133], v[48:63]
  ds_read_b64_tr_b16 v[204:205], v22 offset:10240
  ds_read_b64_tr_b16 v[206:207], v22 offset:10752
  v_exp_f32 v88, v88
  v_exp_f32 v89, v89
  v_exp_f32 v90, v90
  v_smfmac_f32_32x32x32_bf16 a[48:63], v[140:143], v[80:87], v5
  s_cmp_ge_u32 s6, 4
  s_cselect_b64 s[38:39], s[46:47], s[100:101]
  v_exp_f32 v91, v91
  v_exp_f32 v92, v92
  v_exp_f32 v93, v93
  v_exp_f32 v94, v94
  v_exp_f32 v95, v95
  v_exp_f32 v32, v32
  v_exp_f32 v33, v33
  v_smfmac_f32_32x32x32_bf16 a[48:63], v[144:147], v[88:95], v5
  s_add_u32 s38, s38, 0
  s_addc_u32 s39, s39, 0
  v_exp_f32 v34, v34
  v_exp_f32 v35, v35
  v_exp_f32 v36, v36
  v_mfma_f32_32x32x4_2b_bf16 v[64:95], v[130:131], a[134:135], 0 cbsz:1 abid:1
  v_exp_f32 v37, v37
  v_exp_f32 v38, v38
  v_exp_f32 v39, v39
  v_exp_f32 v40, v40
  v_exp_f32 v41, v41
  v_exp_f32 v42, v42
  v_exp_f32 v43, v43
  v_exp_f32 v44, v44
  v_smfmac_f32_32x32x32_bf16 a[64:79], v[132:135], v[32:39], v5
  s_waitcnt lgkmcnt(8)
  s_add_u32 m0, s94, 0
  v_lshlrev_b32 v27, 12, v0
  s_add_u32 s71, s78, 98304
  s_mov_b64 exec, 0xfff
  buffer_load_dword v183, v27, s[52:55], s71 offen
  s_mov_b64 exec, -1
  v_exp_f32 v45, v45
  v_exp_f32 v46, v46
  v_exp_f32 v47, v47
  v_exp_f32 v48, v48
  v_exp_f32 v49, v49
  v_smfmac_f32_32x32x32_bf16 a[64:79], v[136:139], v[40:47], v5
  global_load_lds_dwordx4 v8, s[38:39] offset:0
  v_exp_f32 v50, v50
  v_exp_f32 v51, v51
  v_exp_f32 v52, v52
  v_mfma_f32_32x32x16_bf16 v[64:79], v[126:129], a[126:129], v[64:79]
  global_load_lds_dwordx4 v9, s[38:39] offset:1024
  v_exp_f32 v53, v53
  v_exp_f32 v54, v54
  v_exp_f32 v55, v55
  v_mfma_f32_32x32x16_bf16 v[80:95], v[126:129], a[130:133], v[80:95]
  global_load_lds_dwordx4 v10, s[38:39] offset:2048
  v_exp_f32 v56, v56
  v_exp_f32 v57, v57
  v_exp_f32 v58, v58
  v_smfmac_f32_32x32x32_bf16 a[80:95], v[132:135], v[48:55], v5
  global_load_lds_dwordx4 v11, s[38:39] offset:3072
  v_exp_f32 v59, v59
  v_exp_f32 v60, v60
  v_exp_f32 v61, v61
  v_exp_f32 v62, v62
  v_exp_f32 v63, v63
  v_exp_f32 v64, v64
  v_exp_f32 v65, v65
  v_smfmac_f32_32x32x32_bf16 a[80:95], v[136:139], v[56:63], v5
  s_add_u32 m0, s94, 4096
  v_exp_f32 v66, v66
  v_exp_f32 v67, v67
  v_exp_f32 v68, v68
  v_mfma_f32_32x32x4_2b_bf16 v[32:63], v[130:131], a[104:105], 0 cbsz:1 abid:0
  v_exp_f32 v69, v69
  v_exp_f32 v70, v70
  v_exp_f32 v71, v71
  v_exp_f32 v72, v72
  v_exp_f32 v73, v73
  v_exp_f32 v74, v74
  v_exp_f32 v75, v75
  v_exp_f32 v76, v76
  v_smfmac_f32_32x32x32_bf16 a[64:79], v[140:143], v[64:71], v5
  global_load_lds_dwordx4 v12, s[38:39] offset:0
  v_exp_f32 v77, v77
  v_exp_f32 v78, v78
  v_exp_f32 v79, v79
  v_exp_f32 v80, v80
  v_exp_f32 v81, v81
  v_smfmac_f32_32x32x32_bf16 a[64:79], v[144:147], v[72:79], v5
  ds_read_b64_tr_b16 v[208:209], v21 offset:25600
  ds_read_b64_tr_b16 v[210:211], v21 offset:26112
  v_exp_f32 v82, v82
  v_exp_f32 v83, v83
  v_exp_f32 v84, v84
  v_mfma_f32_32x32x16_bf16 v[32:47], v[122:125], a[96:99], v[32:47]
  ds_read_b64_tr_b16 v[212:213], v22 offset:25600
  ds_read_b64_tr_b16 v[214:215], v22 offset:26112
  v_exp_f32 v85, v85
  v_exp_f32 v86, v86
  v_exp_f32 v87, v87
  v_mfma_f32_32x32x16_bf16 v[48:63], v[122:125], a[100:103], v[48:63]
  ds_read_b64_tr_b16 v[216:217], v21 offset:27648
  ds_read_b64_tr_b16 v[218:219], v21 offset:28160
  v_exp_f32 v88, v88
  v_exp_f32 v89, v89
  v_exp_f32 v90, v90
  v_smfmac_f32_32x32x32_bf16 a[80:95], v[140:143], v[80:87], v5
  ds_read_b64_tr_b16 v[220:221], v22 offset:27648
  ds_read_b64_tr_b16 v[222:223], v22 offset:28160
  v_exp_f32 v91, v91
  v_exp_f32 v92, v92
  v_exp_f32 v93, v93
  v_exp_f32 v94, v94
  v_exp_f32 v95, v95
  v_exp_f32 v32, v32
  v_exp_f32 v33, v33
  v_smfmac_f32_32x32x32_bf16 a[80:95], v[144:147], v[88:95], v5
  s_waitcnt vmcnt(25)
  ds_read_b64_tr_b16 v[224:225], v21 offset:31744
  ds_read_b64_tr_b16 v[226:227], v21 offset:32256
  v_exp_f32 v34, v34
  v_exp_f32 v35, v35
  v_exp_f32 v36, v36
  v_mfma_f32_32x32x4_2b_bf16 v[64:95], v[130:131], a[104:105], 0 cbsz:1 abid:1
  v_exp_f32 v37, v37
  v_exp_f32 v38, v38
  v_exp_f32 v39, v39
  v_exp_f32 v40, v40
  v_exp_f32 v41, v41
  v_exp_f32 v42, v42
  v_exp_f32 v43, v43
  v_exp_f32 v44, v44
  v_smfmac_f32_32x32x32_bf16 v[148:163], v[132:135], v[32:39], v5
  ds_read_b64_tr_b16 v[228:229], v22 offset:31744
  ds_read_b64_tr_b16 v[230:231], v22 offset:32256
  v_exp_f32 v45, v45
  v_exp_f32 v46, v46
  v_exp_f32 v47, v47
  v_exp_f32 v48, v48
  v_exp_f32 v49, v49
  v_smfmac_f32_32x32x32_bf16 v[148:163], v[136:139], v[40:47], v5
  s_waitcnt vmcnt(23)
  ds_read_b64_tr_b16 v[232:233], v21 offset:33792
  ds_read_b64_tr_b16 v[234:235], v21 offset:34304
  v_exp_f32 v50, v50
  v_exp_f32 v51, v51
  v_exp_f32 v52, v52
  v_mfma_f32_32x32x16_bf16 v[64:79], v[126:129], a[96:99], v[64:79]
  ds_read_b64_tr_b16 v[236:237], v22 offset:33792
  ds_read_b64_tr_b16 v[238:239], v22 offset:34304
  v_exp_f32 v53, v53
  v_exp_f32 v54, v54
  v_exp_f32 v55, v55
  v_mfma_f32_32x32x16_bf16 v[80:95], v[126:129], a[100:103], v[80:95]
  v_exp_f32 v56, v56
  v_exp_f32 v57, v57
  v_exp_f32 v58, v58
  v_smfmac_f32_32x32x32_bf16 v[164:179], v[132:135], v[48:55], v5
  s_waitcnt vmcnt(12)
  v_max3_u32 v27, v96, v100, v104
  v_max3_u32 v27, v27, v106, v110
  v_max3_u32 v27, v27, v114, v118
  v_cmp_eq_u32 vcc, -1, v27
  v_exp_f32 v59, v59
  v_exp_f32 v60, v60
  v_exp_f32 v61, v61
  v_exp_f32 v62, v62
  v_exp_f32 v63, v63
  v_exp_f32 v64, v64
  v_exp_f32 v65, v65
  v_smfmac_f32_32x32x32_bf16 v[164:179], v[136:139], v[56:63], v5
  s_cbranch_vccnz L_rtykv6_14
L_okkv6_13:
  v_exp_f32 v66, v66
  v_exp_f32 v67, v67
  v_exp_f32 v68, v68
  v_mfma_f32_32x32x4_2b_bf16 v[32:63], v[104:105], a[114:115], 0 cbsz:1 abid:0
  v_exp_f32 v69, v69
  v_exp_f32 v70, v70
  v_exp_f32 v71, v71
  v_exp_f32 v72, v72
  v_exp_f32 v73, v73
  v_exp_f32 v74, v74
  v_exp_f32 v75, v75
  v_exp_f32 v76, v76
  v_smfmac_f32_32x32x32_bf16 v[148:163], v[140:143], v[64:71], v5
  s_add_u32 s77, s92, 28
  s_and_b32 s77, s77, 31
  v_exp_f32 v77, v77
  v_exp_f32 v78, v78
  v_exp_f32 v79, v79
  v_exp_f32 v80, v80
  v_exp_f32 v81, v81
  v_smfmac_f32_32x32x32_bf16 v[148:163], v[144:147], v[72:79], v5
  s_mul_i32 s77, s77, 6144
  v_exp_f32 v82, v82
  v_exp_f32 v83, v83
  v_exp_f32 v84, v84
  v_mfma_f32_32x32x16_bf16 v[32:47], v[96:99], a[106:109], v[32:47]
  v_exp_f32 v85, v85
  v_exp_f32 v86, v86
  v_exp_f32 v87, v87
  v_mfma_f32_32x32x16_bf16 v[48:63], v[96:99], a[110:113], v[48:63]
  v_exp_f32 v88, v88
  v_exp_f32 v89, v89
  v_exp_f32 v90, v90
  v_smfmac_f32_32x32x32_bf16 v[164:179], v[140:143], v[80:87], v5
  s_add_u32 s14, s28, s77
  s_addc_u32 s15, s29, 0
  v_exp_f32 v91, v91
  v_exp_f32 v92, v92
  v_exp_f32 v93, v93
  v_exp_f32 v94, v94
  v_exp_f32 v95, v95
  v_exp_f32 v32, v32
  v_exp_f32 v33, v33
  v_smfmac_f32_32x32x32_bf16 v[164:179], v[144:147], v[88:95], v5
  global_load_dwordx2 v[130:131], v4, s[14:15] offset:2048 sc1
  v_exp_f32 v34, v34
  v_exp_f32 v35, v35
  v_exp_f32 v36, v36
  v_mfma_f32_32x32x4_2b_bf16 v[64:95], v[104:105], a[114:115], 0 cbsz:1 abid:1
  v_exp_f32 v37, v37
  v_exp_f32 v38, v38
  v_exp_f32 v39, v39
  v_exp_f32 v40, v40
  v_exp_f32 v41, v41
  v_exp_f32 v42, v42
  v_exp_f32 v43, v43
  v_exp_f32 v44, v44
  v_smfmac_f32_32x32x32_bf16 a[0:15], v[106:109], v[32:39], v5
  global_load_dwordx4 v[122:125], v1, s[14:15] offset:0 sc1
  v_exp_f32 v45, v45
  v_exp_f32 v46, v46
  v_exp_f32 v47, v47
  v_exp_f32 v48, v48
  v_exp_f32 v49, v49
  v_smfmac_f32_32x32x32_bf16 a[0:15], v[110:113], v[40:47], v5
  global_load_dwordx4 v[126:129], v1, s[14:15] offset:1024 sc1
  v_exp_f32 v50, v50
  v_exp_f32 v51, v51
  v_exp_f32 v52, v52
  v_mfma_f32_32x32x16_bf16 v[64:79], v[100:103], a[106:109], v[64:79]
  global_load_dwordx4 v[132:135], v6, s[14:15] offset:0 sc1
  v_exp_f32 v53, v53
  v_exp_f32 v54, v54
  v_exp_f32 v55, v55
  v_mfma_f32_32x32x16_bf16 v[80:95], v[100:103], a[110:113], v[80:95]
  global_load_dwordx4 v[136:139], v6, s[14:15] offset:768 sc1
  v_exp_f32 v56, v56
  v_exp_f32 v57, v57
  v_exp_f32 v58, v58
  v_smfmac_f32_32x32x32_bf16 a[16:31], v[106:109], v[48:55], v5
  global_load_dwordx4 v[140:143], v6, s[14:15] offset:1536 sc1
  v_exp_f32 v59, v59
  v_exp_f32 v60, v60
  v_exp_f32 v61, v61
  v_exp_f32 v62, v62
  v_exp_f32 v63, v63
  v_exp_f32 v64, v64
  v_exp_f32 v65, v65
  v_smfmac_f32_32x32x32_bf16 a[16:31], v[110:113], v[56:63], v5
  global_load_dwordx4 v[144:147], v6, s[14:15] offset:2304 sc1
  s_barrier
  s_cmp_lg_u32 s64, 0
  s_cbranch_scc1 L_noarrive
  s_lshl_b32 s71, s67, 7
  s_add_u32 s71, s71, 196608
  v_lshl_add_u32 v28, v0, 2, s71
  v_mul_u32_u24 v29, s8, v0
  v_lshlrev_b32 v29, v29, 1
  s_mov_b64 exec, 3
  global_atomic_add v28, v29, s[28:29]
  s_mov_b64 exec, -1
L_noarrive:
  v_exp_f32 v66, v66
  v_exp_f32 v67, v67
  v_exp_f32 v68, v68
  v_mfma_f32_32x32x4_2b_bf16 v[32:63], v[104:105], a[124:125], 0 cbsz:1 abid:0
  v_exp_f32 v69, v69
  v_exp_f32 v70, v70
  v_exp_f32 v71, v71
  v_exp_f32 v72, v72
  v_exp_f32 v73, v73
  v_exp_f32 v74, v74
  v_exp_f32 v75, v75
  v_exp_f32 v76, v76
  v_smfmac_f32_32x32x32_bf16 a[0:15], v[114:117], v[64:71], v5
  ds_read_b64_tr_b16 v[240:241], v21 offset:35840
  ds_read_b64_tr_b16 v[242:243], v21 offset:36352
  v_exp_f32 v77, v77
  v_exp_f32 v78, v78
  v_exp_f32 v79, v79
  v_exp_f32 v80, v80
  v_exp_f32 v81, v81
  v_smfmac_f32_32x32x32_bf16 a[0:15], v[118:121], v[72:79], v5
  ds_read_b64_tr_b16 v[244:245], v22 offset:35840
  ds_read_b64_tr_b16 v[246:247], v22 offset:36352
  v_exp_f32 v82, v82
  v_exp_f32 v83, v83
  v_exp_f32 v84, v84
  v_mfma_f32_32x32x16_bf16 v[32:47], v[96:99], a[116:119], v[32:47]
  ds_read_b64_tr_b16 v[248:249], v21 offset:37888
  ds_read_b64_tr_b16 v[250:251], v21 offset:38400
  v_exp_f32 v85, v85
  v_exp_f32 v86, v86
  v_exp_f32 v87, v87
  v_mfma_f32_32x32x16_bf16 v[48:63], v[96:99], a[120:123], v[48:63]
  ds_read_b64_tr_b16 v[252:253], v22 offset:37888
  ds_read_b64_tr_b16 v[254:255], v22 offset:38400
  v_exp_f32 v88, v88
  v_exp_f32 v89, v89
  v_exp_f32 v90, v90
  v_smfmac_f32_32x32x32_bf16 a[16:31], v[114:117], v[80:87], v5
  s_cmp_ge_u32 s6, 3
  s_cselect_b64 s[38:39], s[46:47], s[100:101]
  v_exp_f32 v91, v91
  v_exp_f32 v92, v92
  v_exp_f32 v93, v93
  v_exp_f32 v94, v94
  v_exp_f32 v95, v95
  v_exp_f32 v32, v32
  v_exp_f32 v33, v33
  v_smfmac_f32_32x32x32_bf16 a[16:31], v[118:121], v[88:95], v5
  s_add_u32 s38, s38, 204800
  s_addc_u32 s39, s39, 0
  v_exp_f32 v34, v34
  v_exp_f32 v35, v35
  v_exp_f32 v36, v36
  v_mfma_f32_32x32x4_2b_bf16 v[64:95], v[104:105], a[124:125], 0 cbsz:1 abid:1
  v_exp_f32 v37, v37
  v_exp_f32 v38, v38
  v_exp_f32 v39, v39
  v_exp_f32 v40, v40
  v_exp_f32 v41, v41
  v_exp_f32 v42, v42
  v_exp_f32 v43, v43
  v_exp_f32 v44, v44
  v_smfmac_f32_32x32x32_bf16 a[32:47], v[106:109], v[32:39], v5
  s_waitcnt lgkmcnt(15)
  s_add_u32 m0, s94, 5120
  v_exp_f32 v45, v45
  v_exp_f32 v46, v46
  v_exp_f32 v47, v47
  v_exp_f32 v48, v48
  v_exp_f32 v49, v49
  v_smfmac_f32_32x32x32_bf16 a[32:47], v[110:113], v[40:47], v5
  global_load_lds_dwordx4 v8, s[38:39] offset:0
  v_exp_f32 v50, v50
  v_exp_f32 v51, v51
  v_exp_f32 v52, v52
  v_mfma_f32_32x32x16_bf16 v[64:79], v[100:103], a[116:119], v[64:79]
  global_load_lds_dwordx4 v9, s[38:39] offset:1024
  v_exp_f32 v53, v53
  v_exp_f32 v54, v54
  v_exp_f32 v55, v55
  v_mfma_f32_32x32x16_bf16 v[80:95], v[100:103], a[120:123], v[80:95]
  global_load_lds_dwordx4 v10, s[38:39] offset:2048
  v_exp_f32 v56, v56
  v_exp_f32 v57, v57
  v_exp_f32 v58, v58
  v_smfmac_f32_32x32x32_bf16 a[48:63], v[106:109], v[48:55], v5
  global_load_lds_dwordx4 v11, s[38:39] offset:3072
  v_exp_f32 v59, v59
  v_exp_f32 v60, v60
  v_exp_f32 v61, v61
  v_exp_f32 v62, v62
  v_exp_f32 v63, v63
  v_exp_f32 v64, v64
  v_exp_f32 v65, v65
  v_smfmac_f32_32x32x32_bf16 a[48:63], v[110:113], v[56:63], v5
  s_add_u32 m0, s94, 9216
  v_exp_f32 v66, v66
  v_exp_f32 v67, v67
  v_exp_f32 v68, v68
  v_mfma_f32_32x32x4_2b_bf16 v[32:63], v[104:105], a[134:135], 0 cbsz:1 abid:0
  v_exp_f32 v69, v69
  v_exp_f32 v70, v70
  v_exp_f32 v71, v71
  v_exp_f32 v72, v72
  v_exp_f32 v73, v73
  v_exp_f32 v74, v74
  v_exp_f32 v75, v75
  v_exp_f32 v76, v76
  v_smfmac_f32_32x32x32_bf16 a[32:47], v[114:117], v[64:71], v5
  global_load_lds_dwordx4 v12, s[38:39] offset:0
  v_lshlrev_b32 v27, 12, v0
  s_add_u32 s71, s78, 147456
  s_mov_b64 exec, 0xfff
  buffer_load_dword v183, v27, s[52:55], s71 offen
  s_mov_b64 exec, -1
  v_exp_f32 v77, v77
  v_exp_f32 v78, v78
  v_exp_f32 v79, v79
  v_exp_f32 v80, v80
  v_exp_f32 v81, v81
  v_smfmac_f32_32x32x32_bf16 a[32:47], v[118:121], v[72:79], v5
  s_cmp_ge_u32 s5, 2
  s_cselect_b64 s[36:37], s[44:45], s[42:43]
  v_exp_f32 v82, v82
  v_exp_f32 v83, v83
  v_exp_f32 v84, v84
  v_mfma_f32_32x32x16_bf16 v[32:47], v[96:99], a[126:129], v[32:47]
  v_exp_f32 v85, v85
  v_exp_f32 v86, v86
  v_exp_f32 v87, v87
  v_mfma_f32_32x32x16_bf16 v[48:63], v[96:99], a[130:133], v[48:63]
  v_exp_f32 v88, v88
  v_exp_f32 v89, v89
  v_exp_f32 v90, v90
  v_smfmac_f32_32x32x32_bf16 a[48:63], v[114:117], v[80:87], v5
  s_add_u32 s36, s36, 1179648
  s_addc_u32 s37, s37, 0
  v_exp_f32 v91, v91
  v_exp_f32 v92, v92
  v_exp_f32 v93, v93
  v_exp_f32 v94, v94
  v_exp_f32 v95, v95
  v_exp_f32 v32, v32
  v_exp_f32 v33, v33
  v_smfmac_f32_32x32x32_bf16 a[48:63], v[118:121], v[88:95], v5
  s_waitcnt lgkmcnt(8)
  s_add_u32 m0, s94, 31744
  v_exp_f32 v34, v34
  v_exp_f32 v35, v35
  v_exp_f32 v36, v36
  v_mfma_f32_32x32x4_2b_bf16 v[64:95], v[104:105], a[134:135], 0 cbsz:1 abid:1
  v_exp_f32 v37, v37
  v_exp_f32 v38, v38
  v_exp_f32 v39, v39
  v_exp_f32 v40, v40
  v_exp_f32 v41, v41
  v_exp_f32 v42, v42
  v_exp_f32 v43, v43
  v_exp_f32 v44, v44
  v_smfmac_f32_32x32x32_bf16 a[64:79], v[106:109], v[32:39], v5
  global_load_lds_dwordx4 v20, s[36:37] offset:0
  s_getpc_b64 s[16:17]
L_pc2:
  s_mul_i32 s71, s3, 384
  s_add_u32 s71, s71, 3016
  s_min_u32 s71, s71, 21972
  v_lshl_add_u32 v27, v0, 7, s71
  s_mov_b64 exec, 7
  global_load_dword v183, v27, s[16:17]
  s_mov_b64 exec, -1
  v_exp_f32 v45, v45
  v_exp_f32 v46, v46
  v_exp_f32 v47, v47
  v_exp_f32 v48, v48
  v_exp_f32 v49, v49
  v_smfmac_f32_32x32x32_bf16 a[64:79], v[110:113], v[40:47], v5
  global_load_lds_dwordx4 v180, s[36:37] offset:1024
  v_exp_f32 v50, v50
  v_exp_f32 v51, v51
  v_exp_f32 v52, v52
  v_mfma_f32_32x32x16_bf16 v[64:79], v[100:103], a[126:129], v[64:79]
  global_load_lds_dwordx4 v181, s[36:37] offset:2048
  v_exp_f32 v53, v53
  v_exp_f32 v54, v54
  v_exp_f32 v55, v55
  v_mfma_f32_32x32x16_bf16 v[80:95], v[100:103], a[130:133], v[80:95]
  global_load_lds_dwordx4 v182, s[36:37] offset:3072
  v_exp_f32 v56, v56
  v_exp_f32 v57, v57
  v_exp_f32 v58, v58
  v_smfmac_f32_32x32x32_bf16 a[80:95], v[106:109], v[48:55], v5
  s_cmp_ge_u32 s6, 2
  s_cselect_b64 s[38:39], s[46:47], s[100:101]
  v_exp_f32 v59, v59
  v_exp_f32 v60, v60
  v_exp_f32 v61, v61
  v_exp_f32 v62, v62
  v_exp_f32 v63, v63
  v_exp_f32 v64, v64
  v_exp_f32 v65, v65
  v_smfmac_f32_32x32x32_bf16 a[80:95], v[110:113], v[56:63], v5
  s_add_u32 s38, s38, 409600
  s_addc_u32 s39, s39, 0
  v_exp_f32 v66, v66
  v_exp_f32 v67, v67
  v_exp_f32 v68, v68
  v_mfma_f32_32x32x4_2b_bf16 v[32:63], v[104:105], a[104:105], 0 cbsz:1 abid:0
  v_exp_f32 v69, v69
  v_exp_f32 v70, v70
  v_exp_f32 v71, v71
  v_exp_f32 v72, v72
  v_exp_f32 v73, v73
  v_exp_f32 v74, v74
  v_exp_f32 v75, v75
  v_exp_f32 v76, v76
  v_smfmac_f32_32x32x32_bf16 a[64:79], v[114:117], v[64:71], v5
  s_add_u32 m0, s94, 10240
  v_exp_f32 v77, v77
  v_exp_f32 v78, v78
  v_exp_f32 v79, v79
  v_exp_f32 v80, v80
  v_exp_f32 v81, v81
  v_smfmac_f32_32x32x32_bf16 a[64:79], v[118:121], v[72:79], v5
  global_load_lds_dwordx4 v8, s[38:39] offset:0
  v_exp_f32 v82, v82
  v_exp_f32 v83, v83
  v_exp_f32 v84, v84
  v_mfma_f32_32x32x16_bf16 v[32:47], v[96:99], a[96:99], v[32:47]
  global_load_lds_dwordx4 v9, s[38:39] offset:1024
  v_exp_f32 v85, v85
  v_exp_f32 v86, v86
  v_exp_f32 v87, v87
  v_mfma_f32_32x32x16_bf16 v[48:63], v[96:99], a[100:103], v[48:63]
  global_load_lds_dwordx4 v10, s[38:39] offset:2048
  v_exp_f32 v88, v88
  v_exp_f32 v89, v89
  v_exp_f32 v90, v90
  v_smfmac_f32_32x32x32_bf16 a[80:95], v[114:117], v[80:87], v5
  global_load_lds_dwordx4 v11, s[38:39] offset:3072
  v_exp_f32 v91, v91
  v_exp_f32 v92, v92
  v_exp_f32 v93, v93
  v_exp_f32 v94, v94
  v_exp_f32 v95, v95
  v_exp_f32 v32, v32
  v_exp_f32 v33, v33
  v_smfmac_f32_32x32x32_bf16 a[80:95], v[118:121], v[88:95], v5
  s_add_u32 m0, s94, 14336
  v_exp_f32 v34, v34
  v_exp_f32 v35, v35
  v_exp_f32 v36, v36
  v_mfma_f32_32x32x4_2b_bf16 v[64:95], v[104:105], a[104:105], 0 cbsz:1 abid:1
  v_exp_f32 v37, v37
  v_exp_f32 v38, v38
  v_exp_f32 v39, v39
  v_exp_f32 v40, v40
  v_exp_f32 v41, v41
  v_exp_f32 v42, v42
  v_exp_f32 v43, v43
  v_exp_f32 v44, v44
  v_smfmac_f32_32x32x32_bf16 v[148:163], v[106:109], v[32:39], v5
  global_load_lds_dwordx4 v12, s[38:39] offset:0
  v_exp_f32 v45, v45
  v_exp_f32 v46, v46
  v_exp_f32 v47, v47
  v_exp_f32 v48, v48
  v_exp_f32 v49, v49
  v_smfmac_f32_32x32x32_bf16 v[148:163], v[110:113], v[40:47], v5
  s_add_u32 s36, s36, 98304
  s_addc_u32 s37, s37, 0
  v_exp_f32 v50, v50
  v_exp_f32 v51, v51
  v_exp_f32 v52, v52
  v_mfma_f32_32x32x16_bf16 v[64:79], v[100:103], a[96:99], v[64:79]
  s_waitcnt lgkmcnt(0)
  s_add_u32 m0, s94, 35840
  v_exp_f32 v53, v53
  v_exp_f32 v54, v54
  v_exp_f32 v55, v55
  v_mfma_f32_32x32x16_bf16 v[80:95], v[100:103], a[100:103], v[80:95]
  global_load_lds_dwordx4 v20, s[36:37] offset:0
  v_exp_f32 v56, v56
  v_exp_f32 v57, v57
  v_exp_f32 v58, v58
  v_smfmac_f32_32x32x32_bf16 v[164:179], v[106:109], v[48:55], v5
  s_waitcnt vmcnt(17)
  v_max3_u32 v27, v122, v126, v130
  v_max3_u32 v27, v27, v132, v136
  v_max3_u32 v27, v27, v140, v144
  v_cmp_eq_u32 vcc, -1, v27
  v_exp_f32 v59, v59
  v_exp_f32 v60, v60
  v_exp_f32 v61, v61
  v_exp_f32 v62, v62
  v_exp_f32 v63, v63
  v_exp_f32 v64, v64
  v_exp_f32 v65, v65
  v_smfmac_f32_32x32x32_bf16 v[164:179], v[110:113], v[56:63], v5
  s_cbranch_vccnz L_rtykv7_16
L_okkv7_15:
  v_exp_f32 v66, v66
  v_exp_f32 v67, v67
  v_exp_f32 v68, v68
  v_mfma_f32_32x32x4_2b_bf16 v[32:63], v[130:131], a[114:115], 0 cbsz:1 abid:0
  v_exp_f32 v69, v69
  v_exp_f32 v70, v70
  v_exp_f32 v71, v71
  v_exp_f32 v72, v72
  v_exp_f32 v73, v73
  v_exp_f32 v74, v74
  v_exp_f32 v75, v75
  v_exp_f32 v76, v76
  v_smfmac_f32_32x32x32_bf16 v[148:163], v[114:117], v[64:71], v5
  global_load_lds_dwordx4 v180, s[36:37] offset:1024
  v_exp_f32 v77, v77
  v_exp_f32 v78, v78
  v_exp_f32 v79, v79
  v_exp_f32 v80, v80
  v_exp_f32 v81, v81
  v_smfmac_f32_32x32x32_bf16 v[148:163], v[118:121], v[72:79], v5
  global_load_lds_dwordx4 v181, s[36:37] offset:2048
  v_exp_f32 v82, v82
  v_exp_f32 v83, v83
  v_exp_f32 v84, v84
  v_mfma_f32_32x32x16_bf16 v[32:47], v[122:125], a[106:109], v[32:47]
  global_load_lds_dwordx4 v182, s[36:37] offset:3072
  v_exp_f32 v85, v85
  v_exp_f32 v86, v86
  v_exp_f32 v87, v87
  v_mfma_f32_32x32x16_bf16 v[48:63], v[122:125], a[110:113], v[48:63]
  v_exp_f32 v88, v88
  v_exp_f32 v89, v89
  v_exp_f32 v90, v90
  v_smfmac_f32_32x32x32_bf16 v[164:179], v[114:117], v[80:87], v5
  v_exp_f32 v91, v91
  v_exp_f32 v92, v92
  v_exp_f32 v93, v93
  v_exp_f32 v94, v94
  v_exp_f32 v95, v95
  v_exp_f32 v32, v32
  v_exp_f32 v33, v33
  v_smfmac_f32_32x32x32_bf16 v[164:179], v[118:121], v[88:95], v5
  v_exp_f32 v34, v34
  v_exp_f32 v35, v35
  v_exp_f32 v36, v36
  v_mfma_f32_32x32x4_2b_bf16 v[64:95], v[130:131], a[114:115], 0 cbsz:1 abid:1
  v_exp_f32 v37, v37
  v_exp_f32 v38, v38
  v_exp_f32 v39, v39
  v_exp_f32 v40, v40
  v_exp_f32 v41, v41
  v_exp_f32 v42, v42
  v_exp_f32 v43, v43
  v_exp_f32 v44, v44
  v_smfmac_f32_32x32x32_bf16 a[0:15], v[132:135], v[32:39], v5
  v_exp_f32 v45, v45
  v_exp_f32 v46, v46
  v_exp_f32 v47, v47
  v_exp_f32 v48, v48
  v_exp_f32 v49, v49
  v_smfmac_f32_32x32x32_bf16 a[0:15], v[136:139], v[40:47], v5
  buffer_load_dwordx2 v[8:9], v19, s[32:35], s10 offen offset:0
  v_exp_f32 v50, v50
  v_exp_f32 v51, v51
  v_exp_f32 v52, v52
  v_mfma_f32_32x32x16_bf16 v[64:79], v[126:129], a[106:109], v[64:79]
  v_exp_f32 v53, v53
  v_exp_f32 v54, v54
  v_exp_f32 v55, v55
  v_mfma_f32_32x32x16_bf16 v[80:95], v[126:129], a[110:113], v[80:95]
  v_exp_f32 v56, v56
  v_exp_f32 v57, v57
  v_exp_f32 v58, v58
  v_smfmac_f32_32x32x32_bf16 a[16:31], v[132:135], v[48:55], v5
  v_exp_f32 v59, v59
  v_exp_f32 v60, v60
  v_exp_f32 v61, v61
  v_exp_f32 v62, v62
  v_exp_f32 v63, v63
  v_exp_f32 v64, v64
  v_exp_f32 v65, v65
  v_smfmac_f32_32x32x32_bf16 a[16:31], v[136:139], v[56:63], v5
  buffer_load_dwordx2 v[10:11], v19, s[32:35], s10 offen offset:32
  v_exp_f32 v66, v66
  v_exp_f32 v67, v67
  v_exp_f32 v68, v68
  v_mfma_f32_32x32x4_2b_bf16 v[32:63], v[130:131], a[124:125], 0 cbsz:1 abid:0
  v_exp_f32 v69, v69
  v_exp_f32 v70, v70
  v_exp_f32 v71, v71
  v_exp_f32 v72, v72
  v_exp_f32 v73, v73
  v_exp_f32 v74, v74
  v_exp_f32 v75, v75
  v_exp_f32 v76, v76
  v_smfmac_f32_32x32x32_bf16 a[0:15], v[140:143], v[64:71], v5
  v_lshrrev_b32 v30, 5, v0
  v_lshl_add_u32 v30, v30, 3, s90
  global_load_dwordx2 v[180:181], v30, s[18:19]
  global_load_dwordx2 v[182:183], v30, s[18:19] offset:16
  v_exp_f32 v77, v77
  v_exp_f32 v78, v78
  v_exp_f32 v79, v79
  v_exp_f32 v80, v80
  v_exp_f32 v81, v81
  v_smfmac_f32_32x32x32_bf16 a[0:15], v[144:147], v[72:79], v5
  v_lshl_add_u32 v30, v2, 1, s30
  global_load_ushort v31, v30, s[22:23]
  v_exp_f32 v82, v82
  v_exp_f32 v83, v83
  v_exp_f32 v84, v84
  v_mfma_f32_32x32x16_bf16 v[32:47], v[122:125], a[116:119], v[32:47]
  s_lshl_b32 s8, 8, s8
  v_exp_f32 v85, v85
  v_exp_f32 v86, v86
  v_exp_f32 v87, v87
  v_mfma_f32_32x32x16_bf16 v[48:63], v[122:125], a[120:123], v[48:63]
  v_exp_f32 v88, v88
  v_exp_f32 v89, v89
  v_exp_f32 v90, v90
  v_smfmac_f32_32x32x32_bf16 a[16:31], v[140:143], v[80:87], v5
  buffer_load_dwordx2 v[12:13], v19, s[32:35], s10 offen offset:64
  v_exp_f32 v91, v91
  v_exp_f32 v92, v92
  v_exp_f32 v93, v93
  v_exp_f32 v94, v94
  v_exp_f32 v95, v95
  v_exp_f32 v32, v32
  v_exp_f32 v33, v33
  v_smfmac_f32_32x32x32_bf16 a[16:31], v[144:147], v[88:95], v5
  s_barrier
  ds_write_b128 v23, a[0:3] offset:1024
  v_exp_f32 v34, v34
  v_exp_f32 v35, v35
  v_exp_f32 v36, v36
  v_mfma_f32_32x32x4_2b_bf16 v[64:95], v[130:131], a[124:125], 0 cbsz:1 abid:1
  v_exp_f32 v37, v37
  v_exp_f32 v38, v38
  v_exp_f32 v39, v39
  v_exp_f32 v40, v40
  v_exp_f32 v41, v41
  v_exp_f32 v42, v42
  v_exp_f32 v43, v43
  v_exp_f32 v44, v44
  v_smfmac_f32_32x32x32_bf16 a[32:47], v[132:135], v[32:39], v5
  ds_write_b128 v23, a[4:7] offset:2048
  v_exp_f32 v45, v45
  v_exp_f32 v46, v46
  v_exp_f32 v47, v47
  v_exp_f32 v48, v48
  v_exp_f32 v49, v49
  v_smfmac_f32_32x32x32_bf16 a[32:47], v[136:139], v[40:47], v5
  ds_write_b128 v23, a[8:11] offset:3072
  v_exp_f32 v50, v50
  v_exp_f32 v51, v51
  v_exp_f32 v52, v52
  v_mfma_f32_32x32x16_bf16 v[64:79], v[126:129], a[116:119], v[64:79]
  ds_write_b128 v23, a[16:19] offset:4096
  v_exp_f32 v53, v53
  v_exp_f32 v54, v54
  v_exp_f32 v55, v55
  v_mfma_f32_32x32x16_bf16 v[80:95], v[126:129], a[120:123], v[80:95]
  ds_write_b128 v23, a[20:23] offset:5120
  v_exp_f32 v56, v56
  v_exp_f32 v57, v57
  v_exp_f32 v58, v58
  v_smfmac_f32_32x32x32_bf16 a[48:63], v[132:135], v[48:55], v5
  ds_write_b128 v23, a[24:27] offset:6144
  v_exp_f32 v59, v59
  v_exp_f32 v60, v60
  v_exp_f32 v61, v61
  v_exp_f32 v62, v62
  v_exp_f32 v63, v63
  v_exp_f32 v64, v64
  v_exp_f32 v65, v65
  v_smfmac_f32_32x32x32_bf16 a[48:63], v[136:139], v[56:63], v5
  buffer_load_dwordx2 v[14:15], v19, s[32:35], s10 offen offset:96
  v_exp_f32 v66, v66
  v_exp_f32 v67, v67
  v_exp_f32 v68, v68
  v_mfma_f32_32x32x4_2b_bf16 v[32:63], v[130:131], a[134:135], 0 cbsz:1 abid:0
  v_exp_f32 v69, v69
  v_exp_f32 v70, v70
  v_exp_f32 v71, v71
  v_exp_f32 v72, v72
  v_exp_f32 v73, v73
  v_exp_f32 v74, v74
  v_exp_f32 v75, v75
  v_exp_f32 v76, v76
  v_smfmac_f32_32x32x32_bf16 a[32:47], v[140:143], v[64:71], v5
  s_waitcnt lgkmcnt(0)
  s_barrier
  ds_read_b128 v[96:99], v26 offset:1024
  ds_read_b128 v[100:103], v26 offset:2048
  ds_read_b128 v[104:107], v26 offset:3072
  v_exp_f32 v77, v77
  v_exp_f32 v78, v78
  v_exp_f32 v79, v79
  v_exp_f32 v80, v80
  v_exp_f32 v81, v81
  v_smfmac_f32_32x32x32_bf16 a[32:47], v[144:147], v[72:79], v5
  s_nop 0
  ds_read_b128 v[108:111], v26 offset:4096
  ds_read_b128 v[112:115], v26 offset:5120
  ds_read_b128 v[116:119], v26 offset:6144
  v_exp_f32 v82, v82
  v_exp_f32 v83, v83
  v_exp_f32 v84, v84
  v_mfma_f32_32x32x16_bf16 v[32:47], v[122:125], a[126:129], v[32:47]
  v_exp_f32 v85, v85
  v_exp_f32 v86, v86
  v_exp_f32 v87, v87
  v_mfma_f32_32x32x16_bf16 v[48:63], v[122:125], a[130:133], v[48:63]
  buffer_load_dwordx2 v[16:17], v19, s[32:35], s10 offen offset:128
  v_exp_f32 v88, v88
  v_exp_f32 v89, v89
  v_exp_f32 v90, v90
  v_smfmac_f32_32x32x32_bf16 a[48:63], v[140:143], v[80:87], v5
  s_waitcnt lgkmcnt(0)
  v_add_f32 v148, v148, v96
  v_add_f32 v149, v149, v97
  v_add_f32 v150, v150, v98
  v_add_f32 v151, v151, v99
  v_add_f32 v152, v152, v100
  v_add_f32 v153, v153, v101
  v_add_f32 v154, v154, v102
  v_add_f32 v155, v155, v103
  v_add_f32 v156, v156, v104
  v_add_f32 v157, v157, v105
  v_add_f32 v158, v158, v106
  v_add_f32 v164, v164, v108
  v_add_f32 v165, v165, v109
  v_add_f32 v166, v166, v110
  v_add_f32 v167, v167, v111
  v_add_f32 v168, v168, v112
  v_add_f32 v169, v169, v113
  v_add_f32 v170, v170, v114
  v_add_f32 v171, v171, v115
  v_add_f32 v172, v172, v116
  v_add_f32 v173, v173, v117
  v_add_f32 v174, v174, v118
  v_exp_f32 v91, v91
  v_exp_f32 v92, v92
  v_exp_f32 v93, v93
  v_exp_f32 v94, v94
  v_exp_f32 v95, v95
  v_exp_f32 v32, v32
  v_exp_f32 v33, v33
  v_smfmac_f32_32x32x32_bf16 a[48:63], v[144:147], v[88:95], v5
  s_barrier
  ds_write_b128 v24, a[32:35] offset:1024
  v_exp_f32 v34, v34
  v_exp_f32 v35, v35
  v_exp_f32 v36, v36
  v_mfma_f32_32x32x4_2b_bf16 v[64:95], v[130:131], a[134:135], 0 cbsz:1 abid:1
  v_exp_f32 v37, v37
  v_exp_f32 v38, v38
  v_exp_f32 v39, v39
  v_exp_f32 v40, v40
  v_exp_f32 v41, v41
  v_exp_f32 v42, v42
  v_exp_f32 v43, v43
  v_exp_f32 v44, v44
  v_smfmac_f32_32x32x32_bf16 a[64:79], v[132:135], v[32:39], v5
  ds_write_b128 v24, a[36:39] offset:2048
  v_exp_f32 v45, v45
  v_exp_f32 v46, v46
  v_exp_f32 v47, v47
  v_exp_f32 v48, v48
  v_exp_f32 v49, v49
  v_smfmac_f32_32x32x32_bf16 a[64:79], v[136:139], v[40:47], v5
  ds_write_b128 v24, a[40:43] offset:3072
  v_exp_f32 v50, v50
  v_exp_f32 v51, v51
  v_exp_f32 v52, v52
  v_mfma_f32_32x32x16_bf16 v[64:79], v[126:129], a[126:129], v[64:79]
  ds_write_b128 v24, a[48:51] offset:4096
  v_exp_f32 v53, v53
  v_exp_f32 v54, v54
  v_exp_f32 v55, v55
  v_mfma_f32_32x32x16_bf16 v[80:95], v[126:129], a[130:133], v[80:95]
  ds_write_b128 v24, a[52:55] offset:5120
  v_exp_f32 v56, v56
  v_exp_f32 v57, v57
  v_exp_f32 v58, v58
  v_smfmac_f32_32x32x32_bf16 a[80:95], v[132:135], v[48:55], v5
  ds_write_b128 v24, a[56:59] offset:6144
  v_exp_f32 v59, v59
  v_exp_f32 v60, v60
  v_exp_f32 v61, v61
  v_exp_f32 v62, v62
  v_exp_f32 v63, v63
  v_exp_f32 v64, v64
  v_exp_f32 v65, v65
  v_smfmac_f32_32x32x32_bf16 a[80:95], v[136:139], v[56:63], v5
  v_exp_f32 v66, v66
  v_exp_f32 v67, v67
  v_exp_f32 v68, v68
  v_mfma_f32_32x32x4_2b_bf16 v[32:63], v[130:131], a[104:105], 0 cbsz:1 abid:0
  v_exp_f32 v69, v69
  v_exp_f32 v70, v70
  v_exp_f32 v71, v71
  v_exp_f32 v72, v72
  v_exp_f32 v73, v73
  v_exp_f32 v74, v74
  v_exp_f32 v75, v75
  v_exp_f32 v76, v76
  v_smfmac_f32_32x32x32_bf16 a[64:79], v[140:143], v[64:71], v5
  s_waitcnt lgkmcnt(0)
  s_barrier
  ds_read_b128 v[96:99], v26 offset:1024
  ds_read_b128 v[100:103], v26 offset:2048
  ds_read_b128 v[104:107], v26 offset:3072
  v_exp_f32 v77, v77
  v_exp_f32 v78, v78
  v_exp_f32 v79, v79
  v_exp_f32 v80, v80
  v_exp_f32 v81, v81
  v_smfmac_f32_32x32x32_bf16 a[64:79], v[144:147], v[72:79], v5
  s_nop 0
  ds_read_b128 v[108:111], v26 offset:4096
  ds_read_b128 v[112:115], v26 offset:5120
  ds_read_b128 v[116:119], v26 offset:6144
  v_exp_f32 v82, v82
  v_exp_f32 v83, v83
  v_exp_f32 v84, v84
  v_mfma_f32_32x32x16_bf16 v[32:47], v[122:125], a[96:99], v[32:47]
  v_and_b32 v28, 31, v0
  v_lshlrev_b32 v28, 7, v28
  v_add_u32 v28, 196608, v28
  global_load_dwordx2 v[28:29], v28, s[28:29] sc1
  v_exp_f32 v85, v85
  v_exp_f32 v86, v86
  v_exp_f32 v87, v87
  v_mfma_f32_32x32x16_bf16 v[48:63], v[122:125], a[100:103], v[48:63]
  v_exp_f32 v88, v88
  v_exp_f32 v89, v89
  v_exp_f32 v90, v90
  v_smfmac_f32_32x32x32_bf16 a[80:95], v[140:143], v[80:87], v5
  s_waitcnt lgkmcnt(0)
  v_add_f32 v148, v148, v96
  v_add_f32 v149, v149, v97
  v_add_f32 v150, v150, v98
  v_add_f32 v151, v151, v99
  v_add_f32 v152, v152, v100
  v_add_f32 v153, v153, v101
  v_add_f32 v154, v154, v102
  v_add_f32 v155, v155, v103
  v_add_f32 v156, v156, v104
  v_add_f32 v157, v157, v105
  v_add_f32 v158, v158, v106
  v_add_f32 v164, v164, v108
  v_add_f32 v165, v165, v109
  v_add_f32 v166, v166, v110
  v_add_f32 v167, v167, v111
  v_add_f32 v168, v168, v112
  v_add_f32 v169, v169, v113
  v_add_f32 v170, v170, v114
  v_add_f32 v171, v171, v115
  v_add_f32 v172, v172, v116
  v_add_f32 v173, v173, v117
  v_add_f32 v174, v174, v118
  v_exp_f32 v91, v91
  v_exp_f32 v92, v92
  v_exp_f32 v93, v93
  v_exp_f32 v94, v94
  v_exp_f32 v95, v95
  v_exp_f32 v32, v32
  v_exp_f32 v33, v33
  v_smfmac_f32_32x32x32_bf16 a[80:95], v[144:147], v[88:95], v5
  s_barrier
  ds_write_b128 v25, a[64:67] offset:1024
  v_exp_f32 v34, v34
  v_exp_f32 v35, v35
  v_exp_f32 v36, v36
  v_mfma_f32_32x32x4_2b_bf16 v[64:95], v[130:131], a[104:105], 0 cbsz:1 abid:1
  v_exp_f32 v37, v37
  v_exp_f32 v38, v38
  v_exp_f32 v39, v39
  v_exp_f32 v40, v40
  v_exp_f32 v41, v41
  v_exp_f32 v42, v42
  v_exp_f32 v43, v43
  v_exp_f32 v44, v44
  v_smfmac_f32_32x32x32_bf16 v[148:163], v[132:135], v[32:39], v5
  ds_write_b128 v25, a[68:71] offset:2048
  v_exp_f32 v45, v45
  v_exp_f32 v46, v46
  v_exp_f32 v47, v47
  v_exp_f32 v48, v48
  v_exp_f32 v49, v49
  v_smfmac_f32_32x32x32_bf16 v[148:163], v[136:139], v[40:47], v5
  ds_write_b128 v25, a[72:75] offset:3072
  v_exp_f32 v50, v50
  v_exp_f32 v51, v51
  v_exp_f32 v52, v52
  v_mfma_f32_32x32x16_bf16 v[64:79], v[126:129], a[96:99], v[64:79]
  ds_write_b128 v25, a[80:83] offset:4096
  v_exp_f32 v53, v53
  v_exp_f32 v54, v54
  v_exp_f32 v55, v55
  v_mfma_f32_32x32x16_bf16 v[80:95], v[126:129], a[100:103], v[80:95]
  ds_write_b128 v25, a[84:87] offset:5120
  v_exp_f32 v56, v56
  v_exp_f32 v57, v57
  v_exp_f32 v58, v58
  v_smfmac_f32_32x32x32_bf16 v[164:179], v[132:135], v[48:55], v5
  ds_write_b128 v25, a[88:91] offset:6144
  v_exp_f32 v59, v59
  v_exp_f32 v60, v60
  v_exp_f32 v61, v61
  v_exp_f32 v62, v62
  v_exp_f32 v63, v63
  v_exp_f32 v64, v64
  v_exp_f32 v65, v65
  v_smfmac_f32_32x32x32_bf16 v[164:179], v[136:139], v[56:63], v5
  s_waitcnt vmcnt(0)
  v_cmp_gt_u32 vcc, 8, v28
  v_readlane_b32 s9, v29, s67
  v_exp_f32 v66, v66
  v_exp_f32 v67, v67
  v_exp_f32 v68, v68
  v_exp_f32 v69, v69
  v_exp_f32 v70, v70
  v_exp_f32 v71, v71
  v_exp_f32 v72, v72
  v_exp_f32 v73, v73
  v_exp_f32 v74, v74
  v_exp_f32 v75, v75
  v_exp_f32 v76, v76
  v_smfmac_f32_32x32x32_bf16 v[148:163], v[140:143], v[64:71], v5
  s_waitcnt lgkmcnt(0)
  s_barrier
  ds_read_b128 v[96:99], v26 offset:1024
  ds_read_b128 v[100:103], v26 offset:2048
  ds_read_b128 v[104:107], v26 offset:3072
  v_exp_f32 v77, v77
  v_exp_f32 v78, v78
  v_exp_f32 v79, v79
  v_exp_f32 v80, v80
  v_exp_f32 v81, v81
  v_smfmac_f32_32x32x32_bf16 v[148:163], v[144:147], v[72:79], v5
  s_nop 0
  ds_read_b128 v[108:111], v26 offset:4096
  ds_read_b128 v[112:115], v26 offset:5120
  ds_read_b128 v[116:119], v26 offset:6144
  v_exp_f32 v82, v82
  v_exp_f32 v83, v83
  v_exp_f32 v84, v84
  v_exp_f32 v85, v85
  v_exp_f32 v86, v86
  v_exp_f32 v87, v87
  v_exp_f32 v88, v88
  v_exp_f32 v89, v89
  v_exp_f32 v90, v90
  v_smfmac_f32_32x32x32_bf16 v[164:179], v[140:143], v[80:87], v5
  s_mov_b32 s88, vcc_lo
  v_exp_f32 v91, v91
  v_exp_f32 v92, v92
  v_exp_f32 v93, v93
  v_exp_f32 v94, v94
  v_exp_f32 v95, v95
  s_waitcnt lgkmcnt(0)
  s_nop 0
  v_smfmac_f32_32x32x32_bf16 v[164:179], v[144:147], v[88:95], v5
L_attn_sum:
  v_pk_add_f32 v[148:149], v[148:149], v[96:97]
  v_pk_add_f32 v[150:151], v[150:151], v[98:99]
  v_pk_add_f32 v[152:153], v[152:153], v[100:101]
  v_pk_add_f32 v[154:155], v[154:155], v[102:103]
  v_pk_add_f32 v[156:157], v[156:157], v[104:105]
  v_pk_add_f32 v[158:159], v[158:159], v[106:107]
  v_rcp_f32 v32, v158
  v_subrev_u32 v36, 0x21800000, v158
  v_pk_mul_f32 v[148:149], v[148:149], v[32:33] op_sel_hi:[1,0]
  v_pk_mul_f32 v[150:151], v[150:151], v[32:33] op_sel_hi:[1,0]
  v_pk_mul_f32 v[152:153], v[152:153], v[32:33] op_sel_hi:[1,0]
  v_pk_mul_f32 v[154:155], v[154:155], v[32:33] op_sel_hi:[1,0]
  v_pk_mul_f32 v[156:157], v[156:157], v[32:33] op_sel_hi:[1,0]
  v_cvt_pk_bf16_f32 v136, v148, v149
  v_cvt_pk_bf16_f32 v137, v150, v151
  v_cvt_pk_bf16_f32 v138, v152, v153
  v_cvt_pk_bf16_f32 v139, v154, v155
  v_cvt_pk_bf16_f32 v144, v156, v157
  v_min_u32 v136, -2, v136
  v_pk_add_f32 v[164:165], v[164:165], v[108:109]
  v_pk_add_f32 v[166:167], v[166:167], v[110:111]
  v_pk_add_f32 v[168:169], v[168:169], v[112:113]
  v_pk_add_f32 v[170:171], v[170:171], v[114:115]
  v_pk_add_f32 v[172:173], v[172:173], v[116:117]
  v_pk_add_f32 v[174:175], v[174:175], v[118:119]
  v_rcp_f32 v32, v174
  v_subrev_u32 v37, 0x21800000, v174
  v_pk_mul_f32 v[164:165], v[164:165], v[32:33] op_sel_hi:[1,0]
  v_pk_mul_f32 v[166:167], v[166:167], v[32:33] op_sel_hi:[1,0]
  v_pk_mul_f32 v[168:169], v[168:169], v[32:33] op_sel_hi:[1,0]
  v_pk_mul_f32 v[170:171], v[170:171], v[32:33] op_sel_hi:[1,0]
  v_pk_mul_f32 v[172:173], v[172:173], v[32:33] op_sel_hi:[1,0]
  v_cvt_pk_bf16_f32 v140, v164, v165
  v_cvt_pk_bf16_f32 v141, v166, v167
  v_cvt_pk_bf16_f32 v142, v168, v169
  v_cvt_pk_bf16_f32 v143, v170, v171
  v_cvt_pk_bf16_f32 v145, v172, v173
  v_min_u32 v140, -2, v140
  v_max_u32 v36, v36, v37
  v_cmp_lt_u32 vcc, 0x3c000000, v36
  v_permlane32_swap_b32 v144, v146
  v_permlane32_swap_b32 v145, v147
  v_min_u32 v144, -2, v144
  s_cmp_lg_u64 vcc, 0
  s_cselect_b32 s73, 1, 0
  s_cmp_lg_u32 s88, 0
  s_cbranch_scc1 L_spin2
L_spin2_done:
  s_andn2_b32 s73, s73, s31
  s_cbranch_scc1 L_nopub
  s_cmp_lg_u32 s9, s8
  s_cbranch_scc1 L_wto
  buffer_store_dwordx4 v[136:139], v1, s[60:63], s80 offen
  buffer_store_dwordx4 v[140:143], v1, s[60:63], s80 offen offset:1024
  s_mov_b32 exec_hi, 0
  buffer_store_dwordx4 v[144:147], v1, s[60:63], s81 offen
  s_mov_b32 exec_hi, -1
L_wtdo:
L_nopub:
  s_lshl_b32 s71, s64, 2
  s_add_u32 s71, s71, 159744
  v_mov_b32 v28, s71
  v_mov_b32 v29, s73
  ds_write_b32 v28, v29
  v_add_u32 v30, 4096, v18
  v_lshrrev_b32 v27, 2, v0
  v_lshl_add_u32 v19, v27, 7, v4
  v_add_u32 v27, 79872, v19
  v_mov_b32 v28, 159744
  v_lshlrev_b32 v112, 16, v8
  v_and_b32 v113, s76, v8
  v_lshlrev_b32 v114, 16, v9
  v_and_b32 v115, s76, v9
  v_lshlrev_b32 v116, 16, v10
  v_and_b32 v117, s76, v10
  v_lshlrev_b32 v118, 16, v11
  v_and_b32 v119, s76, v11
  v_lshlrev_b32 v120, 16, v12
  v_and_b32 v121, s76, v12
  v_lshlrev_b32 v122, 16, v13
  v_and_b32 v123, s76, v13
  v_lshlrev_b32 v124, 16, v14
  v_and_b32 v125, s76, v14
  v_lshlrev_b32 v126, 16, v15
  v_and_b32 v127, s76, v15
  v_lshlrev_b32 v128, 16, v16
  v_and_b32 v129, s76, v16
  v_lshlrev_b32 v130, 16, v17
  v_and_b32 v131, s76, v17
  s_waitcnt lgkmcnt(0)
  s_barrier
  ds_read_b128 v[132:135], v28
  buffer_load_dwordx4 v[32:35], v18, s[60:63], s82 offen offset:0 sc1
  ds_read_b64_tr_b16 a[0:1], v19 offset:0
  ds_read_b64_tr_b16 a[2:3], v19 offset:2560
  ds_read_b64_tr_b16 a[4:5], v19 offset:32
  ds_read_b64_tr_b16 a[6:7], v19 offset:2592
  buffer_load_dwordx4 v[36:39], v18, s[60:63], s82 offen offset:2048 sc1
  ds_read_b64_tr_b16 a[8:9], v19 offset:64
  ds_read_b64_tr_b16 a[10:11], v19 offset:2624
  ds_read_b64_tr_b16 a[12:13], v19 offset:96
  ds_read_b64_tr_b16 a[14:15], v19 offset:2656
  buffer_load_dwordx4 v[40:43], v30, s[60:63], s82 offen offset:0 sc1
  ds_read_b64_tr_b16 a[16:17], v19 offset:128
  ds_read_b64_tr_b16 a[18:19], v19 offset:2688
  ds_read_b64_tr_b16 a[20:21], v19 offset:39936
  ds_read_b64_tr_b16 a[22:23], v19 offset:42496
  buffer_load_dwordx4 v[44:47], v30, s[60:63], s82 offen offset:2048 sc1
  s_waitcnt lgkmcnt(12)
  v_or3_b32 v132, v132, v133, v134
  v_or_b32 v132, v132, v135
  v_cmp_ne_u32 vcc, 0, v132
  buffer_load_dwordx4 v[48:51], v18, s[60:63], s83 offen offset:0 sc1
  s_cbranch_vccnz L_fallback
  buffer_load_dwordx4 v[52:55], v18, s[60:63], s83 offen offset:2048 sc1
  ds_read_b64_tr_b16 a[24:25], v19 offset:39968
  ds_read_b64_tr_b16 a[26:27], v19 offset:42528
  ds_read_b64_tr_b16 a[28:29], v19 offset:40000
  ds_read_b64_tr_b16 a[30:31], v19 offset:42560
  ds_read_b64_tr_b16 a[32:33], v19 offset:40032
  ds_read_b64_tr_b16 a[34:35], v19 offset:42592
  ds_read_b64_tr_b16 a[36:37], v19 offset:40064
  ds_read_b64_tr_b16 a[38:39], v19 offset:42624
  buffer_load_dwordx4 v[56:59], v30, s[60:63], s83 offen offset:0 sc1
  ds_read_b64_tr_b16 a[40:41], v27 offset:0
  ds_read_b64_tr_b16 a[42:43], v27 offset:2560
  ds_read_b64_tr_b16 a[44:45], v27 offset:32
  ds_read_b64_tr_b16 a[46:47], v27 offset:2592
  ds_read_b64_tr_b16 a[48:49], v27 offset:64
  ds_read_b64_tr_b16 a[50:51], v27 offset:2624
  ds_read_b64_tr_b16 a[52:53], v27 offset:96
  ds_read_b64_tr_b16 a[54:55], v27 offset:2656
  buffer_load_dwordx4 v[60:63], v30, s[60:63], s83 offen offset:2048 sc1
  ds_read_b64_tr_b16 a[56:57], v27 offset:128
  ds_read_b64_tr_b16 a[58:59], v27 offset:2688
  ds_read_b64_tr_b16 a[60:61], v27 offset:39936
  ds_read_b64_tr_b16 a[62:63], v27 offset:42496
  ds_read_b64_tr_b16 a[64:65], v27 offset:39968
  ds_read_b64_tr_b16 a[66:67], v27 offset:42528
  ds_read_b64_tr_b16 a[68:69], v27 offset:40000
  ds_read_b64_tr_b16 a[70:71], v27 offset:42560
  buffer_load_dwordx4 v[64:67], v18, s[60:63], s87 offen offset:0 sc1
  ds_read_b64_tr_b16 a[72:73], v27 offset:40032
  ds_read_b64_tr_b16 a[74:75], v27 offset:42592
  ds_read_b64_tr_b16 a[76:77], v27 offset:40064
  ds_read_b64_tr_b16 a[78:79], v27 offset:42624
  ds_read_b64_tr_b16 a[80:81], v19 offset:5120
  ds_read_b64_tr_b16 a[82:83], v19 offset:7680
  ds_read_b64_tr_b16 a[84:85], v19 offset:5152
  ds_read_b64_tr_b16 a[86:87], v19 offset:7712
  buffer_load_dwordx4 v[68:71], v18, s[60:63], s87 offen offset:2048 sc1
  ds_read_b64_tr_b16 a[88:89], v19 offset:5184
  ds_read_b64_tr_b16 a[90:91], v19 offset:7744
  ds_read_b64_tr_b16 a[92:93], v19 offset:5216
  ds_read_b64_tr_b16 a[94:95], v19 offset:7776
  ds_read_b64_tr_b16 a[96:97], v19 offset:5248
  ds_read_b64_tr_b16 a[98:99], v19 offset:7808
  ds_read_b64_tr_b16 a[100:101], v19 offset:45056
  ds_read_b64_tr_b16 a[102:103], v19 offset:47616
  ds_read_b64_tr_b16 a[104:105], v19 offset:45088
  ds_read_b64_tr_b16 a[106:107], v19 offset:47648
  ds_read_b64_tr_b16 a[108:109], v19 offset:45120
  ds_read_b64_tr_b16 a[110:111], v19 offset:47680
  ds_read_b64_tr_b16 a[112:113], v19 offset:45152
  ds_read_b64_tr_b16 a[114:115], v19 offset:47712
  ds_read_b64_tr_b16 a[116:117], v19 offset:45184
  ds_read_b64_tr_b16 a[118:119], v19 offset:47744
  ds_read_b64_tr_b16 a[120:121], v27 offset:5120
  ds_read_b64_tr_b16 a[122:123], v27 offset:7680
  ds_read_b64_tr_b16 a[124:125], v27 offset:5152
  ds_read_b64_tr_b16 a[126:127], v27 offset:7712
  ds_read_b64_tr_b16 a[128:129], v27 offset:5184
  ds_read_b64_tr_b16 a[130:131], v27 offset:7744
  v_lshrrev_b32 v12, 3, v0
  v_and_b32 v13, 7, v0
  v_lshlrev_b32 v14, 1, v3
  v_xor_b32 v13, v13, v14
  v_lshlrev_b32 v12, 12, v12
  v_lshl_add_u32 v8, v13, 4, v12
  v_add_u32 v9, 31744, v8
  v_add_u32 v10, 63488, v8
  v_add_u32 v11, 95232, v8
  s_add_u32 s36, s20, s4
  s_addc_u32 s37, s21, 0
  s_waitcnt vmcnt(6)
  v_max3_u32 v28, v32, v36, v40
  v_max_u32 v28, v28, v44
  v_cmp_eq_u32 vcc, -1, v28
  s_cbranch_vccz L_oko0_17
L_rtyo0_18:
  s_sub_u32 s75, s75, 1
  s_cbranch_scc1 L_exit
  buffer_load_dwordx4 v[32:35], v18, s[60:63], s82 offen offset:0 sc1
  buffer_load_dwordx4 v[36:39], v18, s[60:63], s82 offen offset:2048 sc1
  buffer_load_dwordx4 v[40:43], v30, s[60:63], s82 offen offset:0 sc1
  buffer_load_dwordx4 v[44:47], v30, s[60:63], s82 offen offset:2048 sc1
  s_waitcnt vmcnt(0)
  v_max3_u32 v28, v32, v36, v40
  v_max_u32 v28, v28, v44
  v_cmp_eq_u32 vcc, -1, v28
  s_cbranch_vccnz L_rtyo0_18
L_oko0_17:
  s_waitcnt lgkmcnt(15)
  v_mfma_f32_16x16x32_bf16 v[112:115], a[0:3], v[32:35], v[112:115]
  buffer_load_dwordx4 v[72:75], v30, s[60:63], s87 offen offset:0 sc1
  v_mfma_f32_16x16x32_bf16 v[116:119], a[4:7], v[32:35], v[116:119]
  s_nop 0
  ds_read_b64_tr_b16 a[132:133], v27 offset:5216
  ds_read_b64_tr_b16 a[134:135], v27 offset:7776
  v_mfma_f32_16x16x32_bf16 v[120:123], a[8:11], v[32:35], v[120:123]
  s_nop 0
  ds_read_b64_tr_b16 a[0:1], v27 offset:5248
  ds_read_b64_tr_b16 a[2:3], v27 offset:7808
  v_mfma_f32_16x16x32_bf16 v[124:127], a[12:15], v[32:35], v[124:127]
  s_nop 0
  ds_read_b64_tr_b16 a[4:5], v27 offset:45056
  ds_read_b64_tr_b16 a[6:7], v27 offset:47616
  v_mfma_f32_16x16x32_bf16 v[128:131], a[16:19], v[32:35], v[128:131]
  buffer_load_dwordx4 v[76:79], v30, s[60:63], s87 offen offset:2048 sc1
  v_mfma_f32_16x16x32_bf16 v[112:115], a[20:23], v[36:39], v[112:115]
  s_nop 0
  ds_read_b64_tr_b16 a[8:9], v27 offset:45088
  ds_read_b64_tr_b16 a[10:11], v27 offset:47648
  v_mfma_f32_16x16x32_bf16 v[116:119], a[24:27], v[36:39], v[116:119]
  s_nop 0
  ds_read_b64_tr_b16 a[12:13], v27 offset:45120
  ds_read_b64_tr_b16 a[14:15], v27 offset:47680
  v_mfma_f32_16x16x32_bf16 v[120:123], a[28:31], v[36:39], v[120:123]
  s_nop 0
  ds_read_b64_tr_b16 a[16:17], v27 offset:45152
  ds_read_b64_tr_b16 a[18:19], v27 offset:47712
  v_mfma_f32_16x16x32_bf16 v[124:127], a[32:35], v[36:39], v[124:127]
  buffer_load_dwordx4 v[80:83], v18, s[60:63], s95 offen offset:0 sc1
  v_mfma_f32_16x16x32_bf16 v[128:131], a[36:39], v[36:39], v[128:131]
  s_nop 0
  ds_read_b64_tr_b16 a[20:21], v27 offset:45184
  ds_read_b64_tr_b16 a[22:23], v27 offset:47744
  v_mfma_f32_16x16x32_bf16 v[112:115], a[40:43], v[40:43], v[112:115]
  s_nop 0
  ds_read_b64_tr_b16 a[24:25], v19 offset:10240
  ds_read_b64_tr_b16 a[26:27], v19 offset:12800
  v_mfma_f32_16x16x32_bf16 v[116:119], a[44:47], v[40:43], v[116:119]
  s_nop 0
  ds_read_b64_tr_b16 a[28:29], v19 offset:10272
  ds_read_b64_tr_b16 a[30:31], v19 offset:12832
  v_mfma_f32_16x16x32_bf16 v[120:123], a[48:51], v[40:43], v[120:123]
  buffer_load_dwordx4 v[84:87], v18, s[60:63], s95 offen offset:2048 sc1
  v_mfma_f32_16x16x32_bf16 v[124:127], a[52:55], v[40:43], v[124:127]
  s_nop 0
  ds_read_b64_tr_b16 a[32:33], v19 offset:10304
  ds_read_b64_tr_b16 a[34:35], v19 offset:12864
  v_mfma_f32_16x16x32_bf16 v[128:131], a[56:59], v[40:43], v[128:131]
  s_waitcnt vmcnt(6)
  v_max3_u32 v28, v48, v52, v56
  v_mfma_f32_16x16x32_bf16 v[112:115], a[60:63], v[44:47], v[112:115]
  v_max_u32 v28, v28, v60
  v_mfma_f32_16x16x32_bf16 v[116:119], a[64:67], v[44:47], v[116:119]
  v_cmp_eq_u32 vcc, -1, v28
  v_mfma_f32_16x16x32_bf16 v[120:123], a[68:71], v[44:47], v[120:123]
  s_nop 0
  ds_read_b64_tr_b16 a[36:37], v19 offset:10336
  ds_read_b64_tr_b16 a[38:39], v19 offset:12896
  v_mfma_f32_16x16x32_bf16 v[124:127], a[72:75], v[44:47], v[124:127]
  s_cbranch_vccnz L_rtyo1_20
L_oko1_19:
  v_mfma_f32_16x16x32_bf16 v[128:131], a[76:79], v[44:47], v[128:131]
  s_nop 0
  ds_read_b64_tr_b16 a[40:41], v19 offset:10368
  ds_read_b64_tr_b16 a[42:43], v19 offset:12928
  v_mfma_f32_16x16x32_bf16 v[112:115], a[80:83], v[48:51], v[112:115]
  buffer_load_dwordx4 v[88:91], v30, s[60:63], s95 offen offset:0 sc1
  v_mfma_f32_16x16x32_bf16 v[116:119], a[84:87], v[48:51], v[116:119]
  s_nop 0
  ds_read_b64_tr_b16 a[44:45], v19 offset:50176
  ds_read_b64_tr_b16 a[46:47], v19 offset:52736
  v_mfma_f32_16x16x32_bf16 v[120:123], a[88:91], v[48:51], v[120:123]
  s_nop 0
  ds_read_b64_tr_b16 a[48:49], v19 offset:50208
  ds_read_b64_tr_b16 a[50:51], v19 offset:52768
  v_mfma_f32_16x16x32_bf16 v[124:127], a[92:95], v[48:51], v[124:127]
  s_nop 0
  ds_read_b64_tr_b16 a[52:53], v19 offset:50240
  ds_read_b64_tr_b16 a[54:55], v19 offset:52800
  v_mfma_f32_16x16x32_bf16 v[128:131], a[96:99], v[48:51], v[128:131]
  s_waitcnt lgkmcnt(15)
  buffer_load_dwordx4 v[92:95], v30, s[60:63], s95 offen offset:2048 sc1
  v_mfma_f32_16x16x32_bf16 v[112:115], a[100:103], v[52:55], v[112:115]
  s_nop 0
  ds_read_b64_tr_b16 a[56:57], v19 offset:50272
  ds_read_b64_tr_b16 a[58:59], v19 offset:52832
  v_mfma_f32_16x16x32_bf16 v[116:119], a[104:107], v[52:55], v[116:119]
  s_nop 0
  ds_read_b64_tr_b16 a[60:61], v19 offset:50304
  ds_read_b64_tr_b16 a[62:63], v19 offset:52864
  v_mfma_f32_16x16x32_bf16 v[120:123], a[108:111], v[52:55], v[120:123]
  s_nop 0
  ds_read_b64_tr_b16 a[64:65], v27 offset:10240
  ds_read_b64_tr_b16 a[66:67], v27 offset:12800
  v_mfma_f32_16x16x32_bf16 v[124:127], a[112:115], v[52:55], v[124:127]
  buffer_load_dwordx4 v[96:99], v18, s[60:63], s89 offen offset:0 sc1
  v_mfma_f32_16x16x32_bf16 v[128:131], a[116:119], v[52:55], v[128:131]
  s_nop 0
  ds_read_b64_tr_b16 a[68:69], v27 offset:10272
  ds_read_b64_tr_b16 a[70:71], v27 offset:12832
  v_mfma_f32_16x16x32_bf16 v[112:115], a[120:123], v[56:59], v[112:115]
  s_nop 0
  ds_read_b64_tr_b16 a[72:73], v27 offset:10304
  ds_read_b64_tr_b16 a[74:75], v27 offset:12864
  v_mfma_f32_16x16x32_bf16 v[116:119], a[124:127], v[56:59], v[116:119]
  s_nop 0
  ds_read_b64_tr_b16 a[76:77], v27 offset:10336
  ds_read_b64_tr_b16 a[78:79], v27 offset:12896
  v_mfma_f32_16x16x32_bf16 v[120:123], a[128:131], v[56:59], v[120:123]
  buffer_load_dwordx4 v[100:103], v18, s[60:63], s89 offen offset:2048 sc1
  v_mfma_f32_16x16x32_bf16 v[124:127], a[132:135], v[56:59], v[124:127]
  s_nop 0
  ds_read_b64_tr_b16 a[80:81], v27 offset:10368
  ds_read_b64_tr_b16 a[82:83], v27 offset:12928
  v_mfma_f32_16x16x32_bf16 v[128:131], a[0:3], v[56:59], v[128:131]
  s_waitcnt vmcnt(6)
  v_max3_u32 v28, v64, v68, v72
  v_mfma_f32_16x16x32_bf16 v[112:115], a[4:7], v[60:63], v[112:115]
  v_max_u32 v28, v28, v76
  v_mfma_f32_16x16x32_bf16 v[116:119], a[8:11], v[60:63], v[116:119]
  v_cmp_eq_u32 vcc, -1, v28
  v_mfma_f32_16x16x32_bf16 v[120:123], a[12:15], v[60:63], v[120:123]
  s_nop 0
  ds_read_b64_tr_b16 a[84:85], v27 offset:50176
  ds_read_b64_tr_b16 a[86:87], v27 offset:52736
  v_mfma_f32_16x16x32_bf16 v[124:127], a[16:19], v[60:63], v[124:127]
  s_cbranch_vccnz L_rtyo2_22
L_oko2_21:
  v_mfma_f32_16x16x32_bf16 v[128:131], a[20:23], v[60:63], v[128:131]
  s_waitcnt lgkmcnt(15)
  ds_read_b64_tr_b16 a[88:89], v27 offset:50208
  ds_read_b64_tr_b16 a[90:91], v27 offset:52768
  v_mfma_f32_16x16x32_bf16 v[112:115], a[24:27], v[64:67], v[112:115]
  buffer_load_dwordx4 v[104:107], v30, s[60:63], s89 offen offset:0 sc1
  v_mfma_f32_16x16x32_bf16 v[116:119], a[28:31], v[64:67], v[116:119]
  s_nop 0
  ds_read_b64_tr_b16 a[92:93], v27 offset:50240
  ds_read_b64_tr_b16 a[94:95], v27 offset:52800
  v_mfma_f32_16x16x32_bf16 v[120:123], a[32:35], v[64:67], v[120:123]
  s_nop 0
  ds_read_b64_tr_b16 a[96:97], v27 offset:50272
  ds_read_b64_tr_b16 a[98:99], v27 offset:52832
  v_mfma_f32_16x16x32_bf16 v[124:127], a[36:39], v[64:67], v[124:127]
  s_nop 0
  ds_read_b64_tr_b16 a[100:101], v27 offset:50304
  ds_read_b64_tr_b16 a[102:103], v27 offset:52864
  v_mfma_f32_16x16x32_bf16 v[128:131], a[40:43], v[64:67], v[128:131]
  buffer_load_dwordx4 v[108:111], v30, s[60:63], s89 offen offset:2048 sc1
  v_mfma_f32_16x16x32_bf16 v[112:115], a[44:47], v[68:71], v[112:115]
  s_nop 0
  ds_read_b64_tr_b16 a[104:105], v19 offset:15360
  ds_read_b64_tr_b16 a[106:107], v19 offset:17920
  v_mfma_f32_16x16x32_bf16 v[116:119], a[48:51], v[68:71], v[116:119]
  s_nop 0
  ds_read_b64_tr_b16 a[108:109], v19 offset:15392
  ds_read_b64_tr_b16 a[110:111], v19 offset:17952
  v_mfma_f32_16x16x32_bf16 v[120:123], a[52:55], v[68:71], v[120:123]
  s_waitcnt lgkmcnt(15)
  ds_read_b64_tr_b16 a[112:113], v19 offset:15424
  ds_read_b64_tr_b16 a[114:115], v19 offset:17984
  v_mfma_f32_16x16x32_bf16 v[124:127], a[56:59], v[68:71], v[124:127]
  s_add_u32 m0, s94, 25600
  s_add_u32 s71, s11, 0
  buffer_load_dwordx4 v20, s[48:51], s71 offen  lds
  s_add_u32 m0, s94, 26624
  s_add_u32 s71, s11, 24576
  v_mfma_f32_16x16x32_bf16 v[128:131], a[60:63], v[68:71], v[128:131]
  s_nop 0
  ds_read_b64_tr_b16 a[116:117], v19 offset:15456
  ds_read_b64_tr_b16 a[118:119], v19 offset:18016
  v_mfma_f32_16x16x32_bf16 v[112:115], a[64:67], v[72:75], v[112:115]
  s_nop 0
  ds_read_b64_tr_b16 a[120:121], v19 offset:15488
  ds_read_b64_tr_b16 a[122:123], v19 offset:18048
  v_mfma_f32_16x16x32_bf16 v[116:119], a[68:71], v[72:75], v[116:119]
  s_nop 0
  ds_read_b64_tr_b16 a[124:125], v19 offset:55296
  ds_read_b64_tr_b16 a[126:127], v19 offset:57856
  v_mfma_f32_16x16x32_bf16 v[120:123], a[72:75], v[72:75], v[120:123]
  buffer_load_dwordx4 v20, s[48:51], s71 offen  lds
  s_add_u32 m0, s94, 27648
  s_add_u32 s71, s11, 49152
  v_mfma_f32_16x16x32_bf16 v[124:127], a[76:79], v[72:75], v[124:127]
  s_waitcnt lgkmcnt(15)
  ds_read_b64_tr_b16 a[128:129], v19 offset:55328
  ds_read_b64_tr_b16 a[130:131], v19 offset:57888
  v_mfma_f32_16x16x32_bf16 v[128:131], a[80:83], v[72:75], v[128:131]
  s_waitcnt vmcnt(6)
  v_max3_u32 v28, v80, v84, v88
  v_mfma_f32_16x16x32_bf16 v[112:115], a[84:87], v[76:79], v[112:115]
  v_max_u32 v28, v28, v92
  v_mfma_f32_16x16x32_bf16 v[116:119], a[88:91], v[76:79], v[116:119]
  v_cmp_eq_u32 vcc, -1, v28
  v_mfma_f32_16x16x32_bf16 v[120:123], a[92:95], v[76:79], v[120:123]
  s_waitcnt lgkmcnt(15)
  ds_read_b64_tr_b16 a[132:133], v19 offset:55360
  ds_read_b64_tr_b16 a[134:135], v19 offset:57920
  v_mfma_f32_16x16x32_bf16 v[124:127], a[96:99], v[76:79], v[124:127]
  s_waitcnt lgkmcnt(15)
  s_cbranch_vccnz L_rtyo3_24
L_oko3_23:
  ds_read_b64_tr_b16 a[0:1], v19 offset:55392
  ds_read_b64_tr_b16 a[2:3], v19 offset:57952
  v_mfma_f32_16x16x32_bf16 v[128:131], a[100:103], v[76:79], v[128:131]
  s_waitcnt lgkmcnt(15)
  ds_read_b64_tr_b16 a[4:5], v19 offset:55424
  ds_read_b64_tr_b16 a[6:7], v19 offset:57984
  v_mfma_f32_16x16x32_bf16 v[112:115], a[104:107], v[80:83], v[112:115]
  s_waitcnt lgkmcnt(15)
  buffer_load_dwordx4 v20, s[48:51], s71 offen  lds
  s_add_u32 m0, s94, 28672
  s_add_u32 s71, s11, 73728
  ds_read_b64_tr_b16 a[8:9], v27 offset:15360
  ds_read_b64_tr_b16 a[10:11], v27 offset:17920
  v_mfma_f32_16x16x32_bf16 v[116:119], a[108:111], v[80:83], v[116:119]
  s_waitcnt lgkmcnt(15)
  ds_read_b64_tr_b16 a[12:13], v27 offset:15392
  ds_read_b64_tr_b16 a[14:15], v27 offset:17952
  v_mfma_f32_16x16x32_bf16 v[120:123], a[112:115], v[80:83], v[120:123]
  s_waitcnt lgkmcnt(15)
  ds_read_b64_tr_b16 a[16:17], v27 offset:15424
  ds_read_b64_tr_b16 a[18:19], v27 offset:17984
  v_mfma_f32_16x16x32_bf16 v[124:127], a[116:119], v[80:83], v[124:127]
  s_waitcnt lgkmcnt(15)
  ds_read_b64_tr_b16 a[20:21], v27 offset:15456
  ds_read_b64_tr_b16 a[22:23], v27 offset:18016
  v_mfma_f32_16x16x32_bf16 v[128:131], a[120:123], v[80:83], v[128:131]
  s_waitcnt lgkmcnt(15)
  buffer_load_dwordx4 v20, s[48:51], s71 offen  lds
  s_add_u32 m0, s94, 29696
  s_add_u32 s71, s11, 98304
  ds_read_b64_tr_b16 a[24:25], v27 offset:15488
  ds_read_b64_tr_b16 a[26:27], v27 offset:18048
  v_mfma_f32_16x16x32_bf16 v[112:115], a[124:127], v[84:87], v[112:115]
  s_waitcnt lgkmcnt(15)
  ds_read_b64_tr_b16 a[28:29], v27 offset:55296
  ds_read_b64_tr_b16 a[30:31], v27 offset:57856
  v_mfma_f32_16x16x32_bf16 v[116:119], a[128:131], v[84:87], v[116:119]
  s_waitcnt lgkmcnt(15)
  ds_read_b64_tr_b16 a[32:33], v27 offset:55328
  ds_read_b64_tr_b16 a[34:35], v27 offset:57888
  v_mfma_f32_16x16x32_bf16 v[120:123], a[132:135], v[84:87], v[120:123]
  s_waitcnt lgkmcnt(15)
  ds_read_b64_tr_b16 a[36:37], v27 offset:55360
  ds_read_b64_tr_b16 a[38:39], v27 offset:57920
  v_mfma_f32_16x16x32_bf16 v[124:127], a[0:3], v[84:87], v[124:127]
  s_waitcnt lgkmcnt(15)
  buffer_load_dwordx4 v20, s[48:51], s71 offen  lds
  s_add_u32 m0, s94, 30720
  s_add_u32 s71, s11, 122880
  ds_read_b64_tr_b16 a[40:41], v27 offset:55392
  ds_read_b64_tr_b16 a[42:43], v27 offset:57952
  v_mfma_f32_16x16x32_bf16 v[128:131], a[4:7], v[84:87], v[128:131]
  s_waitcnt lgkmcnt(15)
  ds_read_b64_tr_b16 a[44:45], v27 offset:55424
  ds_read_b64_tr_b16 a[46:47], v27 offset:57984
  v_mfma_f32_16x16x32_bf16 v[112:115], a[8:11], v[88:91], v[112:115]
  s_waitcnt lgkmcnt(15)
  ds_read_b64_tr_b16 a[48:49], v19 offset:20480
  ds_read_b64_tr_b16 a[50:51], v19 offset:23040
  v_mfma_f32_16x16x32_bf16 v[116:119], a[12:15], v[88:91], v[116:119]
  s_waitcnt lgkmcnt(15)
  ds_read_b64_tr_b16 a[52:53], v19 offset:60416
  ds_read_b64_tr_b16 a[54:55], v19 offset:62976
  v_mfma_f32_16x16x32_bf16 v[120:123], a[16:19], v[88:91], v[120:123]
  s_waitcnt lgkmcnt(15)
  buffer_load_dwordx4 v20, s[48:51], s71 offen  lds
  ds_read_b64_tr_b16 a[56:57], v27 offset:20480
  ds_read_b64_tr_b16 a[58:59], v27 offset:23040
  v_mfma_f32_16x16x32_bf16 v[124:127], a[20:23], v[88:91], v[124:127]
  s_waitcnt lgkmcnt(15)
  ds_read_b64_tr_b16 a[60:61], v27 offset:60416
  ds_read_b64_tr_b16 a[62:63], v27 offset:62976
  v_mfma_f32_16x16x32_bf16 v[128:131], a[24:27], v[88:91], v[128:131]
  s_waitcnt lgkmcnt(15)
  s_waitcnt vmcnt(6)
  v_max3_u32 v28, v96, v100, v104
  ds_read_b64_tr_b16 a[64:65], v19 offset:20512
  ds_read_b64_tr_b16 a[66:67], v19 offset:23072
  v_mfma_f32_16x16x32_bf16 v[112:115], a[28:31], v[92:95], v[112:115]
  s_waitcnt lgkmcnt(15)
  v_max_u32 v28, v28, v108
  ds_read_b64_tr_b16 a[68:69], v19 offset:60448
  ds_read_b64_tr_b16 a[70:71], v19 offset:63008
  v_mfma_f32_16x16x32_bf16 v[116:119], a[32:35], v[92:95], v[116:119]
  s_waitcnt lgkmcnt(15)
  v_cmp_eq_u32 vcc, -1, v28
  ds_read_b64_tr_b16 a[72:73], v27 offset:20512
  ds_read_b64_tr_b16 a[74:75], v27 offset:23072
  v_mfma_f32_16x16x32_bf16 v[120:123], a[36:39], v[92:95], v[120:123]
  s_waitcnt lgkmcnt(15)
  ds_read_b64_tr_b16 a[76:77], v27 offset:60448
  ds_read_b64_tr_b16 a[78:79], v27 offset:63008
  v_mfma_f32_16x16x32_bf16 v[124:127], a[40:43], v[92:95], v[124:127]
  s_waitcnt lgkmcnt(15)
  s_cbranch_vccnz L_rtyo4_26
L_oko4_25:
  ds_read_b64_tr_b16 a[80:81], v19 offset:20544
  ds_read_b64_tr_b16 a[82:83], v19 offset:23104
  v_mfma_f32_16x16x32_bf16 v[128:131], a[44:47], v[92:95], v[128:131]
  s_waitcnt lgkmcnt(15)
  ds_read_b64_tr_b16 a[84:85], v19 offset:60480
  ds_read_b64_tr_b16 a[86:87], v19 offset:63040
  v_mfma_f32_16x16x32_bf16 v[112:115], a[48:51], v[96:99], v[112:115]
  s_waitcnt lgkmcnt(15)
  ds_read_b64_tr_b16 a[88:89], v27 offset:20544
  ds_read_b64_tr_b16 a[90:91], v27 offset:23104
  v_mfma_f32_16x16x32_bf16 v[112:115], a[52:55], v[100:103], v[112:115]
  s_waitcnt lgkmcnt(15)
  ds_read_b64_tr_b16 a[92:93], v27 offset:60480
  ds_read_b64_tr_b16 a[94:95], v27 offset:63040
  v_mfma_f32_16x16x32_bf16 v[112:115], a[56:59], v[104:107], v[112:115]
  s_waitcnt lgkmcnt(15)
  ds_read_b64_tr_b16 a[96:97], v19 offset:20576
  ds_read_b64_tr_b16 a[98:99], v19 offset:23136
  v_mfma_f32_16x16x32_bf16 v[112:115], a[60:63], v[108:111], v[112:115]
  s_waitcnt lgkmcnt(15)
  ds_read_b64_tr_b16 a[100:101], v19 offset:60512
  ds_read_b64_tr_b16 a[102:103], v19 offset:63072
  v_mfma_f32_16x16x32_bf16 v[116:119], a[64:67], v[96:99], v[116:119]
  s_waitcnt lgkmcnt(15)
  ds_read_b64_tr_b16 a[104:105], v27 offset:20576
  ds_read_b64_tr_b16 a[106:107], v27 offset:23136
  v_mfma_f32_16x16x32_bf16 v[116:119], a[68:71], v[100:103], v[116:119]
  s_waitcnt lgkmcnt(15)
  ds_read_b64_tr_b16 a[108:109], v27 offset:60512
  ds_read_b64_tr_b16 a[110:111], v27 offset:63072
  v_mfma_f32_16x16x32_bf16 v[116:119], a[72:75], v[104:107], v[116:119]
  s_waitcnt lgkmcnt(15)
  ds_read_b64_tr_b16 a[112:113], v19 offset:20608
  ds_read_b64_tr_b16 a[114:115], v19 offset:23168
  v_mfma_f32_16x16x32_bf16 v[116:119], a[76:79], v[108:111], v[116:119]
  s_waitcnt lgkmcnt(15)
  ds_read_b64_tr_b16 a[116:117], v19 offset:60544
  ds_read_b64_tr_b16 a[118:119], v19 offset:63104
  v_mfma_f32_16x16x32_bf16 v[120:123], a[80:83], v[96:99], v[120:123]
  s_waitcnt lgkmcnt(15)
  ds_read_b64_tr_b16 a[120:121], v27 offset:20608
  ds_read_b64_tr_b16 a[122:123], v27 offset:23168
  v_mfma_f32_16x16x32_bf16 v[120:123], a[84:87], v[100:103], v[120:123]
  s_waitcnt lgkmcnt(15)
  ds_read_b64_tr_b16 a[124:125], v27 offset:60544
  ds_read_b64_tr_b16 a[126:127], v27 offset:63104
  v_add_f32 v60, v112, v113
  v_mul_f32 v61, v112, v112
  v_mfma_f32_16x16x32_bf16 v[120:123], a[88:91], v[104:107], v[120:123]
  s_waitcnt lgkmcnt(15)
  v_fmac_f32 v61, v113, v113
  v_add_f32 v60, v60, v114
  v_mfma_f32_16x16x32_bf16 v[120:123], a[92:95], v[108:111], v[120:123]
  s_waitcnt lgkmcnt(14)
  v_fmac_f32 v61, v114, v114
  v_add_f32 v60, v60, v115
  v_mfma_f32_16x16x32_bf16 v[124:127], a[96:99], v[96:99], v[124:127]
  s_waitcnt lgkmcnt(12)
  v_fmac_f32 v61, v115, v115
  v_add_f32 v60, v60, v116
  v_mfma_f32_16x16x32_bf16 v[124:127], a[100:103], v[100:103], v[124:127]
  s_waitcnt lgkmcnt(10)
  v_fmac_f32 v61, v116, v116
  v_add_f32 v60, v60, v117
  v_mfma_f32_16x16x32_bf16 v[124:127], a[104:107], v[104:107], v[124:127]
  s_waitcnt lgkmcnt(8)
  v_fmac_f32 v61, v117, v117
  v_add_f32 v60, v60, v118
  v_mfma_f32_16x16x32_bf16 v[124:127], a[108:111], v[108:111], v[124:127]
  s_waitcnt lgkmcnt(6)
  v_fmac_f32 v61, v118, v118
  v_add_f32 v60, v60, v119
  v_mfma_f32_16x16x32_bf16 v[128:131], a[112:115], v[96:99], v[128:131]
  s_waitcnt lgkmcnt(4)
  v_fmac_f32 v61, v119, v119
  v_add_f32 v60, v60, v120
  v_mfma_f32_16x16x32_bf16 v[128:131], a[116:119], v[100:103], v[128:131]
  s_waitcnt lgkmcnt(2)
  v_fmac_f32 v61, v120, v120
  v_add_f32 v60, v60, v121
  v_mfma_f32_16x16x32_bf16 v[128:131], a[120:123], v[104:107], v[128:131]
  s_waitcnt lgkmcnt(0)
  v_fmac_f32 v61, v121, v121
  v_add_f32 v60, v60, v122
  v_mfma_f32_16x16x32_bf16 v[128:131], a[124:127], v[108:111], v[128:131]
  v_fmac_f32 v61, v122, v122
  v_add_f32 v60, v60, v123
  v_fmac_f32 v61, v123, v123
  v_add_f32 v60, v60, v124
  v_fmac_f32 v61, v124, v124
  v_add_f32 v60, v60, v125
  v_fmac_f32 v61, v125, v125
  v_add_f32 v60, v60, v126
  v_fmac_f32 v61, v126, v126
  v_add_f32 v60, v60, v127
  v_fmac_f32 v61, v127, v127
  v_add_f32 v60, v60, v128
  v_fmac_f32 v61, v128, v128
  v_add_f32 v60, v60, v129
  v_fmac_f32 v61, v129, v129
  v_add_f32 v60, v60, v130
  v_fmac_f32 v61, v130, v130
  v_add_f32 v60, v60, v131
  v_fmac_f32 v61, v131, v131
  s_nop 1
  v_permlane32_swap_b32 v60, v61
  v_add_f32 v60, v60, v61
  v_mov_b32 v61, v60
  s_nop 1
  v_permlane16_swap_b32 v60, v61
  v_add_f32 v60, v60, v61
  v_min_u32 v60, -2, v60
  s_cmp_lg_u32 s9, s8
  s_cbranch_scc1 L_wtst
  s_mov_b32 exec_lo, 0xffff
  s_mov_b32 exec_hi, 0xffff
  buffer_store_dword v60, v1, s[60:63], s85 offen
  s_mov_b64 exec, -1
L_wtdst:
  buffer_load_dwordx4 v[64:67], v1, s[60:63], s84 offen sc1
  ds_read_b64_tr_b16 a[72:73], v21 offset:31744
  ds_read_b64_tr_b16 a[74:75], v21 offset:32256
  ds_read_b64_tr_b16 a[76:77], v22 offset:31744
  ds_read_b64_tr_b16 a[78:79], v22 offset:32256
  ds_read_b64_tr_b16 a[80:81], v21 offset:33792
  ds_read_b64_tr_b16 a[82:83], v21 offset:34304
  ds_read_b64_tr_b16 a[84:85], v22 offset:33792
  ds_read_b64_tr_b16 a[86:87], v22 offset:34304
  ds_read_b64_tr_b16 a[88:89], v21 offset:35840
  ds_read_b64_tr_b16 a[90:91], v21 offset:36352
  ds_read_b64_tr_b16 a[92:93], v22 offset:35840
  ds_read_b64_tr_b16 a[94:95], v22 offset:36352
  ds_read_b64_tr_b16 a[96:97], v21 offset:37888
  ds_read_b64_tr_b16 a[98:99], v21 offset:38400
  ds_read_b64_tr_b16 a[100:101], v22 offset:37888
  ds_read_b64_tr_b16 a[102:103], v22 offset:38400
  v_mul_u32_u24 v76, 176, v2
  v_lshl_add_u32 v76, v3, 3, v76
  v_add_u32 v68, s94, v76
  v_bfe_u32 v76, v0, 2, 2
  v_and_b32 v77, 1, v3
  v_lshl_add_u32 v76, v77, 3, v76
  v_mul_u32_u24 v76, 176, v76
  v_lshrrev_b32 v78, 1, v3
  v_lshl_add_u32 v76, v78, 5, v76
  v_and_b32 v79, 3, v0
  v_lshl_add_u32 v76, v79, 3, v76
  v_add_u32 v69, s94, v76
  s_and_b32 s73, s68, 1
  s_mul_i32 s12, s68, 5
  s_add_u32 s12, s12, s73
  s_lshr_b32 s12, s12, 1
  v_lshlrev_b32 v77, 9, v77
  v_lshl_add_u32 v77, v2, 4, v77
  v_or_b32 v81, s73, v78
  v_add_u32 v78, s12, v78
  v_lshrrev_b32 v80, 1, v78
  v_and_b32 v79, 1, v78
  v_lshl_add_u32 v80, v80, 17, v77
  v_lshl_add_u32 v70, v79, 8, v80
  v_mad_u32_u24 v79, v81, 17, v78
  v_add_u32 v79, 2, v79
  v_lshrrev_b32 v80, 1, v79
  v_and_b32 v79, 1, v79
  v_lshl_add_u32 v80, v80, 17, v77
  v_lshl_add_u32 v71, v79, 8, v80
  v_add_u32 v79, 21, v78
  v_lshrrev_b32 v80, 1, v79
  v_and_b32 v79, 1, v79
  v_lshl_add_u32 v80, v80, 17, v77
  v_lshl_add_u32 v72, v79, 8, v80
  s_waitcnt vmcnt(2)
  ds_read_b64_tr_b16 a[104:105], v21 offset:25600
  ds_read_b64_tr_b16 a[106:107], v21 offset:26112
  ds_read_b64_tr_b16 a[108:109], v22 offset:25600
  ds_read_b64_tr_b16 a[110:111], v22 offset:26112
  ds_read_b64_tr_b16 a[112:113], v21 offset:27648
  ds_read_b64_tr_b16 a[114:115], v21 offset:28160
  ds_read_b64_tr_b16 a[116:117], v22 offset:27648
  ds_read_b64_tr_b16 a[118:119], v22 offset:28160
  ds_read_b64_tr_b16 a[120:121], v21 offset:29696
  ds_read_b64_tr_b16 a[122:123], v21 offset:30208
  ds_read_b64_tr_b16 a[124:125], v22 offset:29696
  ds_read_b64_tr_b16 a[126:127], v22 offset:30208
  s_waitcnt vmcnt(0)
  v_max3_u32 v28, v64, v65, v66
  v_max_u32 v28, v28, v67
  v_cmp_eq_u32 vcc, -1, v28
  s_cbranch_vccz L_okst_27
L_rtyst_28:
  s_sub_u32 s75, s75, 1
  s_cbranch_scc1 L_exit
  buffer_load_dwordx4 v[64:67], v1, s[60:63], s84 offen sc1
  s_waitcnt vmcnt(0)
  v_max3_u32 v28, v64, v65, v66
  v_max_u32 v28, v28, v67
  v_cmp_eq_u32 vcc, -1, v28
  s_cbranch_vccnz L_rtyst_28
L_okst_27:
  v_add_f32 v64, v64, v65
  v_add_f32 v66, v66, v67
  v_add_f32 v64, v64, v66
  v_mov_b32 v65, v64
  s_nop 1
  v_permlane16_swap_b32 v64, v65
  v_add_f32 v64, v64, v65
  v_mov_b32 v65, v64
  s_nop 1
  v_permlane32_swap_b32 v64, v65
  v_mul_f32 v64, 0x3acccccd, v64
  v_mul_f32 v65, 0x3acccccd, v65
  v_fma_f32 v65, -v64, v64, v65
  v_max_f32 v65, 0, v65
  v_add_f32 v66, 0x3727c5ac, v65
  v_fmac_f32 v65, 0x3727c5ac, v66
  v_rsq_f32 v62, v65
  s_nop 0
  v_mul_f32 v63, -v64, v62
  v_pk_fma_f32 v[32:33], v[112:113], v[62:63], v[62:63] op_sel:[0,0,1] op_sel_hi:[1,0,1]
  v_pk_fma_f32 v[34:35], v[114:115], v[62:63], v[62:63] op_sel:[0,0,1] op_sel_hi:[1,0,1]
  v_cvt_pk_bf16_f32 v32, v32, v33
  v_cvt_pk_bf16_f32 v33, v34, v35
  ds_write_b64 v68, v[32:33] offset:31744
  v_pk_fma_f32 v[36:37], v[116:117], v[62:63], v[62:63] op_sel:[0,0,1] op_sel_hi:[1,0,1]
  v_pk_fma_f32 v[38:39], v[118:119], v[62:63], v[62:63] op_sel:[0,0,1] op_sel_hi:[1,0,1]
  v_cvt_pk_bf16_f32 v36, v36, v37
  v_cvt_pk_bf16_f32 v37, v38, v39
  ds_write_b64 v68, v[36:37] offset:31776
  v_pk_fma_f32 v[40:41], v[120:121], v[62:63], v[62:63] op_sel:[0,0,1] op_sel_hi:[1,0,1]
  v_pk_fma_f32 v[42:43], v[122:123], v[62:63], v[62:63] op_sel:[0,0,1] op_sel_hi:[1,0,1]
  v_cvt_pk_bf16_f32 v40, v40, v41
  v_cvt_pk_bf16_f32 v41, v42, v43
  ds_write_b64 v68, v[40:41] offset:31808
  v_pk_fma_f32 v[44:45], v[124:125], v[62:63], v[62:63] op_sel:[0,0,1] op_sel_hi:[1,0,1]
  v_pk_fma_f32 v[46:47], v[126:127], v[62:63], v[62:63] op_sel:[0,0,1] op_sel_hi:[1,0,1]
  v_cvt_pk_bf16_f32 v44, v44, v45
  v_cvt_pk_bf16_f32 v45, v46, v47
  ds_write_b64 v68, v[44:45] offset:31840
  v_pk_fma_f32 v[48:49], v[128:129], v[62:63], v[62:63] op_sel:[0,0,1] op_sel_hi:[1,0,1]
  v_pk_fma_f32 v[50:51], v[130:131], v[62:63], v[62:63] op_sel:[0,0,1] op_sel_hi:[1,0,1]
  v_cvt_pk_bf16_f32 v48, v48, v49
  v_cvt_pk_bf16_f32 v49, v50, v51
  ds_write_b64 v68, v[48:49] offset:31872
  ds_read_b64_tr_b16 v[76:77], v69 offset:31744
  ds_read_b64_tr_b16 v[78:79], v69 offset:32448
  ds_read_b64_tr_b16 v[80:81], v69 offset:31808
  ds_read_b64_tr_b16 v[82:83], v69 offset:32512
  ds_read_b64_tr_b16 v[84:85], v69 offset:31872
  ds_read_b64_tr_b16 v[86:87], v69 offset:32576
  s_waitcnt lgkmcnt(4)
  v_min_u32 v76, -2, v76
  buffer_store_dwordx4 v[76:79], v70, s[60:63], s86 offen sc1
  s_waitcnt lgkmcnt(2)
  v_min_u32 v80, -2, v80
  buffer_store_dwordx4 v[80:83], v71, s[60:63], s86 offen sc1
  s_waitcnt lgkmcnt(0)
  v_min_u32 v84, -2, v84
  s_mov_b32 exec_hi, 0
  buffer_store_dwordx4 v[84:87], v72, s[60:63], s86 offen sc1
  s_mov_b32 exec_hi, -1
  s_add_u32 m0, s94, 37888
  s_add_u32 s71, s11, 147456
  buffer_load_dwordx4 v20, s[48:51], s71 offen  lds
  s_add_u32 m0, s94, 38912
  s_add_u32 s71, s11, 172032
  buffer_load_dwordx4 v20, s[48:51], s71 offen  lds
  s_barrier
  s_cmp_gt_u32 s66, 29
  s_cbranch_scc1 L_p3idle
  s_add_u32 m0, s94, 0
  s_nop 0
  global_load_lds_dwordx4 v8, s[36:37] offset:0
  s_lshl_b32 s72, s69, 17
  s_lshl_b32 s73, s64, 15
  s_add_u32 s72, s72, s73
  global_load_lds_dwordx4 v9, s[36:37] offset:1024
  s_add_u32 s78, s72, 3801088
  s_add_u32 s79, s78, 1310720
  v_bfe_u32 v96, v0, 4, 1
  global_load_lds_dwordx4 v10, s[36:37] offset:2048
  v_mul_u32_u24 v96, 49152, v96
  v_lshrrev_b32 v97, 5, v0
  v_lshl_add_u32 v96, v97, 8, v96
  global_load_lds_dwordx4 v11, s[36:37] offset:3072
  s_add_u32 m0, s94, 4096
  s_add_u32 s36, s36, 131072
  s_addc_u32 s37, s37, 0
  v_lshl_add_u32 v16, v2, 4, v96
  s_mul_i32 s72, s69, 192
  s_lshl_b32 s73, s70, 2
  global_load_lds_dwordx4 v8, s[36:37] offset:0
  s_add_u32 s72, s72, s73
  s_add_u32 s72, s72, s64
  s_lshl_b32 s72, s72, 9
  global_load_lds_dwordx4 v9, s[36:37] offset:1024
  s_add_u32 s30, s72, 6422528
  v_lshlrev_b32 v148, 16, v180
  v_and_b32 v149, s76, v180
  global_load_lds_dwordx4 v10, s[36:37] offset:2048
  v_mov_b64 v[156:157], 0
  v_lshlrev_b32 v150, 16, v181
  v_and_b32 v151, s76, v181
  global_load_lds_dwordx4 v11, s[36:37] offset:3072
  s_add_u32 m0, s94, 8192
  s_add_u32 s36, s36, 131072
  s_addc_u32 s37, s37, 0
  v_mov_b64 v[158:159], 0
  v_lshlrev_b32 v152, 16, v182
  v_and_b32 v153, s76, v182
  global_load_lds_dwordx4 v8, s[36:37] offset:0
  v_mov_b64 v[160:161], 0
  v_lshlrev_b32 v154, 16, v183
  v_and_b32 v155, s76, v183
  global_load_lds_dwordx4 v9, s[36:37] offset:1024
  v_mov_b64 v[162:163], 0
  s_mov_b32 s90, 0xbdd2d3e8
  v_mov_b32 v29, 0xc0135761
  global_load_lds_dwordx4 v10, s[36:37] offset:2048
  global_load_lds_dwordx4 v11, s[36:37] offset:3072
  s_add_u32 m0, s94, 12288
  s_add_u32 s36, s36, 131072
  s_addc_u32 s37, s37, 0
  s_waitcnt vmcnt(14)
  s_add_u32 s72, s5, 0
  s_and_b32 s72, s72, 7
  s_lshl_b32 s72, s72, 12
  s_add_u32 s72, s72, s78
  buffer_load_dwordx4 v[32:35], v1, s[60:63], s72 offen offset:0 sc1
  s_add_u32 s71, s5, 1
  buffer_load_dwordx4 v[36:39], v1, s[60:63], s72 offen offset:1024 sc1
  s_and_b32 s71, s71, 7
  buffer_load_dwordx4 v[40:43], v1, s[60:63], s72 offen offset:2048 sc1
  s_lshl_b32 s71, s71, 12
  buffer_load_dwordx4 v[44:47], v1, s[60:63], s72 offen offset:3072 sc1
  s_add_u32 s71, s71, s78
  buffer_load_dwordx4 v[48:51], v1, s[60:63], s71 offen offset:0 sc1
  s_add_u32 s72, s5, 2
  buffer_load_dwordx4 v[52:55], v1, s[60:63], s71 offen offset:1024 sc1
  s_and_b32 s72, s72, 7
  buffer_load_dwordx4 v[56:59], v1, s[60:63], s71 offen offset:2048 sc1
  s_lshl_b32 s72, s72, 12
  buffer_load_dwordx4 v[60:63], v1, s[60:63], s71 offen offset:3072 sc1
  s_add_u32 s72, s72, s78
  buffer_load_dwordx4 v[64:67], v1, s[60:63], s72 offen offset:0 sc1
  s_add_u32 s71, s5, 3
  buffer_load_dwordx4 v[68:71], v1, s[60:63], s72 offen offset:1024 sc1
  s_and_b32 s71, s71, 7
  buffer_load_dwordx4 v[72:75], v1, s[60:63], s72 offen offset:2048 sc1
  s_lshl_b32 s71, s71, 12
  buffer_load_dwordx4 v[76:79], v1, s[60:63], s72 offen offset:3072 sc1
  s_add_u32 s71, s71, s78
  buffer_load_dwordx4 v[80:83], v1, s[60:63], s71 offen offset:0 sc1
  s_add_u32 s72, s5, 4
  buffer_load_dwordx4 v[84:87], v1, s[60:63], s71 offen offset:1024 sc1
  s_and_b32 s72, s72, 7
  s_waitcnt vmcnt(26)
  ds_read_b64_tr_b16 a[128:129], v21 offset:37888
  ds_read_b64_tr_b16 a[130:131], v21 offset:38400
  ds_read_b64_tr_b16 a[132:133], v22 offset:37888
  ds_read_b64_tr_b16 a[134:135], v22 offset:38400
  s_waitcnt vmcnt(10)
  v_max3_u32 v28, v32, v36, v40
  v_max_u32 v28, v28, v44
  v_cmp_eq_u32 vcc, -1, v28
  s_cbranch_vccz L_okhn0_29
L_rtyhn0_30:
  s_sub_u32 s75, s75, 1
  s_cbranch_scc1 L_exit
  s_sleep 1
  s_add_u32 s7, s5, 0
  s_and_b32 s7, s7, 7
  s_lshl_b32 s7, s7, 12
  s_add_u32 s7, s7, s78
  buffer_load_dwordx4 v[32:35], v1, s[60:63], s7 offen offset:0 sc1
  buffer_load_dwordx4 v[36:39], v1, s[60:63], s7 offen offset:1024 sc1
  buffer_load_dwordx4 v[40:43], v1, s[60:63], s7 offen offset:2048 sc1
  buffer_load_dwordx4 v[44:47], v1, s[60:63], s7 offen offset:3072 sc1
  s_waitcnt vmcnt(0)
  v_max3_u32 v28, v32, v36, v40
  v_max_u32 v28, v28, v44
  v_cmp_eq_u32 vcc, -1, v28
  s_cbranch_vccnz L_rtyhn0_30
L_okhn0_29:
  v_mfma_f32_32x32x16_bf16 a[0:15], a[140:143], v[32:35], 0
  buffer_load_dwordx4 v[88:91], v1, s[60:63], s71 offen offset:2048 sc1
  s_lshl_b32 s72, s72, 12
  v_mfma_f32_32x32x16_bf16 v[132:147], a[136:139], v[32:35], v[148:163]
  v_mfma_f32_32x32x16_bf16 a[0:15], a[148:151], v[36:39], a[0:15]
  buffer_load_dwordx4 v[92:95], v1, s[60:63], s71 offen offset:3072 sc1
  s_add_u32 s72, s72, s78
  v_mfma_f32_32x32x16_bf16 v[132:147], a[144:147], v[36:39], v[132:147]
  v_bfe_u32 v96, v0, 2, 3
  v_lshrrev_b32 v97, 1, v96
  v_lshrrev_b32 v98, 5, v0
  v_mfma_f32_32x32x16_bf16 a[0:15], a[156:159], v[40:43], a[0:15]
  buffer_load_dwordx4 v[32:35], v1, s[60:63], s72 offen offset:0 sc1
  s_add_u32 s71, s5, 5
  v_mfma_f32_32x32x16_bf16 v[132:147], a[152:155], v[40:43], v[132:147]
  v_lshlrev_b32 v98, 11, v98
  v_lshl_add_u32 v98, v96, 7, v98
  v_and_b32 v99, 3, v0
  v_mfma_f32_32x32x16_bf16 a[0:15], a[164:167], v[44:47], a[0:15]
  buffer_load_dwordx4 v[36:39], v1, s[60:63], s72 offen offset:1024 sc1
  s_and_b32 s71, s71, 7
  s_waitcnt vmcnt(10)
  v_max3_u32 v28, v48, v52, v56
  v_max_u32 v28, v28, v60
  v_cmp_eq_u32 vcc, -1, v28
  v_mfma_f32_32x32x16_bf16 v[132:147], a[160:163], v[44:47], v[132:147]
  v_lshl_add_u32 v98, v99, 3, v98
  v_add_u32 v98, s94, v98
  v_xor_b32 v97, s64, v97
  s_cbranch_vccnz L_rtyhn1_32
L_okhn1_31:
  v_mfma_f32_32x32x16_bf16 a[0:15], a[172:175], v[48:51], a[0:15]
  buffer_load_dwordx4 v[40:43], v1, s[60:63], s72 offen offset:2048 sc1
  s_lshl_b32 s71, s71, 12
  v_mfma_f32_32x32x16_bf16 v[132:147], a[168:171], v[48:51], v[132:147]
  v_xor_b32 v99, 0, v97
  v_lshl_add_u32 v12, v99, 5, v98
  v_xor_b32 v99, 1, v97
  v_mfma_f32_32x32x16_bf16 a[0:15], a[180:183], v[52:55], a[0:15]
  buffer_load_dwordx4 v[44:47], v1, s[60:63], s72 offen offset:3072 sc1
  s_add_u32 s71, s71, s78
  v_mfma_f32_32x32x16_bf16 v[132:147], a[176:179], v[52:55], v[132:147]
  v_lshl_add_u32 v13, v99, 5, v98
  v_xor_b32 v99, 2, v97
  v_lshl_add_u32 v14, v99, 5, v98
  v_mfma_f32_32x32x16_bf16 a[0:15], a[188:191], v[56:59], a[0:15]
  buffer_load_dwordx4 v[48:51], v1, s[60:63], s71 offen offset:0 sc1
  s_add_u32 s72, s5, 6
  v_mfma_f32_32x32x16_bf16 v[132:147], a[184:187], v[56:59], v[132:147]
  v_xor_b32 v99, 3, v97
  v_lshl_add_u32 v15, v99, 5, v98
  s_mul_i32 s73, s12, 48
  v_mfma_f32_32x32x16_bf16 a[0:15], a[196:199], v[60:63], a[0:15]
  buffer_load_dwordx4 v[52:55], v1, s[60:63], s71 offen offset:1024 sc1
  s_and_b32 s72, s72, 7
  s_waitcnt vmcnt(10)
  v_max3_u32 v28, v64, v68, v72
  v_max_u32 v28, v28, v76
  v_cmp_eq_u32 vcc, -1, v28
  v_mfma_f32_32x32x16_bf16 v[132:147], a[192:195], v[60:63], v[132:147]
  s_mul_i32 s74, s64, 12
  s_add_u32 s73, s73, s74
  s_lshl_b32 s73, s73, 10
  s_cbranch_vccnz L_rtyhn2_34
L_okhn2_33:
  v_mfma_f32_32x32x16_bf16 a[0:15], a[204:207], v[64:67], a[0:15]
  buffer_load_dwordx4 v[56:59], v1, s[60:63], s71 offen offset:2048 sc1
  s_lshl_b32 s72, s72, 12
  v_mfma_f32_32x32x16_bf16 v[132:147], a[200:203], v[64:67], v[132:147]
  s_add_u32 s73, s73, 6426624
  s_and_b32 s74, s68, 1
  s_mul_i32 s74, s74, 835584
  v_mfma_f32_32x32x16_bf16 a[0:15], a[212:215], v[68:71], a[0:15]
  buffer_load_dwordx4 v[60:63], v1, s[60:63], s71 offen offset:3072 sc1
  s_add_u32 s72, s72, s78
  v_mfma_f32_32x32x16_bf16 v[132:147], a[208:211], v[68:71], v[132:147]
  s_add_u32 s74, s74, 98304
  s_add_u32 s38, s28, s73
  s_addc_u32 s39, s29, 0
  s_add_u32 s40, s38, 49152
  s_addc_u32 s41, s39, 0
  v_mfma_f32_32x32x16_bf16 a[0:15], a[220:223], v[72:75], a[0:15]
  buffer_load_dwordx4 v[64:67], v1, s[60:63], s72 offen offset:0 sc1
  s_add_u32 s71, s5, 7
  v_mfma_f32_32x32x16_bf16 v[132:147], a[216:219], v[72:75], v[132:147]
  s_add_u32 s42, s38, s74
  s_addc_u32 s43, s39, 0
  s_add_u32 s44, s38, 983040
  s_addc_u32 s45, s39, 0
  s_add_u32 s46, s38, 1032192
  s_addc_u32 s47, s39, 0
  v_mfma_f32_32x32x16_bf16 a[0:15], a[228:231], v[76:79], a[0:15]
  buffer_load_dwordx4 v[68:71], v1, s[60:63], s72 offen offset:1024 sc1
  s_and_b32 s71, s71, 7
  s_waitcnt vmcnt(10)
  v_max3_u32 v28, v80, v84, v88
  v_max_u32 v28, v28, v92
  v_cmp_eq_u32 vcc, -1, v28
  v_mfma_f32_32x32x16_bf16 v[132:147], a[224:227], v[76:79], v[132:147]
  v_add_u32 v30, 8192, v1
  v_mul_u32_u24 v96, 144, v2
  v_lshl_add_u32 v96, v3, 3, v96
  s_cbranch_vccnz L_rtyhn3_36
L_okhn3_35:
  v_mfma_f32_32x32x16_bf16 a[0:15], a[236:239], v[80:83], a[0:15]
  buffer_load_dwordx4 v[72:75], v1, s[60:63], s72 offen offset:2048 sc1
  s_lshl_b32 s71, s71, 12
  v_mfma_f32_32x32x16_bf16 v[132:147], a[232:235], v[80:83], v[132:147]
  v_add_u32 v17, s94, v96
  v_lshrrev_b32 v96, 3, v0
  v_and_b32 v97, 7, v0
  v_mfma_f32_32x32x16_bf16 a[0:15], a[244:247], v[84:87], a[0:15]
  buffer_load_dwordx4 v[76:79], v1, s[60:63], s72 offen offset:3072 sc1
  s_add_u32 s71, s71, s78
  v_mfma_f32_32x32x16_bf16 v[132:147], a[240:243], v[84:87], v[132:147]
  v_lshlrev_b32 v97, 4, v97
  v_mul_u32_u24 v98, 144, v96
  v_add3_u32 v18, v98, v97, s94
  v_mfma_f32_32x32x16_bf16 a[0:15], a[252:255], v[88:91], a[0:15]
  buffer_load_dwordx4 v[80:83], v1, s[60:63], s71 offen offset:0 sc1
  s_add_u32 s72, s5, 8
  v_mfma_f32_32x32x16_bf16 v[132:147], a[248:251], v[88:91], v[132:147]
  v_mul_u32_u24 v98, 1280, v96
  v_add_u32 v19, v98, v97
  v_mul_u32_u24 v96, 1280, v2
  v_mfma_f32_32x32x16_bf16 a[0:15], v[188:191], v[92:95], a[0:15]
  buffer_load_dwordx4 v[84:87], v1, s[60:63], s71 offen offset:1024 sc1
  s_and_b32 s72, s72, 7
  s_waitcnt vmcnt(10)
  v_max3_u32 v28, v32, v36, v40
  v_max_u32 v28, v28, v44
  v_cmp_eq_u32 vcc, -1, v28
  v_mfma_f32_32x32x16_bf16 v[132:147], v[184:187], v[92:95], v[132:147]
  v_lshl_add_u32 v27, v3, 3, v96
  s_add_u32 s13, s10, 10240
  v_lshlrev_b32 v31, 16, v31
  s_cbranch_vccnz L_rtyhn4_38
L_okhn4_37:
  v_mfma_f32_32x32x16_bf16 a[0:15], v[196:199], v[32:35], a[0:15]
  buffer_load_dwordx4 v[88:91], v1, s[60:63], s71 offen offset:2048 sc1
  s_lshl_b32 s72, s72, 12
  v_mfma_f32_32x32x16_bf16 v[132:147], v[192:195], v[32:35], v[132:147]
  v_add_f32 v112, v112, v31
  v_add_f32 v113, v113, v31
  v_add_f32 v114, v114, v31
  v_mfma_f32_32x32x16_bf16 a[0:15], v[204:207], v[36:39], a[0:15]
  buffer_load_dwordx4 v[92:95], v1, s[60:63], s71 offen offset:3072 sc1
  s_add_u32 s72, s72, s79
  v_mfma_f32_32x32x16_bf16 v[132:147], v[200:203], v[36:39], v[132:147]
  v_add_f32 v115, v115, v31
  v_add_f32 v116, v116, v31
  v_add_f32 v117, v117, v31
  v_mfma_f32_32x32x16_bf16 a[0:15], v[212:215], v[40:43], a[0:15]
  buffer_load_dwordx4 v[32:35], v1, s[60:63], s72 offen offset:0 sc1
  s_add_u32 s71, s5, 9
  v_mfma_f32_32x32x16_bf16 v[132:147], v[208:211], v[40:43], v[132:147]
  v_add_f32 v118, v118, v31
  v_add_f32 v119, v119, v31
  v_add_f32 v120, v120, v31
  v_mfma_f32_32x32x16_bf16 a[0:15], v[220:223], v[44:47], a[0:15]
  buffer_load_dwordx4 v[36:39], v1, s[60:63], s72 offen offset:1024 sc1
  s_and_b32 s71, s71, 7
  s_waitcnt vmcnt(10)
  v_max3_u32 v28, v48, v52, v56
  v_max_u32 v28, v28, v60
  v_cmp_eq_u32 vcc, -1, v28
  v_mfma_f32_32x32x16_bf16 v[132:147], v[216:219], v[44:47], v[132:147]
  v_add_f32 v121, v121, v31
  v_add_f32 v122, v122, v31
  v_add_f32 v123, v123, v31
  s_cbranch_vccnz L_rtyhn5_40
L_okhn5_39:
  v_mfma_f32_32x32x16_bf16 a[0:15], v[228:231], v[48:51], a[0:15]
  buffer_load_dwordx4 v[40:43], v1, s[60:63], s72 offen offset:2048 sc1
  s_lshl_b32 s71, s71, 12
  v_mfma_f32_32x32x16_bf16 v[132:147], v[224:227], v[48:51], v[132:147]
  v_add_f32 v124, v124, v31
  v_add_f32 v125, v125, v31
  v_add_f32 v126, v126, v31
  v_mfma_f32_32x32x16_bf16 a[0:15], v[236:239], v[52:55], a[0:15]
  buffer_load_dwordx4 v[44:47], v1, s[60:63], s72 offen offset:3072 sc1
  s_add_u32 s71, s71, s79
  v_mfma_f32_32x32x16_bf16 v[132:147], v[232:235], v[52:55], v[132:147]
  v_add_f32 v127, v127, v31
  v_add_f32 v128, v128, v31
  v_add_f32 v129, v129, v31
  v_mfma_f32_32x32x16_bf16 a[0:15], v[244:247], v[56:59], a[0:15]
  buffer_load_dwordx4 v[48:51], v1, s[60:63], s71 offen offset:0 sc1
  s_add_u32 s72, s5, 10
  v_mfma_f32_32x32x16_bf16 v[132:147], v[240:243], v[56:59], v[132:147]
  v_add_f32 v130, v130, v31
  v_add_f32 v131, v131, v31
  v_mfma_f32_32x32x16_bf16 a[0:15], v[252:255], v[60:63], a[0:15]
  buffer_load_dwordx4 v[52:55], v1, s[60:63], s71 offen offset:1024 sc1
  s_and_b32 s72, s72, 7
  s_waitcnt vmcnt(10)
  v_max3_u32 v28, v64, v68, v72
  v_max_u32 v28, v28, v76
  v_cmp_eq_u32 vcc, -1, v28
  v_mfma_f32_32x32x16_bf16 v[132:147], v[248:251], v[60:63], v[132:147]
  s_cbranch_vccnz L_rtyhn6_42
L_okhn6_41:
  v_mfma_f32_32x32x16_bf16 a[0:15], a[76:79], v[64:67], a[0:15]
  buffer_load_dwordx4 v[56:59], v1, s[60:63], s71 offen offset:2048 sc1
  s_lshl_b32 s72, s72, 12
  v_mfma_f32_32x32x16_bf16 v[132:147], a[72:75], v[64:67], v[132:147]
  s_waitcnt lgkmcnt(0)
  s_barrier
  v_mfma_f32_32x32x16_bf16 a[0:15], a[84:87], v[68:71], a[0:15]
  buffer_load_dwordx4 v[60:63], v1, s[60:63], s71 offen offset:3072 sc1
  s_add_u32 s72, s72, s79
  v_mfma_f32_32x32x16_bf16 v[132:147], a[80:83], v[68:71], v[132:147]
  v_mfma_f32_32x32x16_bf16 a[0:15], a[92:95], v[72:75], a[0:15]
  buffer_load_dwordx4 v[64:67], v1, s[60:63], s72 offen offset:0 sc1
  s_add_u32 s71, s5, 11
  v_mfma_f32_32x32x16_bf16 v[132:147], a[88:91], v[72:75], v[132:147]
  v_mfma_f32_32x32x16_bf16 a[0:15], a[100:103], v[76:79], a[0:15]
  buffer_load_dwordx4 v[68:71], v1, s[60:63], s72 offen offset:1024 sc1
  s_and_b32 s71, s71, 7
  s_waitcnt vmcnt(10)
  v_max3_u32 v28, v80, v84, v88
  v_max_u32 v28, v28, v92
  v_cmp_eq_u32 vcc, -1, v28
  v_mfma_f32_32x32x16_bf16 v[132:147], a[96:99], v[76:79], v[132:147]
  s_cbranch_vccnz L_rtyhn7_44
L_okhn7_43:
  v_mfma_f32_32x32x16_bf16 a[0:15], a[108:111], v[80:83], a[0:15]
  buffer_load_dwordx4 v[72:75], v1, s[60:63], s72 offen offset:2048 sc1
  s_lshl_b32 s71, s71, 12
  v_mfma_f32_32x32x16_bf16 v[132:147], a[104:107], v[80:83], v[132:147]
  v_mfma_f32_32x32x16_bf16 a[0:15], a[116:119], v[84:87], a[0:15]
  buffer_load_dwordx4 v[76:79], v1, s[60:63], s72 offen offset:3072 sc1
  s_add_u32 s71, s71, s79
  v_mfma_f32_32x32x16_bf16 v[132:147], a[112:115], v[84:87], v[132:147]
  v_mfma_f32_32x32x16_bf16 a[0:15], a[124:127], v[88:91], a[0:15]
  buffer_load_dwordx4 v[80:83], v1, s[60:63], s71 offen offset:0 sc1
  s_add_u32 s72, s5, 12
  v_mfma_f32_32x32x16_bf16 v[132:147], a[120:123], v[88:91], v[132:147]
  v_mfma_f32_32x32x16_bf16 a[0:15], a[132:135], v[92:95], a[0:15]
  buffer_load_dwordx4 v[84:87], v1, s[60:63], s71 offen offset:1024 sc1
  s_and_b32 s72, s72, 7
  s_waitcnt vmcnt(10)
  v_max3_u32 v28, v32, v36, v40
  v_max_u32 v28, v28, v44
  v_cmp_eq_u32 vcc, -1, v28
  v_mfma_f32_32x32x16_bf16 v[132:147], a[128:131], v[92:95], v[132:147]
  s_cbranch_vccnz L_rtyhn8_46
L_okhn8_45:
  v_mfma_f32_32x32x16_bf16 a[16:31], a[140:143], v[32:35], 0
  buffer_load_dwordx4 v[88:91], v1, s[60:63], s71 offen offset:2048 sc1
  s_lshl_b32 s72, s72, 12
  v_mfma_f32_32x32x16_bf16 v[148:163], a[136:139], v[32:35], v[148:163]
  v_mfma_f32_32x32x16_bf16 a[16:31], a[148:151], v[36:39], a[16:31]
  buffer_load_dwordx4 v[92:95], v1, s[60:63], s71 offen offset:3072 sc1
  s_add_u32 s72, s72, s79
  v_mfma_f32_32x32x16_bf16 v[148:163], a[144:147], v[36:39], v[148:163]
  ds_write_b128 v24, a[0:3] offset:2048
  v_mfma_f32_32x32x16_bf16 a[16:31], a[156:159], v[40:43], a[16:31]
  buffer_load_dwordx4 v[32:35], v1, s[60:63], s72 offen offset:0 sc1
  s_add_u32 s71, s5, 13
  ds_read_b64_tr_b16 a[136:137], v12 offset:0
  ds_read_b64_tr_b16 a[138:139], v12 offset:1024
  ds_read_b64_tr_b16 a[140:141], v13 offset:0
  v_mfma_f32_32x32x16_bf16 v[148:163], a[152:155], v[40:43], v[148:163]
  ds_write_b128 v24, a[4:7] offset:3072
  ds_read_b64_tr_b16 a[142:143], v13 offset:1024
  v_mfma_f32_32x32x16_bf16 a[16:31], a[164:167], v[44:47], a[16:31]
  buffer_load_dwordx4 v[36:39], v1, s[60:63], s72 offen offset:1024 sc1
  s_and_b32 s71, s71, 7
  s_waitcnt vmcnt(10)
  v_max3_u32 v28, v48, v52, v56
  v_max_u32 v28, v28, v60
  v_cmp_eq_u32 vcc, -1, v28
  v_mfma_f32_32x32x16_bf16 v[148:163], a[160:163], v[44:47], v[148:163]
  ds_write_b128 v25, a[8:11] offset:4096
  s_cbranch_vccnz L_rtyhn9_48
L_okhn9_47:
  v_mfma_f32_32x32x16_bf16 a[16:31], a[172:175], v[48:51], a[16:31]
  buffer_load_dwordx4 v[40:43], v1, s[60:63], s72 offen offset:2048 sc1
  s_lshl_b32 s71, s71, 12
  ds_read_b64_tr_b16 a[144:145], v14 offset:0
  ds_read_b64_tr_b16 a[146:147], v14 offset:1024
  ds_read_b64_tr_b16 a[148:149], v15 offset:0
  v_mfma_f32_32x32x16_bf16 v[148:163], a[168:171], v[48:51], v[148:163]
  ds_write_b128 v25, a[12:15] offset:5120
  ds_read_b64_tr_b16 a[150:151], v15 offset:1024
  v_mfma_f32_32x32x16_bf16 a[16:31], a[180:183], v[52:55], a[16:31]
  buffer_load_dwordx4 v[44:47], v1, s[60:63], s72 offen offset:3072 sc1
  s_add_u32 s71, s71, s79
  ds_read_b64_tr_b16 a[152:153], v12 offset:4096
  ds_read_b64_tr_b16 a[154:155], v12 offset:5120
  ds_read_b64_tr_b16 a[156:157], v13 offset:4096
  v_mfma_f32_32x32x16_bf16 v[148:163], a[176:179], v[52:55], v[148:163]
  ds_write_b128 v23, v[140:143] offset:0
  ds_read_b64_tr_b16 a[158:159], v13 offset:5120
  v_mfma_f32_32x32x16_bf16 a[16:31], a[188:191], v[56:59], a[16:31]
  buffer_load_dwordx4 v[48:51], v1, s[60:63], s71 offen offset:0 sc1
  s_add_u32 s72, s5, 14
  ds_read_b64_tr_b16 a[160:161], v14 offset:4096
  ds_read_b64_tr_b16 a[162:163], v14 offset:5120
  ds_read_b64_tr_b16 a[164:165], v15 offset:4096
  v_mfma_f32_32x32x16_bf16 v[148:163], a[184:187], v[56:59], v[148:163]
  ds_write_b128 v23, v[144:147] offset:1024
  ds_read_b64_tr_b16 a[166:167], v15 offset:5120
  v_mfma_f32_32x32x16_bf16 a[16:31], a[196:199], v[60:63], a[16:31]
  buffer_load_dwordx4 v[52:55], v1, s[60:63], s71 offen offset:1024 sc1
  s_and_b32 s72, s72, 7
  s_waitcnt vmcnt(10)
  v_max3_u32 v28, v64, v68, v72
  v_max_u32 v28, v28, v76
  v_cmp_eq_u32 vcc, -1, v28
  v_mfma_f32_32x32x16_bf16 v[148:163], a[192:195], v[60:63], v[148:163]
  s_waitcnt lgkmcnt(0)
  s_barrier
  s_cbranch_vccnz L_rtyhn10_50
L_okhn10_49:
  v_mfma_f32_32x32x16_bf16 a[16:31], a[204:207], v[64:67], a[16:31]
  buffer_load_dwordx4 v[56:59], v1, s[60:63], s71 offen offset:2048 sc1
  s_lshl_b32 s72, s72, 12
  ds_read_b128 v[96:99], v26 offset:0
  ds_read_b128 v[104:107], v26 offset:2048
  ds_read_b128 v[164:167], v26 offset:4096
  v_mfma_f32_32x32x16_bf16 v[148:163], a[200:203], v[64:67], v[148:163]
  ds_read_b128 v[100:103], v26 offset:1024
  ds_read_b128 v[108:111], v26 offset:3072
  ds_read_b128 v[168:171], v26 offset:5120
  v_mfma_f32_32x32x16_bf16 a[16:31], a[212:215], v[68:71], a[16:31]
  buffer_load_dwordx4 v[60:63], v1, s[60:63], s71 offen offset:3072 sc1
  s_add_u32 s72, s72, s79
  v_mfma_f32_32x32x16_bf16 v[148:163], a[208:211], v[68:71], v[148:163]
  v_mfma_f32_32x32x16_bf16 a[16:31], a[220:223], v[72:75], a[16:31]
  buffer_load_dwordx4 v[64:67], v1, s[60:63], s72 offen offset:0 sc1
  s_add_u32 s71, s5, 15
  s_waitcnt lgkmcnt(3)
  v_add_f32 v96, v96, v104
  v_add_f32 v132, v132, v164
  v_mfma_f32_32x32x16_bf16 v[148:163], a[216:219], v[72:75], v[148:163]
  v_add_f32 v97, v97, v105
  v_add_f32 v133, v133, v165
  v_add_f32 v98, v98, v106
  v_add_f32 v134, v134, v166
  v_add_f32 v99, v99, v107
  v_add_f32 v135, v135, v167
  v_mfma_f32_32x32x16_bf16 a[16:31], a[228:231], v[76:79], a[16:31]
  buffer_load_dwordx4 v[68:71], v1, s[60:63], s72 offen offset:1024 sc1
  s_and_b32 s71, s71, 7
  s_waitcnt vmcnt(10)
  v_max3_u32 v28, v80, v84, v88
  v_max_u32 v28, v28, v92
  v_cmp_eq_u32 vcc, -1, v28
  v_mfma_f32_32x32x16_bf16 v[148:163], a[224:227], v[76:79], v[148:163]
  v_add_f32 v132, v132, v96
  v_add_f32 v133, v133, v97
  v_add_f32 v134, v134, v98
  v_add_f32 v135, v135, v99
  v_mul_f32 v172, v132, v132
  s_cbranch_vccnz L_rtyhn11_52
L_okhn11_51:
  v_mfma_f32_32x32x16_bf16 a[16:31], a[236:239], v[80:83], a[16:31]
  buffer_load_dwordx4 v[72:75], v1, s[60:63], s72 offen offset:2048 sc1
  s_lshl_b32 s71, s71, 12
  v_mul_f32 v173, v133, v133
  v_mul_f32 v174, v134, v134
  v_mul_f32 v175, v135, v135
  v_mfma_f32_32x32x16_bf16 v[148:163], a[232:235], v[80:83], v[148:163]
  v_fma_f32 v172, v172, s90, v29
  v_fma_f32 v173, v173, s90, v29
  v_fma_f32 v174, v174, s90, v29
  v_fma_f32 v175, v175, s90, v29
  v_mul_f32 v172, v172, v132
  v_mul_f32 v173, v173, v133
  v_mfma_f32_32x32x16_bf16 a[16:31], a[244:247], v[84:87], a[16:31]
  buffer_load_dwordx4 v[76:79], v1, s[60:63], s72 offen offset:3072 sc1
  s_add_u32 s71, s71, s79
  v_mul_f32 v174, v174, v134
  v_mul_f32 v175, v175, v135
  v_mfma_f32_32x32x16_bf16 v[148:163], a[240:243], v[84:87], v[148:163]
  v_exp_f32 v172, v172
  v_exp_f32 v173, v173
  v_exp_f32 v174, v174
  v_mfma_f32_32x32x16_bf16 a[16:31], a[252:255], v[88:91], a[16:31]
  buffer_load_dwordx4 v[80:83], v1, s[60:63], s71 offen offset:0 sc1
  v_exp_f32 v175, v175
  v_add_f32 v172, 1.0, v172
  v_mfma_f32_32x32x16_bf16 v[148:163], a[248:251], v[88:91], v[148:163]
  v_add_f32 v173, 1.0, v173
  v_add_f32 v174, 1.0, v174
  v_add_f32 v175, 1.0, v175
  v_rcp_f32 v172, v172
  v_mfma_f32_32x32x16_bf16 a[16:31], v[188:191], v[92:95], a[16:31]
  buffer_load_dwordx4 v[84:87], v1, s[60:63], s71 offen offset:1024 sc1
  s_waitcnt vmcnt(10)
  v_max3_u32 v28, v32, v36, v40
  v_max_u32 v28, v28, v44
  v_cmp_eq_u32 vcc, -1, v28
  v_mfma_f32_32x32x16_bf16 v[148:163], v[184:187], v[92:95], v[148:163]
  v_rcp_f32 v173, v173
  v_rcp_f32 v174, v174
  s_cbranch_vccnz L_rtyhn12_54
L_okhn12_53:
  v_mfma_f32_32x32x16_bf16 a[16:31], v[196:199], v[32:35], a[16:31]
  buffer_load_dwordx4 v[88:91], v1, s[60:63], s71 offen offset:2048 sc1
  v_rcp_f32 v175, v175
  v_mul_f32 v172, v172, v132
  v_mfma_f32_32x32x16_bf16 v[148:163], v[192:195], v[32:35], v[148:163]
  v_mul_f32 v173, v173, v133
  v_mul_f32 v174, v174, v134
  v_mul_f32 v175, v175, v135
  v_cvt_pk_bf16_f32 v176, v172, v173
  v_cvt_pk_bf16_f32 v177, v174, v175
  s_waitcnt lgkmcnt(0)
  v_mfma_f32_32x32x16_bf16 a[16:31], v[204:207], v[36:39], a[16:31]
  buffer_load_dwordx4 v[92:95], v1, s[60:63], s71 offen offset:3072 sc1
  v_add_f32 v100, v100, v108
  v_add_f32 v136, v136, v168
  v_add_f32 v101, v101, v109
  v_mfma_f32_32x32x16_bf16 v[148:163], v[200:203], v[36:39], v[148:163]
  v_add_f32 v137, v137, v169
  v_add_f32 v102, v102, v110
  v_add_f32 v138, v138, v170
  v_add_f32 v103, v103, v111
  v_add_f32 v139, v139, v171
  v_add_f32 v136, v136, v100
  v_mfma_f32_32x32x16_bf16 a[16:31], v[212:215], v[40:43], a[16:31]
  global_load_lds_dwordx4 v8, s[36:37] offset:0
  v_add_f32 v137, v137, v101
  v_add_f32 v138, v138, v102
  v_add_f32 v139, v139, v103
  v_mfma_f32_32x32x16_bf16 v[148:163], v[208:211], v[40:43], v[148:163]
  v_mul_f32 v172, v136, v136
  v_mul_f32 v173, v137, v137
  v_mul_f32 v174, v138, v138
  v_mul_f32 v175, v139, v139
  v_fma_f32 v172, v172, s90, v29
  v_fma_f32 v173, v173, s90, v29
  v_mfma_f32_32x32x16_bf16 a[16:31], v[220:223], v[44:47], a[16:31]
  global_load_lds_dwordx4 v9, s[36:37] offset:1024
  s_waitcnt vmcnt(10)
  v_max3_u32 v28, v48, v52, v56
  v_max_u32 v28, v28, v60
  v_cmp_eq_u32 vcc, -1, v28
  v_mfma_f32_32x32x16_bf16 v[148:163], v[216:219], v[44:47], v[148:163]
  v_fma_f32 v174, v174, s90, v29
  v_fma_f32 v175, v175, s90, v29
  v_mul_f32 v172, v172, v136
  v_mul_f32 v173, v173, v137
  v_mul_f32 v174, v174, v138
  s_cbranch_vccnz L_rtyhn13_56
L_okhn13_55:
  v_mfma_f32_32x32x16_bf16 a[16:31], v[228:231], v[48:51], a[16:31]
  global_load_lds_dwordx4 v10, s[36:37] offset:2048
  v_mul_f32 v175, v175, v139
  v_exp_f32 v172, v172
  v_mfma_f32_32x32x16_bf16 v[148:163], v[224:227], v[48:51], v[148:163]
  v_exp_f32 v173, v173
  v_exp_f32 v174, v174
  v_exp_f32 v175, v175
  v_mfma_f32_32x32x16_bf16 a[16:31], v[236:239], v[52:55], a[16:31]
  global_load_lds_dwordx4 v11, s[36:37] offset:3072
  s_add_u32 m0, s94, 16384
  s_add_u32 s36, s36, 131072
  s_addc_u32 s37, s37, 0
  v_add_f32 v172, 1.0, v172
  v_add_f32 v173, 1.0, v173
  v_add_f32 v174, 1.0, v174
  v_mfma_f32_32x32x16_bf16 v[148:163], v[232:235], v[52:55], v[148:163]
  v_add_f32 v175, 1.0, v175
  v_rcp_f32 v172, v172
  v_rcp_f32 v173, v173
  v_mfma_f32_32x32x16_bf16 a[16:31], v[244:247], v[56:59], a[16:31]
  global_load_lds_dwordx4 v8, s[36:37] offset:0
  v_rcp_f32 v174, v174
  v_mfma_f32_32x32x16_bf16 v[148:163], v[240:243], v[56:59], v[148:163]
  v_rcp_f32 v175, v175
  v_mul_f32 v172, v172, v136
  v_mul_f32 v173, v173, v137
  v_mul_f32 v174, v174, v138
  v_mul_f32 v175, v175, v139
  v_mfma_f32_32x32x16_bf16 a[16:31], v[252:255], v[60:63], a[16:31]
  global_load_lds_dwordx4 v9, s[36:37] offset:1024
  s_waitcnt vmcnt(10)
  v_max3_u32 v28, v64, v68, v72
  v_max_u32 v28, v28, v76
  v_cmp_eq_u32 vcc, -1, v28
  v_mfma_f32_32x32x16_bf16 v[148:163], v[248:251], v[60:63], v[148:163]
  v_cvt_pk_bf16_f32 v178, v172, v173
  v_cvt_pk_bf16_f32 v179, v174, v175
  v_min_u32 v176, -2, v176
  buffer_store_dwordx4 v[176:179], v16, s[60:63], s30 offen sc1
  s_cbranch_vccnz L_rtyhn14_58
L_okhn14_57:
  v_mfma_f32_32x32x16_bf16 a[16:31], a[76:79], v[64:67], a[16:31]
  global_load_lds_dwordx4 v10, s[36:37] offset:2048
  ds_read_b64_tr_b16 a[168:169], v12 offset:8192
  ds_read_b64_tr_b16 a[170:171], v12 offset:9216
  ds_read_b64_tr_b16 a[172:173], v13 offset:8192
  v_mfma_f32_32x32x16_bf16 v[148:163], a[72:75], v[64:67], v[148:163]
  ds_read_b64_tr_b16 a[174:175], v13 offset:9216
  ds_read_b64_tr_b16 a[176:177], v14 offset:8192
  ds_read_b64_tr_b16 a[178:179], v14 offset:9216
  ds_read_b64_tr_b16 a[180:181], v15 offset:8192
  ds_read_b64_tr_b16 a[182:183], v15 offset:9216
  v_mfma_f32_32x32x16_bf16 a[16:31], a[84:87], v[68:71], a[16:31]
  global_load_lds_dwordx4 v11, s[36:37] offset:3072
  s_add_u32 m0, s94, 20480
  s_add_u32 s36, s36, 131072
  s_addc_u32 s37, s37, 0
  v_mfma_f32_32x32x16_bf16 v[148:163], a[80:83], v[68:71], v[148:163]
  v_mfma_f32_32x32x16_bf16 a[16:31], a[92:95], v[72:75], a[16:31]
  global_load_lds_dwordx4 v8, s[36:37] offset:0
  v_mfma_f32_32x32x16_bf16 v[148:163], a[88:91], v[72:75], v[148:163]
  v_mfma_f32_32x32x16_bf16 a[16:31], a[100:103], v[76:79], a[16:31]
  global_load_lds_dwordx4 v9, s[36:37] offset:1024
  s_waitcnt vmcnt(11)
  v_max3_u32 v28, v80, v84, v88
  v_max_u32 v28, v28, v92
  v_cmp_eq_u32 vcc, -1, v28
  v_mfma_f32_32x32x16_bf16 v[148:163], a[96:99], v[76:79], v[148:163]
  s_cbranch_vccnz L_rtyhn15_60
L_okhn15_59:
  v_mfma_f32_32x32x16_bf16 a[16:31], a[108:111], v[80:83], a[16:31]
  global_load_lds_dwordx4 v10, s[36:37] offset:2048
  v_mfma_f32_32x32x16_bf16 v[148:163], a[104:107], v[80:83], v[148:163]
  v_mfma_f32_32x32x16_bf16 a[16:31], a[116:119], v[84:87], a[16:31]
  global_load_lds_dwordx4 v11, s[36:37] offset:3072
  s_add_u32 m0, s94, 0
  s_add_u32 s36, s36, 131072
  s_addc_u32 s37, s37, 0
  v_mfma_f32_32x32x16_bf16 v[148:163], a[112:115], v[84:87], v[148:163]
  v_mfma_f32_32x32x16_bf16 a[16:31], a[124:127], v[88:91], a[16:31]
  global_load_lds_dwordx4 v8, s[36:37] offset:0
  v_mfma_f32_32x32x16_bf16 v[148:163], a[120:123], v[88:91], v[148:163]
  v_mfma_f32_32x32x16_bf16 a[16:31], a[132:135], v[92:95], a[16:31]
  global_load_lds_dwordx4 v9, s[36:37] offset:1024
  v_mfma_f32_32x32x16_bf16 v[148:163], a[128:131], v[92:95], v[148:163]
  s_waitcnt vmcnt(11)
  ds_read_b64_tr_b16 a[184:185], v12 offset:12288
  ds_read_b64_tr_b16 a[186:187], v12 offset:13312
  ds_read_b64_tr_b16 a[188:189], v13 offset:12288
  ds_read_b64_tr_b16 a[190:191], v13 offset:13312
  ds_read_b64_tr_b16 a[192:193], v14 offset:12288
  ds_read_b64_tr_b16 a[194:195], v14 offset:13312
  ds_read_b64_tr_b16 a[196:197], v15 offset:12288
  ds_read_b64_tr_b16 a[198:199], v15 offset:13312
  global_load_lds_dwordx4 v10, s[36:37] offset:2048
  ds_write_b128 v24, a[16:19] offset:8192
  global_load_lds_dwordx4 v11, s[36:37] offset:3072
  s_add_u32 m0, s94, 4096
  s_add_u32 s36, s36, 131072
  s_addc_u32 s37, s37, 0
  ds_write_b128 v24, a[20:23] offset:9216
  global_load_lds_dwordx4 v8, s[36:37] offset:0
  ds_write_b128 v25, a[24:27] offset:10240
  global_load_lds_dwordx4 v9, s[36:37] offset:1024
  ds_write_b128 v25, a[28:31] offset:11264
  global_load_lds_dwordx4 v10, s[36:37] offset:2048
  ds_write_b128 v23, v[156:159] offset:6144
  global_load_lds_dwordx4 v11, s[36:37] offset:3072
  s_add_u32 m0, s94, 8192
  s_add_u32 s36, s36, 131072
  s_addc_u32 s37, s37, 0
  ds_write_b128 v23, v[160:163] offset:7168
  s_waitcnt lgkmcnt(0)
  s_barrier
  ds_read_b128 v[96:99], v26 offset:6144
  ds_read_b128 v[104:107], v26 offset:8192
  ds_read_b128 v[164:167], v26 offset:10240
  ds_read_b128 v[100:103], v26 offset:7168
  ds_read_b128 v[108:111], v26 offset:9216
  ds_read_b128 v[168:171], v26 offset:11264
  s_waitcnt vmcnt(12)
  ds_read_b64_tr_b16 a[200:201], v12 offset:16384
  ds_read_b64_tr_b16 a[202:203], v12 offset:17408
  ds_read_b64_tr_b16 a[204:205], v13 offset:16384
  ds_read_b64_tr_b16 a[206:207], v13 offset:17408
  ds_read_b64_tr_b16 a[208:209], v14 offset:16384
  ds_read_b64_tr_b16 a[210:211], v14 offset:17408
  ds_read_b64_tr_b16 a[212:213], v15 offset:16384
  ds_read_b64_tr_b16 a[214:215], v15 offset:17408
  global_load_lds_dwordx4 v8, s[36:37] offset:0
  global_load_lds_dwordx4 v9, s[36:37] offset:1024
  global_load_lds_dwordx4 v10, s[36:37] offset:2048
  s_waitcnt lgkmcnt(11)
  v_add_f32 v96, v96, v104
  v_add_f32 v148, v148, v164
  v_add_f32 v97, v97, v105
  v_add_f32 v149, v149, v165
  v_add_f32 v98, v98, v106
  v_add_f32 v150, v150, v166
  v_add_f32 v99, v99, v107
  v_add_f32 v151, v151, v167
  global_load_lds_dwordx4 v11, s[36:37] offset:3072
  s_add_u32 m0, s94, 12288
  s_add_u32 s36, s36, 131072
  s_addc_u32 s37, s37, 0
  v_add_f32 v148, v148, v96
  v_add_f32 v149, v149, v97
  v_add_f32 v150, v150, v98
  v_add_f32 v151, v151, v99
  v_mul_f32 v172, v148, v148
  v_mul_f32 v173, v149, v149
  v_mul_f32 v174, v150, v150
  v_mul_f32 v175, v151, v151
  global_load_dwordx4 v[32:35], v1, s[38:39] offset:-4096 sc1
  v_fma_f32 v172, v172, s90, v29
  v_fma_f32 v173, v173, s90, v29
  v_fma_f32 v174, v174, s90, v29
  v_fma_f32 v175, v175, s90, v29
  v_mul_f32 v172, v172, v148
  v_mul_f32 v173, v173, v149
  v_mul_f32 v174, v174, v150
  v_mul_f32 v175, v175, v151
  global_load_dwordx4 v[36:39], v1, s[38:39] offset:-3072 sc1
  v_exp_f32 v172, v172
  v_exp_f32 v173, v173
  v_exp_f32 v174, v174
  v_exp_f32 v175, v175
  v_add_f32 v172, 1.0, v172
  v_add_f32 v173, 1.0, v173
  v_add_f32 v174, 1.0, v174
  v_add_f32 v175, 1.0, v175
  global_load_dwordx4 v[40:43], v1, s[38:39] offset:-2048 sc1
  v_rcp_f32 v172, v172
  v_rcp_f32 v173, v173
  v_rcp_f32 v174, v174
  v_rcp_f32 v175, v175
  v_mul_f32 v172, v172, v148
  v_mul_f32 v173, v173, v149
  v_mul_f32 v174, v174, v150
  v_mul_f32 v175, v175, v151
  s_waitcnt vmcnt(15)
  ds_read_b64_tr_b16 a[216:217], v12 offset:20480
  ds_read_b64_tr_b16 a[218:219], v12 offset:21504
  ds_read_b64_tr_b16 a[220:221], v13 offset:20480
  ds_read_b64_tr_b16 a[222:223], v13 offset:21504
  ds_read_b64_tr_b16 a[224:225], v14 offset:20480
  ds_read_b64_tr_b16 a[226:227], v14 offset:21504
  ds_read_b64_tr_b16 a[228:229], v15 offset:20480
  ds_read_b64_tr_b16 a[230:231], v15 offset:21504
  global_load_dwordx4 v[44:47], v1, s[38:39] offset:-1024 sc1
  v_cvt_pk_bf16_f32 v176, v172, v173
  v_cvt_pk_bf16_f32 v177, v174, v175
  s_waitcnt lgkmcnt(15)
  v_add_f32 v100, v100, v108
  v_add_f32 v152, v152, v168
  v_add_f32 v101, v101, v109
  v_add_f32 v153, v153, v169
  v_add_f32 v102, v102, v110
  global_load_dwordx4 v[48:51], v1, s[38:39] offset:0 sc1
  v_add_f32 v154, v154, v170
  v_add_f32 v103, v103, v111
  v_add_f32 v155, v155, v171
  v_add_f32 v152, v152, v100
  v_add_f32 v153, v153, v101
  v_add_f32 v154, v154, v102
  v_add_f32 v155, v155, v103
  v_mul_f32 v172, v152, v152
  global_load_dwordx4 v[52:55], v1, s[38:39] offset:1024 sc1
  v_mul_f32 v173, v153, v153
  v_mul_f32 v174, v154, v154
  v_mul_f32 v175, v155, v155
  v_fma_f32 v172, v172, s90, v29
  v_fma_f32 v173, v173, s90, v29
  v_fma_f32 v174, v174, s90, v29
  v_fma_f32 v175, v175, s90, v29
  v_mul_f32 v172, v172, v152
  global_load_dwordx4 v[56:59], v1, s[38:39] offset:2048 sc1
  v_mul_f32 v173, v173, v153
  v_mul_f32 v174, v174, v154
  v_mul_f32 v175, v175, v155
  v_exp_f32 v172, v172
  v_exp_f32 v173, v173
  v_exp_f32 v174, v174
  v_exp_f32 v175, v175
  v_add_f32 v172, 1.0, v172
  global_load_dwordx4 v[60:63], v1, s[38:39] offset:3072 sc1
  v_add_f32 v173, 1.0, v173
  v_add_f32 v174, 1.0, v174
  v_add_f32 v175, 1.0, v175
  v_rcp_f32 v172, v172
  v_rcp_f32 v173, v173
  v_rcp_f32 v174, v174
  v_rcp_f32 v175, v175
  v_mul_f32 v172, v172, v152
  v_mul_f32 v173, v173, v153
  v_mul_f32 v174, v174, v154
  v_mul_f32 v175, v175, v155
  v_cvt_pk_bf16_f32 v178, v172, v173
  v_cvt_pk_bf16_f32 v179, v174, v175
  global_load_dwordx4 v[64:67], v30, s[38:39] offset:-4096 sc1
  s_add_u32 s30, s30, 983040
  v_min_u32 v176, -2, v176
  buffer_store_dwordx4 v[176:179], v16, s[60:63], s30 offen sc1
L_p3join:
  global_load_lds_dwordx4 v8, s[36:37] offset:0
  global_load_lds_dwordx4 v9, s[36:37] offset:1024
  s_waitcnt vmcnt(20)
  ds_read_b64_tr_b16 a[232:233], v12 offset:0
  ds_read_b64_tr_b16 a[234:235], v12 offset:1024
  ds_read_b64_tr_b16 a[236:237], v13 offset:0
  ds_read_b64_tr_b16 a[238:239], v13 offset:1024
  ds_read_b64_tr_b16 a[240:241], v14 offset:0
  ds_read_b64_tr_b16 a[242:243], v14 offset:1024
  ds_read_b64_tr_b16 a[244:245], v15 offset:0
  ds_read_b64_tr_b16 a[246:247], v15 offset:1024
  global_load_lds_dwordx4 v10, s[36:37] offset:2048
  global_load_lds_dwordx4 v11, s[36:37] offset:3072
  s_add_u32 m0, s94, 16384
  s_add_u32 s36, s36, 131072
  s_addc_u32 s37, s37, 0
  s_waitcnt vmcnt(18)
  ds_read_b64_tr_b16 v[192:193], v12 offset:4096
  ds_read_b64_tr_b16 v[194:195], v12 offset:5120
  ds_read_b64_tr_b16 v[196:197], v13 offset:4096
  ds_read_b64_tr_b16 v[198:199], v13 offset:5120
  ds_read_b64_tr_b16 v[200:201], v14 offset:4096
  ds_read_b64_tr_b16 v[202:203], v14 offset:5120
  ds_read_b64_tr_b16 v[204:205], v15 offset:4096
  ds_read_b64_tr_b16 v[206:207], v15 offset:5120
  global_load_dwordx4 v[68:71], v1, s[40:41] offset:-4096 sc1
  global_load_dwordx4 v[72:75], v1, s[40:41] offset:-3072 sc1
  s_waitcnt vmcnt(16)
  ds_read_b64_tr_b16 v[208:209], v12 offset:8192
  ds_read_b64_tr_b16 v[210:211], v12 offset:9216
  ds_read_b64_tr_b16 v[212:213], v13 offset:8192
  ds_read_b64_tr_b16 v[214:215], v13 offset:9216
  ds_read_b64_tr_b16 v[216:217], v14 offset:8192
  ds_read_b64_tr_b16 v[218:219], v14 offset:9216
  ds_read_b64_tr_b16 v[220:221], v15 offset:8192
  ds_read_b64_tr_b16 v[222:223], v15 offset:9216
  s_barrier
  s_waitcnt vmcnt(13)
  v_max3_u32 v28, v32, v36, v40
  v_cmp_eq_u32 vcc, -1, v28
  s_cbranch_vccnz L_rtyu0_62
L_oku0_61:
  v_mfma_f32_16x16x32_bf16 a[0:3], v[32:35], a[140:143], 0
  global_load_dwordx4 v[76:79], v1, s[40:41] offset:-2048 sc1
  v_mfma_f32_16x16x32_bf16 a[4:7], v[32:35], a[144:147], 0
  v_mfma_f32_16x16x32_bf16 a[8:11], v[32:35], a[148:151], 0
  s_waitcnt lgkmcnt(15)
  global_load_lds_dwordx4 v8, s[36:37] offset:0
  v_mfma_f32_16x16x32_bf16 v[112:115], v[32:35], a[136:139], v[112:115]
  v_mfma_f32_16x16x32_bf16 a[0:3], v[36:39], a[156:159], a[0:3]
  global_load_lds_dwordx4 v9, s[36:37] offset:1024
  v_mfma_f32_16x16x32_bf16 a[4:7], v[36:39], a[160:163], a[4:7]
  v_mfma_f32_16x16x32_bf16 a[8:11], v[36:39], a[164:167], a[8:11]
  global_load_lds_dwordx4 v10, s[36:37] offset:2048
  v_mfma_f32_16x16x32_bf16 v[112:115], v[36:39], a[152:155], v[112:115]
  v_mfma_f32_16x16x32_bf16 a[0:3], v[40:43], a[172:175], a[0:3]
  global_load_lds_dwordx4 v11, s[36:37] offset:3072
  s_add_u32 m0, s94, 20480
  s_add_u32 s36, s36, 131072
  s_addc_u32 s37, s37, 0
  v_mfma_f32_16x16x32_bf16 a[4:7], v[40:43], a[176:179], a[4:7]
  s_waitcnt vmcnt(15)
  v_max3_u32 v28, v44, v48, v52
  v_mfma_f32_16x16x32_bf16 a[8:11], v[40:43], a[180:183], a[8:11]
  global_load_dwordx4 v[80:83], v1, s[40:41] offset:-1024 sc1
  v_cmp_eq_u32 vcc, -1, v28
  v_mfma_f32_16x16x32_bf16 v[112:115], v[40:43], a[168:171], v[112:115]
  s_cbranch_vccnz L_rtyu1_64
L_oku1_63:
  v_mfma_f32_16x16x32_bf16 a[0:3], v[44:47], a[188:191], a[0:3]
  global_load_dwordx4 v[84:87], v1, s[40:41] offset:0 sc1
  v_mfma_f32_16x16x32_bf16 a[4:7], v[44:47], a[192:195], a[4:7]
  v_mfma_f32_16x16x32_bf16 a[8:11], v[44:47], a[196:199], a[8:11]
  global_load_dwordx4 v[88:91], v1, s[40:41] offset:1024 sc1
  v_mfma_f32_16x16x32_bf16 v[112:115], v[44:47], a[184:187], v[112:115]
  v_mfma_f32_16x16x32_bf16 a[0:3], v[48:51], a[204:207], a[0:3]
  global_load_lds_dwordx4 v8, s[36:37] offset:0
  v_mfma_f32_16x16x32_bf16 a[4:7], v[48:51], a[208:211], a[4:7]
  v_mfma_f32_16x16x32_bf16 a[8:11], v[48:51], a[212:215], a[8:11]
  global_load_lds_dwordx4 v9, s[36:37] offset:1024
  v_mfma_f32_16x16x32_bf16 v[112:115], v[48:51], a[200:203], v[112:115]
  v_mfma_f32_16x16x32_bf16 a[0:3], v[52:55], a[220:223], a[0:3]
  global_load_lds_dwordx4 v10, s[36:37] offset:2048
  v_mfma_f32_16x16x32_bf16 a[4:7], v[52:55], a[224:227], a[4:7]
  s_waitcnt vmcnt(18)
  v_max3_u32 v28, v56, v60, v64
  v_mfma_f32_16x16x32_bf16 a[8:11], v[52:55], a[228:231], a[8:11]
  global_load_lds_dwordx4 v11, s[36:37] offset:3072
  v_cmp_eq_u32 vcc, -1, v28
  v_mfma_f32_16x16x32_bf16 v[112:115], v[52:55], a[216:219], v[112:115]
  s_cbranch_vccnz L_rtyu2_66
L_oku2_65:
  v_mfma_f32_16x16x32_bf16 a[0:3], v[56:59], a[236:239], a[0:3]
  global_load_dwordx4 v[92:95], v1, s[40:41] offset:2048 sc1
  v_mfma_f32_16x16x32_bf16 a[4:7], v[56:59], a[240:243], a[4:7]
  v_mfma_f32_16x16x32_bf16 a[8:11], v[56:59], a[244:247], a[8:11]
  global_load_dwordx4 v[96:99], v1, s[40:41] offset:3072 sc1
  v_mfma_f32_16x16x32_bf16 v[112:115], v[56:59], a[232:235], v[112:115]
  s_waitcnt lgkmcnt(8)
  v_mfma_f32_16x16x32_bf16 a[0:3], v[60:63], v[196:199], a[0:3]
  global_load_dwordx4 v[100:103], v30, s[40:41] offset:-4096 sc1
  v_mfma_f32_16x16x32_bf16 a[4:7], v[60:63], v[200:203], a[4:7]
  v_mfma_f32_16x16x32_bf16 a[8:11], v[60:63], v[204:207], a[8:11]
  global_load_dwordx4 v[32:35], v30, s[38:39] offset:-3072 sc1
  v_mfma_f32_16x16x32_bf16 v[112:115], v[60:63], v[192:195], v[112:115]
  s_waitcnt lgkmcnt(0)
  v_mfma_f32_16x16x32_bf16 a[0:3], v[64:67], v[212:215], a[0:3]
  global_load_dwordx4 v[36:39], v30, s[38:39] offset:-2048 sc1
  v_mfma_f32_16x16x32_bf16 a[4:7], v[64:67], v[216:219], a[4:7]
  s_waitcnt vmcnt(16)
  v_max3_u32 v28, v68, v72, v76
  v_mfma_f32_16x16x32_bf16 a[8:11], v[64:67], v[220:223], a[8:11]
  global_load_dwordx4 v[40:43], v30, s[38:39] offset:-1024 sc1
  v_cmp_eq_u32 vcc, -1, v28
  v_mfma_f32_16x16x32_bf16 v[112:115], v[64:67], v[208:211], v[112:115]
  s_cbranch_vccnz L_rtyu3_68
L_oku3_67:
  v_mfma_f32_16x16x32_bf16 a[12:15], v[68:71], a[140:143], 0
  global_load_dwordx4 v[44:47], v30, s[40:41] offset:-3072 sc1
  v_mfma_f32_16x16x32_bf16 a[16:19], v[68:71], a[144:147], 0
  ds_read_b64_tr_b16 v[224:225], v12 offset:12288
  ds_read_b64_tr_b16 v[226:227], v12 offset:13312
  v_mfma_f32_16x16x32_bf16 a[20:23], v[68:71], a[148:151], 0
  global_load_dwordx4 v[48:51], v30, s[40:41] offset:-2048 sc1
  v_mfma_f32_16x16x32_bf16 v[116:119], v[68:71], a[136:139], v[116:119]
  ds_read_b64_tr_b16 v[228:229], v13 offset:12288
  ds_read_b64_tr_b16 v[230:231], v13 offset:13312
  v_mfma_f32_16x16x32_bf16 a[12:15], v[72:75], a[156:159], a[12:15]
  global_load_dwordx4 v[52:55], v30, s[40:41] offset:-1024 sc1
  v_mfma_f32_16x16x32_bf16 a[16:19], v[72:75], a[160:163], a[16:19]
  ds_read_b64_tr_b16 v[232:233], v14 offset:12288
  ds_read_b64_tr_b16 v[234:235], v14 offset:13312
  v_mfma_f32_16x16x32_bf16 a[20:23], v[72:75], a[164:167], a[20:23]
  global_load_dwordx4 v[56:59], v1, s[42:43] offset:-4096 sc1
  v_mfma_f32_16x16x32_bf16 v[116:119], v[72:75], a[152:155], v[116:119]
  ds_read_b64_tr_b16 v[236:237], v15 offset:12288
  ds_read_b64_tr_b16 v[238:239], v15 offset:13312
  v_mfma_f32_16x16x32_bf16 a[12:15], v[76:79], a[172:175], a[12:15]
  global_load_dwordx4 v[60:63], v1, s[42:43] offset:-3072 sc1
  v_mfma_f32_16x16x32_bf16 a[16:19], v[76:79], a[176:179], a[16:19]
  s_waitcnt vmcnt(15)
  v_max3_u32 v28, v80, v84, v88
  v_mfma_f32_16x16x32_bf16 a[20:23], v[76:79], a[180:183], a[20:23]
  v_cmp_eq_u32 vcc, -1, v28
  v_mfma_f32_16x16x32_bf16 v[116:119], v[76:79], a[168:171], v[116:119]
  s_cbranch_vccnz L_rtyu4_70
L_oku4_69:
  v_mfma_f32_16x16x32_bf16 a[12:15], v[80:83], a[188:191], a[12:15]
  global_load_dwordx4 v[64:67], v1, s[42:43] offset:-2048 sc1
  v_mfma_f32_16x16x32_bf16 a[16:19], v[80:83], a[192:195], a[16:19]
  ds_read_b64_tr_b16 v[240:241], v12 offset:16384
  ds_read_b64_tr_b16 v[242:243], v12 offset:17408
  v_mfma_f32_16x16x32_bf16 a[20:23], v[80:83], a[196:199], a[20:23]
  v_mfma_f32_16x16x32_bf16 v[116:119], v[80:83], a[184:187], v[116:119]
  ds_read_b64_tr_b16 v[244:245], v13 offset:16384
  ds_read_b64_tr_b16 v[246:247], v13 offset:17408
  v_mfma_f32_16x16x32_bf16 a[12:15], v[84:87], a[204:207], a[12:15]
  global_load_dwordx4 v[68:71], v1, s[42:43] offset:-1024 sc1
  v_mfma_f32_16x16x32_bf16 a[16:19], v[84:87], a[208:211], a[16:19]
  ds_read_b64_tr_b16 v[248:249], v14 offset:16384
  ds_read_b64_tr_b16 v[250:251], v14 offset:17408
  v_mfma_f32_16x16x32_bf16 a[20:23], v[84:87], a[212:215], a[20:23]
  v_mfma_f32_16x16x32_bf16 v[116:119], v[84:87], a[200:203], v[116:119]
  ds_read_b64_tr_b16 v[252:253], v15 offset:16384
  ds_read_b64_tr_b16 v[254:255], v15 offset:17408
  v_mfma_f32_16x16x32_bf16 a[12:15], v[88:91], a[220:223], a[12:15]
  global_load_dwordx4 v[72:75], v1, s[42:43] offset:0 sc1
  v_mfma_f32_16x16x32_bf16 a[16:19], v[88:91], a[224:227], a[16:19]
  s_waitcnt vmcnt(11)
  v_max3_u32 v28, v92, v96, v100
  v_mfma_f32_16x16x32_bf16 a[20:23], v[88:91], a[228:231], a[20:23]
  v_cmp_eq_u32 vcc, -1, v28
  v_mfma_f32_16x16x32_bf16 v[116:119], v[88:91], a[216:219], v[116:119]
  s_cbranch_vccnz L_rtyu5_72
L_oku5_71:
  v_mfma_f32_16x16x32_bf16 a[12:15], v[92:95], a[236:239], a[12:15]
  global_load_dwordx4 v[76:79], v1, s[42:43] offset:1024 sc1
  v_mfma_f32_16x16x32_bf16 a[16:19], v[92:95], a[240:243], a[16:19]
  ds_read_b64_tr_b16 a[72:73], v12 offset:20480
  ds_read_b64_tr_b16 a[74:75], v12 offset:21504
  v_mfma_f32_16x16x32_bf16 a[20:23], v[92:95], a[244:247], a[20:23]
  v_mfma_f32_16x16x32_bf16 v[116:119], v[92:95], a[232:235], v[116:119]
  ds_read_b64_tr_b16 a[76:77], v13 offset:20480
  ds_read_b64_tr_b16 a[78:79], v13 offset:21504
  v_mfma_f32_16x16x32_bf16 a[12:15], v[96:99], v[196:199], a[12:15]
  global_load_dwordx4 v[80:83], v1, s[42:43] offset:2048 sc1
  v_mfma_f32_16x16x32_bf16 a[16:19], v[96:99], v[200:203], a[16:19]
  ds_read_b64_tr_b16 a[80:81], v14 offset:20480
  ds_read_b64_tr_b16 a[82:83], v14 offset:21504
  v_mfma_f32_16x16x32_bf16 a[20:23], v[96:99], v[204:207], a[20:23]
  v_mfma_f32_16x16x32_bf16 v[116:119], v[96:99], v[192:195], v[116:119]
  ds_read_b64_tr_b16 a[84:85], v15 offset:20480
  ds_read_b64_tr_b16 a[86:87], v15 offset:21504
  v_mfma_f32_16x16x32_bf16 a[12:15], v[100:103], v[212:215], a[12:15]
  global_load_dwordx4 v[84:87], v1, s[42:43] offset:3072 sc1
  v_mfma_f32_16x16x32_bf16 a[16:19], v[100:103], v[216:219], a[16:19]
  s_waitcnt vmcnt(11)
  v_max3_u32 v28, v32, v36, v40
  v_mfma_f32_16x16x32_bf16 a[20:23], v[100:103], v[220:223], a[20:23]
  v_cmp_eq_u32 vcc, -1, v28
  v_mfma_f32_16x16x32_bf16 v[116:119], v[100:103], v[208:211], v[116:119]
  s_cbranch_vccnz L_rtyu6_74
L_oku6_73:
  s_waitcnt lgkmcnt(15)
  v_mfma_f32_16x16x32_bf16 a[0:3], v[32:35], v[228:231], a[0:3]
  global_load_dwordx4 v[88:91], v30, s[42:43] offset:-4096 sc1
  v_mfma_f32_16x16x32_bf16 a[4:7], v[32:35], v[232:235], a[4:7]
  v_mfma_f32_16x16x32_bf16 a[8:11], v[32:35], v[236:239], a[8:11]
  v_mfma_f32_16x16x32_bf16 v[112:115], v[32:35], v[224:227], v[112:115]
  s_waitcnt lgkmcnt(8)
  v_mfma_f32_16x16x32_bf16 a[0:3], v[36:39], v[244:247], a[0:3]
  global_load_dwordx4 v[92:95], v30, s[42:43] offset:-3072 sc1
  v_mfma_f32_16x16x32_bf16 a[4:7], v[36:39], v[248:251], a[4:7]
  v_mfma_f32_16x16x32_bf16 a[8:11], v[36:39], v[252:255], a[8:11]
  v_mfma_f32_16x16x32_bf16 v[112:115], v[36:39], v[240:243], v[112:115]
  s_waitcnt lgkmcnt(0)
  v_mfma_f32_16x16x32_bf16 a[0:3], v[40:43], a[76:79], a[0:3]
  global_load_dwordx4 v[96:99], v30, s[42:43] offset:-2048 sc1
  v_mfma_f32_16x16x32_bf16 a[4:7], v[40:43], a[80:83], a[4:7]
  s_waitcnt vmcnt(11)
  v_max3_u32 v28, v44, v48, v52
  v_mfma_f32_16x16x32_bf16 a[8:11], v[40:43], a[84:87], a[8:11]
  v_cmp_eq_u32 vcc, -1, v28
  v_mfma_f32_16x16x32_bf16 v[112:115], v[40:43], a[72:75], v[112:115]
  s_cbranch_vccnz L_rtyu7_76
L_oku7_75:
  v_mfma_f32_16x16x32_bf16 a[12:15], v[44:47], v[228:231], a[12:15]
  global_load_dwordx4 v[100:103], v30, s[42:43] offset:-1024 sc1
  v_mfma_f32_16x16x32_bf16 a[16:19], v[44:47], v[232:235], a[16:19]
  v_mfma_f32_16x16x32_bf16 a[20:23], v[44:47], v[236:239], a[20:23]
  v_mfma_f32_16x16x32_bf16 v[116:119], v[44:47], v[224:227], v[116:119]
  v_mfma_f32_16x16x32_bf16 a[12:15], v[48:51], v[244:247], a[12:15]
  global_load_dwordx4 v[32:35], v1, s[44:45] offset:-4096 sc1
  v_mfma_f32_16x16x32_bf16 a[16:19], v[48:51], v[248:251], a[16:19]
  ds_write_b128 v23, a[0:3] offset:0
  v_mfma_f32_16x16x32_bf16 a[20:23], v[48:51], v[252:255], a[20:23]
  v_mfma_f32_16x16x32_bf16 v[116:119], v[48:51], v[240:243], v[116:119]
  ds_write_b128 v24, a[4:7] offset:5120
  v_mfma_f32_16x16x32_bf16 a[12:15], v[52:55], a[76:79], a[12:15]
  global_load_dwordx4 v[36:39], v1, s[44:45] offset:-3072 sc1
  v_mfma_f32_16x16x32_bf16 a[16:19], v[52:55], a[80:83], a[16:19]
  s_waitcnt vmcnt(11)
  v_max3_u32 v28, v56, v60, v64
  v_mfma_f32_16x16x32_bf16 a[20:23], v[52:55], a[84:87], a[20:23]
  v_cmp_eq_u32 vcc, -1, v28
  v_mfma_f32_16x16x32_bf16 v[116:119], v[52:55], a[72:75], v[116:119]
  ds_write_b128 v25, a[8:11] offset:10240
  s_cbranch_vccnz L_rtyu8_78
L_oku8_77:
  v_mfma_f32_16x16x32_bf16 a[24:27], v[56:59], a[140:143], 0
  global_load_dwordx4 v[40:43], v1, s[44:45] offset:-2048 sc1
  v_mfma_f32_16x16x32_bf16 a[28:31], v[56:59], a[144:147], 0
  v_mfma_f32_16x16x32_bf16 a[32:35], v[56:59], a[148:151], 0
  v_mfma_f32_16x16x32_bf16 v[120:123], v[56:59], a[136:139], v[120:123]
  v_mfma_f32_16x16x32_bf16 a[24:27], v[60:63], a[156:159], a[24:27]
  global_load_dwordx4 v[44:47], v1, s[44:45] offset:-1024 sc1
  v_mfma_f32_16x16x32_bf16 a[28:31], v[60:63], a[160:163], a[28:31]
  ds_write_b128 v23, a[12:15] offset:1024
  v_mfma_f32_16x16x32_bf16 a[32:35], v[60:63], a[164:167], a[32:35]
  v_mfma_f32_16x16x32_bf16 v[120:123], v[60:63], a[152:155], v[120:123]
  ds_write_b128 v24, a[16:19] offset:6144
  v_mfma_f32_16x16x32_bf16 a[24:27], v[64:67], a[172:175], a[24:27]
  global_load_dwordx4 v[48:51], v1, s[44:45] offset:0 sc1
  v_mfma_f32_16x16x32_bf16 a[28:31], v[64:67], a[176:179], a[28:31]
  s_waitcnt vmcnt(11)
  v_max3_u32 v28, v68, v72, v76
  v_mfma_f32_16x16x32_bf16 a[32:35], v[64:67], a[180:183], a[32:35]
  v_cmp_eq_u32 vcc, -1, v28
  v_mfma_f32_16x16x32_bf16 v[120:123], v[64:67], a[168:171], v[120:123]
  ds_write_b128 v25, a[20:23] offset:11264
  s_cbranch_vccnz L_rtyu9_80
L_oku9_79:
  v_mfma_f32_16x16x32_bf16 a[24:27], v[68:71], a[188:191], a[24:27]
  global_load_dwordx4 v[52:55], v1, s[44:45] offset:1024 sc1
  v_mfma_f32_16x16x32_bf16 a[28:31], v[68:71], a[192:195], a[28:31]
  v_mfma_f32_16x16x32_bf16 a[32:35], v[68:71], a[196:199], a[32:35]
  v_mfma_f32_16x16x32_bf16 v[120:123], v[68:71], a[184:187], v[120:123]
  v_mfma_f32_16x16x32_bf16 a[24:27], v[72:75], a[204:207], a[24:27]
  global_load_dwordx4 v[56:59], v1, s[44:45] offset:2048 sc1
  v_mfma_f32_16x16x32_bf16 a[28:31], v[72:75], a[208:211], a[28:31]
  s_waitcnt lgkmcnt(0)
  s_barrier
  v_mfma_f32_16x16x32_bf16 a[32:35], v[72:75], a[212:215], a[32:35]
  ds_read_b128 v[132:135], v26 offset:0
  ds_read_b128 v[136:139], v26 offset:5120
  v_mfma_f32_16x16x32_bf16 v[120:123], v[72:75], a[200:203], v[120:123]
  ds_read_b128 v[140:143], v26 offset:10240
  ds_read_b128 v[144:147], v26 offset:1024
  v_mfma_f32_16x16x32_bf16 a[24:27], v[76:79], a[220:223], a[24:27]
  global_load_dwordx4 v[60:63], v1, s[44:45] offset:3072 sc1
  v_mfma_f32_16x16x32_bf16 a[28:31], v[76:79], a[224:227], a[28:31]
  s_waitcnt vmcnt(11)
  v_max3_u32 v28, v80, v84, v88
  v_mfma_f32_16x16x32_bf16 a[32:35], v[76:79], a[228:231], a[32:35]
  v_cmp_eq_u32 vcc, -1, v28
  v_mfma_f32_16x16x32_bf16 v[120:123], v[76:79], a[216:219], v[120:123]
  ds_read_b128 v[148:151], v26 offset:6144
  ds_read_b128 v[152:155], v26 offset:11264
  s_cbranch_vccnz L_rtyu10_82
L_oku10_81:
  v_mfma_f32_16x16x32_bf16 a[24:27], v[80:83], a[236:239], a[24:27]
  global_load_dwordx4 v[64:67], v30, s[44:45] offset:-4096 sc1
  v_mfma_f32_16x16x32_bf16 a[28:31], v[80:83], a[240:243], a[28:31]
  v_mfma_f32_16x16x32_bf16 a[32:35], v[80:83], a[244:247], a[32:35]
  v_mfma_f32_16x16x32_bf16 v[120:123], v[80:83], a[232:235], v[120:123]
  s_waitcnt lgkmcnt(3)
  v_add_f32 v132, v132, v136
  v_add_f32 v112, v112, v140
  v_mfma_f32_16x16x32_bf16 a[24:27], v[84:87], v[196:199], a[24:27]
  global_load_dwordx4 v[68:71], v30, s[44:45] offset:-3072 sc1
  v_mfma_f32_16x16x32_bf16 a[28:31], v[84:87], v[200:203], a[28:31]
  v_add_f32 v133, v133, v137
  v_add_f32 v113, v113, v141
  v_mfma_f32_16x16x32_bf16 a[32:35], v[84:87], v[204:207], a[32:35]
  v_add_f32 v134, v134, v138
  v_add_f32 v114, v114, v142
  v_mfma_f32_16x16x32_bf16 v[120:123], v[84:87], v[192:195], v[120:123]
  v_add_f32 v135, v135, v139
  v_add_f32 v115, v115, v143
  v_mfma_f32_16x16x32_bf16 a[24:27], v[88:91], v[212:215], a[24:27]
  global_load_dwordx4 v[72:75], v30, s[44:45] offset:-2048 sc1
  v_mfma_f32_16x16x32_bf16 a[28:31], v[88:91], v[216:219], a[28:31]
  s_waitcnt vmcnt(11)
  v_max3_u32 v28, v92, v96, v100
  v_mfma_f32_16x16x32_bf16 a[32:35], v[88:91], v[220:223], a[32:35]
  v_cmp_eq_u32 vcc, -1, v28
  v_mfma_f32_16x16x32_bf16 v[120:123], v[88:91], v[208:211], v[120:123]
  v_add_f32 v112, v112, v132
  v_add_f32 v113, v113, v133
  s_cbranch_vccnz L_rtyu11_84
L_oku11_83:
  v_mfma_f32_16x16x32_bf16 a[24:27], v[92:95], v[228:231], a[24:27]
  global_load_dwordx4 v[76:79], v30, s[44:45] offset:-1024 sc1
  v_mfma_f32_16x16x32_bf16 a[28:31], v[92:95], v[232:235], a[28:31]
  v_add_f32 v114, v114, v134
  v_add_f32 v115, v115, v135
  v_mfma_f32_16x16x32_bf16 a[32:35], v[92:95], v[236:239], a[32:35]
  v_cvt_pk_bf16_f32 v112, v112, v113
  v_cvt_pk_bf16_f32 v113, v114, v115
  v_mfma_f32_16x16x32_bf16 v[120:123], v[92:95], v[224:227], v[120:123]
  ds_write_b64 v17, v[112:113] offset:0
  v_mfma_f32_16x16x32_bf16 a[24:27], v[96:99], v[244:247], a[24:27]
  global_load_dwordx4 v[80:83], v1, s[46:47] offset:-4096 sc1
  v_mfma_f32_16x16x32_bf16 a[28:31], v[96:99], v[248:251], a[28:31]
  s_waitcnt lgkmcnt(1)
  v_add_f32 v144, v144, v148
  v_add_f32 v116, v116, v152
  v_mfma_f32_16x16x32_bf16 a[32:35], v[96:99], v[252:255], a[32:35]
  v_add_f32 v145, v145, v149
  v_add_f32 v117, v117, v153
  v_mfma_f32_16x16x32_bf16 v[120:123], v[96:99], v[240:243], v[120:123]
  v_add_f32 v146, v146, v150
  v_add_f32 v118, v118, v154
  v_mfma_f32_16x16x32_bf16 a[24:27], v[100:103], a[76:79], a[24:27]
  global_load_dwordx4 v[84:87], v1, s[46:47] offset:-3072 sc1
  v_mfma_f32_16x16x32_bf16 a[28:31], v[100:103], a[80:83], a[28:31]
  s_waitcnt vmcnt(11)
  v_max3_u32 v28, v32, v36, v40
  v_mfma_f32_16x16x32_bf16 a[32:35], v[100:103], a[84:87], a[32:35]
  v_cmp_eq_u32 vcc, -1, v28
  v_mfma_f32_16x16x32_bf16 v[120:123], v[100:103], a[72:75], v[120:123]
  v_add_f32 v147, v147, v151
  v_add_f32 v119, v119, v155
  s_cbranch_vccnz L_rtyu12_86
L_oku12_85:
  v_mfma_f32_16x16x32_bf16 a[36:39], v[32:35], a[140:143], 0
  global_load_dwordx4 v[88:91], v1, s[46:47] offset:-2048 sc1
  v_mfma_f32_16x16x32_bf16 a[40:43], v[32:35], a[144:147], 0
  v_add_f32 v116, v116, v144
  v_add_f32 v117, v117, v145
  v_mfma_f32_16x16x32_bf16 a[44:47], v[32:35], a[148:151], 0
  v_add_f32 v118, v118, v146
  v_add_f32 v119, v119, v147
  v_mfma_f32_16x16x32_bf16 v[124:127], v[32:35], a[136:139], v[124:127]
  v_cvt_pk_bf16_f32 v116, v116, v117
  v_cvt_pk_bf16_f32 v117, v118, v119
  v_mfma_f32_16x16x32_bf16 a[36:39], v[36:39], a[156:159], a[36:39]
  global_load_dwordx4 v[92:95], v1, s[46:47] offset:-1024 sc1
  v_mfma_f32_16x16x32_bf16 a[40:43], v[36:39], a[160:163], a[40:43]
  ds_write_b64 v17, v[116:117] offset:32
  v_mfma_f32_16x16x32_bf16 a[44:47], v[36:39], a[164:167], a[44:47]
  ds_write_b128 v23, a[24:27] offset:2048
  v_mfma_f32_16x16x32_bf16 v[124:127], v[36:39], a[152:155], v[124:127]
  v_mfma_f32_16x16x32_bf16 a[36:39], v[40:43], a[172:175], a[36:39]
  global_load_dwordx4 v[96:99], v1, s[46:47] offset:0 sc1
  v_mfma_f32_16x16x32_bf16 a[40:43], v[40:43], a[176:179], a[40:43]
  s_waitcnt vmcnt(11)
  v_max3_u32 v28, v44, v48, v52
  v_mfma_f32_16x16x32_bf16 a[44:47], v[40:43], a[180:183], a[44:47]
  v_cmp_eq_u32 vcc, -1, v28
  v_mfma_f32_16x16x32_bf16 v[124:127], v[40:43], a[168:171], v[124:127]
  ds_write_b128 v24, a[28:31] offset:7168
  s_cbranch_vccnz L_rtyu13_88
L_oku13_87:
  v_mfma_f32_16x16x32_bf16 a[36:39], v[44:47], a[188:191], a[36:39]
  global_load_dwordx4 v[100:103], v1, s[46:47] offset:1024 sc1
  v_mfma_f32_16x16x32_bf16 a[40:43], v[44:47], a[192:195], a[40:43]
  ds_write_b128 v25, a[32:35] offset:12288
  v_mfma_f32_16x16x32_bf16 a[44:47], v[44:47], a[196:199], a[44:47]
  v_mfma_f32_16x16x32_bf16 v[124:127], v[44:47], a[184:187], v[124:127]
  v_mfma_f32_16x16x32_bf16 a[36:39], v[48:51], a[204:207], a[36:39]
  global_load_dwordx4 v[32:35], v1, s[46:47] offset:2048 sc1
  v_mfma_f32_16x16x32_bf16 a[40:43], v[48:51], a[208:211], a[40:43]
  v_mfma_f32_16x16x32_bf16 a[44:47], v[48:51], a[212:215], a[44:47]
  s_waitcnt lgkmcnt(0)
  s_barrier
  v_mfma_f32_16x16x32_bf16 v[124:127], v[48:51], a[200:203], v[124:127]
  ds_read_b128 v[156:159], v26 offset:2048
  ds_read_b128 v[160:163], v26 offset:7168
  v_mfma_f32_16x16x32_bf16 a[36:39], v[52:55], a[220:223], a[36:39]
  global_load_dwordx4 v[36:39], v1, s[46:47] offset:3072 sc1
  v_mfma_f32_16x16x32_bf16 a[40:43], v[52:55], a[224:227], a[40:43]
  s_waitcnt vmcnt(11)
  v_max3_u32 v28, v56, v60, v64
  v_mfma_f32_16x16x32_bf16 a[44:47], v[52:55], a[228:231], a[44:47]
  v_cmp_eq_u32 vcc, -1, v28
  v_mfma_f32_16x16x32_bf16 v[124:127], v[52:55], a[216:219], v[124:127]
  ds_read_b128 v[164:167], v26 offset:12288
  s_cbranch_vccnz L_rtyu14_90
L_oku14_89:
  v_mfma_f32_16x16x32_bf16 a[36:39], v[56:59], a[236:239], a[36:39]
  global_load_dwordx4 v[40:43], v30, s[46:47] offset:-4096 sc1
  v_mfma_f32_16x16x32_bf16 a[40:43], v[56:59], a[240:243], a[40:43]
  v_mfma_f32_16x16x32_bf16 a[44:47], v[56:59], a[244:247], a[44:47]
  v_mfma_f32_16x16x32_bf16 v[124:127], v[56:59], a[232:235], v[124:127]
  s_waitcnt lgkmcnt(0)
  v_add_f32 v156, v156, v160
  v_add_f32 v120, v120, v164
  v_mfma_f32_16x16x32_bf16 a[36:39], v[60:63], v[196:199], a[36:39]
  global_load_dwordx4 v[44:47], v30, s[46:47] offset:-3072 sc1
  v_mfma_f32_16x16x32_bf16 a[40:43], v[60:63], v[200:203], a[40:43]
  v_add_f32 v157, v157, v161
  v_add_f32 v121, v121, v165
  v_mfma_f32_16x16x32_bf16 a[44:47], v[60:63], v[204:207], a[44:47]
  v_add_f32 v158, v158, v162
  v_add_f32 v122, v122, v166
  v_mfma_f32_16x16x32_bf16 v[124:127], v[60:63], v[192:195], v[124:127]
  v_add_f32 v159, v159, v163
  v_add_f32 v123, v123, v167
  v_mfma_f32_16x16x32_bf16 a[36:39], v[64:67], v[212:215], a[36:39]
  global_load_dwordx4 v[48:51], v30, s[46:47] offset:-2048 sc1
  v_mfma_f32_16x16x32_bf16 a[40:43], v[64:67], v[216:219], a[40:43]
  s_waitcnt vmcnt(11)
  v_max3_u32 v28, v68, v72, v76
  v_mfma_f32_16x16x32_bf16 a[44:47], v[64:67], v[220:223], a[44:47]
  v_cmp_eq_u32 vcc, -1, v28
  v_mfma_f32_16x16x32_bf16 v[124:127], v[64:67], v[208:211], v[124:127]
  v_add_f32 v120, v120, v156
  v_add_f32 v121, v121, v157
  s_cbranch_vccnz L_rtyu15_92
L_oku15_91:
  v_mfma_f32_16x16x32_bf16 a[36:39], v[68:71], v[228:231], a[36:39]
  global_load_dwordx4 v[52:55], v30, s[46:47] offset:-1024 sc1
  v_mfma_f32_16x16x32_bf16 a[40:43], v[68:71], v[232:235], a[40:43]
  v_add_f32 v122, v122, v158
  v_add_f32 v123, v123, v159
  v_mfma_f32_16x16x32_bf16 a[44:47], v[68:71], v[236:239], a[44:47]
  v_cvt_pk_bf16_f32 v120, v120, v121
  v_cvt_pk_bf16_f32 v121, v122, v123
  v_mfma_f32_16x16x32_bf16 v[124:127], v[68:71], v[224:227], v[124:127]
  ds_write_b64 v17, v[120:121] offset:64
  v_mfma_f32_16x16x32_bf16 a[36:39], v[72:75], v[244:247], a[36:39]
  v_mfma_f32_16x16x32_bf16 a[40:43], v[72:75], v[248:251], a[40:43]
  v_mfma_f32_16x16x32_bf16 a[44:47], v[72:75], v[252:255], a[44:47]
  v_mfma_f32_16x16x32_bf16 v[124:127], v[72:75], v[240:243], v[124:127]
  v_mfma_f32_16x16x32_bf16 a[36:39], v[76:79], a[76:79], a[36:39]
  v_mfma_f32_16x16x32_bf16 a[40:43], v[76:79], a[80:83], a[40:43]
  s_waitcnt vmcnt(9)
  v_max3_u32 v28, v80, v84, v88
  v_mfma_f32_16x16x32_bf16 a[44:47], v[76:79], a[84:87], a[44:47]
  v_cmp_eq_u32 vcc, -1, v28
  v_mfma_f32_16x16x32_bf16 v[124:127], v[76:79], a[72:75], v[124:127]
  s_cbranch_vccnz L_rtyu16_94
L_oku16_93:
  v_mfma_f32_16x16x32_bf16 a[48:51], v[80:83], a[140:143], 0
  v_mfma_f32_16x16x32_bf16 a[52:55], v[80:83], a[144:147], 0
  v_mfma_f32_16x16x32_bf16 a[56:59], v[80:83], a[148:151], 0
  v_mfma_f32_16x16x32_bf16 v[128:131], v[80:83], a[136:139], v[128:131]
  v_mfma_f32_16x16x32_bf16 a[48:51], v[84:87], a[156:159], a[48:51]
  v_mfma_f32_16x16x32_bf16 a[52:55], v[84:87], a[160:163], a[52:55]
  ds_write_b128 v23, a[36:39] offset:3072
  v_mfma_f32_16x16x32_bf16 a[56:59], v[84:87], a[164:167], a[56:59]
  v_mfma_f32_16x16x32_bf16 v[128:131], v[84:87], a[152:155], v[128:131]
  ds_write_b128 v24, a[40:43] offset:8192
  v_mfma_f32_16x16x32_bf16 a[48:51], v[88:91], a[172:175], a[48:51]
  v_mfma_f32_16x16x32_bf16 a[52:55], v[88:91], a[176:179], a[52:55]
  s_waitcnt vmcnt(6)
  v_max3_u32 v28, v92, v96, v100
  v_mfma_f32_16x16x32_bf16 a[56:59], v[88:91], a[180:183], a[56:59]
  v_cmp_eq_u32 vcc, -1, v28
  v_mfma_f32_16x16x32_bf16 v[128:131], v[88:91], a[168:171], v[128:131]
  ds_write_b128 v25, a[44:47] offset:13312
  s_cbranch_vccnz L_rtyu17_96
L_oku17_95:
  v_mfma_f32_16x16x32_bf16 a[48:51], v[92:95], a[188:191], a[48:51]
  v_mfma_f32_16x16x32_bf16 a[52:55], v[92:95], a[192:195], a[52:55]
  v_mfma_f32_16x16x32_bf16 a[56:59], v[92:95], a[196:199], a[56:59]
  v_mfma_f32_16x16x32_bf16 v[128:131], v[92:95], a[184:187], v[128:131]
  v_mfma_f32_16x16x32_bf16 a[48:51], v[96:99], a[204:207], a[48:51]
  s_waitcnt lgkmcnt(0)
  s_barrier
  v_mfma_f32_16x16x32_bf16 a[52:55], v[96:99], a[208:211], a[52:55]
  ds_read_b128 v[168:171], v26 offset:3072
  ds_read_b128 v[172:175], v26 offset:8192
  v_mfma_f32_16x16x32_bf16 a[56:59], v[96:99], a[212:215], a[56:59]
  ds_read_b128 v[176:179], v26 offset:13312
  v_mfma_f32_16x16x32_bf16 v[128:131], v[96:99], a[200:203], v[128:131]
  v_mfma_f32_16x16x32_bf16 a[48:51], v[100:103], a[220:223], a[48:51]
  v_mfma_f32_16x16x32_bf16 a[52:55], v[100:103], a[224:227], a[52:55]
  s_waitcnt vmcnt(3)
  v_max3_u32 v28, v32, v36, v40
  v_mfma_f32_16x16x32_bf16 a[56:59], v[100:103], a[228:231], a[56:59]
  v_cmp_eq_u32 vcc, -1, v28
  v_mfma_f32_16x16x32_bf16 v[128:131], v[100:103], a[216:219], v[128:131]
  s_waitcnt lgkmcnt(0)
  v_add_f32 v168, v168, v172
  v_add_f32 v124, v124, v176
  s_cbranch_vccnz L_rtyu18_98
L_oku18_97:
  v_mfma_f32_16x16x32_bf16 a[48:51], v[32:35], a[236:239], a[48:51]
  v_add_f32 v169, v169, v173
  v_add_f32 v125, v125, v177
  v_mfma_f32_16x16x32_bf16 a[52:55], v[32:35], a[240:243], a[52:55]
  v_add_f32 v170, v170, v174
  v_add_f32 v126, v126, v178
  v_mfma_f32_16x16x32_bf16 a[56:59], v[32:35], a[244:247], a[56:59]
  v_add_f32 v171, v171, v175
  v_add_f32 v127, v127, v179
  v_mfma_f32_16x16x32_bf16 v[128:131], v[32:35], a[232:235], v[128:131]
  v_add_f32 v124, v124, v168
  v_add_f32 v125, v125, v169
  v_mfma_f32_16x16x32_bf16 a[48:51], v[36:39], v[196:199], a[48:51]
  v_add_f32 v126, v126, v170
  v_add_f32 v127, v127, v171
  v_mfma_f32_16x16x32_bf16 a[52:55], v[36:39], v[200:203], a[52:55]
  v_cvt_pk_bf16_f32 v124, v124, v125
  v_cvt_pk_bf16_f32 v125, v126, v127
  v_mfma_f32_16x16x32_bf16 a[56:59], v[36:39], v[204:207], a[56:59]
  ds_write_b64 v17, v[124:125] offset:96
  v_mfma_f32_16x16x32_bf16 v[128:131], v[36:39], v[192:195], v[128:131]
  ds_read_b128 v[104:107], v18 offset:0
  ds_read_b128 v[108:111], v18 offset:1152
  v_mfma_f32_16x16x32_bf16 a[48:51], v[40:43], v[212:215], a[48:51]
  v_mfma_f32_16x16x32_bf16 a[52:55], v[40:43], v[216:219], a[52:55]
  s_waitcnt vmcnt(0)
  v_max3_u32 v28, v44, v48, v52
  v_mfma_f32_16x16x32_bf16 a[56:59], v[40:43], v[220:223], a[56:59]
  v_cmp_eq_u32 vcc, -1, v28
  v_mfma_f32_16x16x32_bf16 v[128:131], v[40:43], v[208:211], v[128:131]
  s_cbranch_vccnz L_rtyu19_100
L_oku19_99:
  v_mfma_f32_16x16x32_bf16 a[48:51], v[44:47], v[228:231], a[48:51]
  v_mfma_f32_16x16x32_bf16 a[48:51], v[48:51], v[244:247], a[48:51]
  v_mfma_f32_16x16x32_bf16 a[48:51], v[52:55], a[76:79], a[48:51]
  v_mfma_f32_16x16x32_bf16 a[52:55], v[44:47], v[232:235], a[52:55]
  v_mfma_f32_16x16x32_bf16 a[52:55], v[48:51], v[248:251], a[52:55]
  v_mfma_f32_16x16x32_bf16 a[52:55], v[52:55], a[80:83], a[52:55]
  v_mfma_f32_16x16x32_bf16 a[56:59], v[44:47], v[236:239], a[56:59]
  v_mfma_f32_16x16x32_bf16 a[56:59], v[48:51], v[252:255], a[56:59]
  v_mfma_f32_16x16x32_bf16 a[56:59], v[52:55], a[84:87], a[56:59]
  s_nop 1
  ds_write_b128 v23, a[48:51] offset:4096
  v_mfma_f32_16x16x32_bf16 v[128:131], v[44:47], v[224:227], v[128:131]
  v_mfma_f32_16x16x32_bf16 v[128:131], v[48:51], v[240:243], v[128:131]
  ds_write_b128 v24, a[52:55] offset:9216
  v_mfma_f32_16x16x32_bf16 v[128:131], v[52:55], a[72:75], v[128:131]
  s_waitcnt lgkmcnt(2)
  buffer_store_dwordx4 v[104:107], v19, s[56:59], s10 offen
  ds_write_b128 v25, a[56:59] offset:14336
  buffer_store_dwordx4 v[108:111], v19, s[56:59], s13 offen
  s_waitcnt lgkmcnt(0)
  s_barrier
  ds_read_b128 v[180:183], v26 offset:4096
  ds_read_b128 v[184:187], v26 offset:9216
  ds_read_b128 v[188:191], v26 offset:14336
  s_waitcnt lgkmcnt(0)
  v_add_f32 v180, v180, v184
  v_add_f32 v128, v128, v188
  v_add_f32 v181, v181, v185
  v_add_f32 v129, v129, v189
  v_add_f32 v182, v182, v186
  v_add_f32 v130, v130, v190
  v_add_f32 v183, v183, v187
  v_add_f32 v131, v131, v191
  v_add_f32 v128, v128, v180
  v_add_f32 v129, v129, v181
  v_add_f32 v130, v130, v182
  v_add_f32 v131, v131, v183
  v_cvt_pk_bf16_f32 v128, v128, v129
  v_cvt_pk_bf16_f32 v129, v130, v131
  buffer_store_dwordx2 v[128:129], v27, s[56:59], s10 offen offset:128
L_exit:
  s_endpgm
L_spin1:
  s_sub_u32 s75, s75, 1
  s_cbranch_scc1 L_exit
  v_and_b32 v66, 7, v0
  v_lshlrev_b32 v66, 2, v66
  global_load_dword v67, v66, s[26:27] sc1
  s_waitcnt vmcnt(0)
  v_cmp_ne_u32 vcc, 1, v67
  s_cbranch_vccz L_spin1_done
  s_sleep 4
  s_branch L_spin1
L_rtykv0_2:
  s_sub_u32 s75, s75, 1
  s_cbranch_scc1 L_exit
  global_load_dwordx2 v[104:105], v4, s[14:15] offset:2048 sc1
  global_load_dwordx4 v[96:99], v1, s[14:15] offset:0 sc1
  global_load_dwordx4 v[100:103], v1, s[14:15] offset:1024 sc1
  global_load_dwordx4 v[106:109], v6, s[14:15] offset:0 sc1
  global_load_dwordx4 v[110:113], v6, s[14:15] offset:768 sc1
  global_load_dwordx4 v[114:117], v6, s[14:15] offset:1536 sc1
  global_load_dwordx4 v[118:121], v6, s[14:15] offset:2304 sc1
  s_waitcnt vmcnt(0)
  v_max3_u32 v60, v96, v100, v104
  v_max3_u32 v60, v60, v106, v110
  v_max3_u32 v60, v60, v114, v118
  v_cmp_eq_u32 vcc, -1, v60
  s_cbranch_vccnz L_rtykv0_2
  s_branch L_okkv0_1
L_rtykv1_4:
  s_sub_u32 s75, s75, 1
  s_cbranch_scc1 L_exit
  global_load_dwordx2 v[130:131], v4, s[14:15] offset:2048 sc1
  global_load_dwordx4 v[122:125], v1, s[14:15] offset:0 sc1
  global_load_dwordx4 v[126:129], v1, s[14:15] offset:1024 sc1
  global_load_dwordx4 v[132:135], v6, s[14:15] offset:0 sc1
  global_load_dwordx4 v[136:139], v6, s[14:15] offset:768 sc1
  global_load_dwordx4 v[140:143], v6, s[14:15] offset:1536 sc1
  global_load_dwordx4 v[144:147], v6, s[14:15] offset:2304 sc1
  s_waitcnt vmcnt(0)
  v_max3_u32 v27, v122, v126, v130
  v_max3_u32 v27, v27, v132, v136
  v_max3_u32 v27, v27, v140, v144
  v_cmp_eq_u32 vcc, -1, v27
  s_cbranch_vccnz L_rtykv1_4
  s_branch L_okkv1_3
L_rtykv2_6:
  s_sub_u32 s75, s75, 1
  s_cbranch_scc1 L_exit
  global_load_dwordx2 v[104:105], v4, s[14:15] offset:2048 sc1
  global_load_dwordx4 v[96:99], v1, s[14:15] offset:0 sc1
  global_load_dwordx4 v[100:103], v1, s[14:15] offset:1024 sc1
  global_load_dwordx4 v[106:109], v6, s[14:15] offset:0 sc1
  global_load_dwordx4 v[110:113], v6, s[14:15] offset:768 sc1
  global_load_dwordx4 v[114:117], v6, s[14:15] offset:1536 sc1
  global_load_dwordx4 v[118:121], v6, s[14:15] offset:2304 sc1
  s_waitcnt vmcnt(0)
  v_max3_u32 v27, v96, v100, v104
  v_max3_u32 v27, v27, v106, v110
  v_max3_u32 v27, v27, v114, v118
  v_cmp_eq_u32 vcc, -1, v27
  s_cbranch_vccnz L_rtykv2_6
  s_branch L_okkv2_5
L_rtykv3_8:
  s_sub_u32 s75, s75, 1
  s_cbranch_scc1 L_exit
  global_load_dwordx2 v[130:131], v4, s[14:15] offset:2048 sc1
  global_load_dwordx4 v[122:125], v1, s[14:15] offset:0 sc1
  global_load_dwordx4 v[126:129], v1, s[14:15] offset:1024 sc1
  global_load_dwordx4 v[132:135], v6, s[14:15] offset:0 sc1
  global_load_dwordx4 v[136:139], v6, s[14:15] offset:768 sc1
  global_load_dwordx4 v[140:143], v6, s[14:15] offset:1536 sc1
  global_load_dwordx4 v[144:147], v6, s[14:15] offset:2304 sc1
  s_waitcnt vmcnt(0)
  v_max3_u32 v27, v122, v126, v130
  v_max3_u32 v27, v27, v132, v136
  v_max3_u32 v27, v27, v140, v144
  v_cmp_eq_u32 vcc, -1, v27
  s_cbranch_vccnz L_rtykv3_8
  s_branch L_okkv3_7
L_rtykv4_10:
  s_sub_u32 s75, s75, 1
  s_cbranch_scc1 L_exit
  global_load_dwordx2 v[104:105], v4, s[14:15] offset:2048 sc1
  global_load_dwordx4 v[96:99], v1, s[14:15] offset:0 sc1
  global_load_dwordx4 v[100:103], v1, s[14:15] offset:1024 sc1
  global_load_dwordx4 v[106:109], v6, s[14:15] offset:0 sc1
  global_load_dwordx4 v[110:113], v6, s[14:15] offset:768 sc1
  global_load_dwordx4 v[114:117], v6, s[14:15] offset:1536 sc1
  global_load_dwordx4 v[118:121], v6, s[14:15] offset:2304 sc1
  s_waitcnt vmcnt(0)
  v_max3_u32 v27, v96, v100, v104
  v_max3_u32 v27, v27, v106, v110
  v_max3_u32 v27, v27, v114, v118
  v_cmp_eq_u32 vcc, -1, v27
  s_cbranch_vccnz L_rtykv4_10
  s_branch L_okkv4_9
L_rtykv5_12:
  s_sub_u32 s75, s75, 1
  s_cbranch_scc1 L_exit
  global_load_dwordx2 v[130:131], v4, s[14:15] offset:2048 sc1
  global_load_dwordx4 v[122:125], v1, s[14:15] offset:0 sc1
  global_load_dwordx4 v[126:129], v1, s[14:15] offset:1024 sc1
  global_load_dwordx4 v[132:135], v6, s[14:15] offset:0 sc1
  global_load_dwordx4 v[136:139], v6, s[14:15] offset:768 sc1
  global_load_dwordx4 v[140:143], v6, s[14:15] offset:1536 sc1
  global_load_dwordx4 v[144:147], v6, s[14:15] offset:2304 sc1
  s_waitcnt vmcnt(0)
  v_max3_u32 v27, v122, v126, v130
  v_max3_u32 v27, v27, v132, v136
  v_max3_u32 v27, v27, v140, v144
  v_cmp_eq_u32 vcc, -1, v27
  s_cbranch_vccnz L_rtykv5_12
  s_branch L_okkv5_11
L_rtykv6_14:
  s_sub_u32 s75, s75, 1
  s_cbranch_scc1 L_exit
  global_load_dwordx2 v[104:105], v4, s[14:15] offset:2048 sc1
  global_load_dwordx4 v[96:99], v1, s[14:15] offset:0 sc1
  global_load_dwordx4 v[100:103], v1, s[14:15] offset:1024 sc1
  global_load_dwordx4 v[106:109], v6, s[14:15] offset:0 sc1
  global_load_dwordx4 v[110:113], v6, s[14:15] offset:768 sc1
  global_load_dwordx4 v[114:117], v6, s[14:15] offset:1536 sc1
  global_load_dwordx4 v[118:121], v6, s[14:15] offset:2304 sc1
  s_waitcnt vmcnt(0)
  v_max3_u32 v27, v96, v100, v104
  v_max3_u32 v27, v27, v106, v110
  v_max3_u32 v27, v27, v114, v118
  v_cmp_eq_u32 vcc, -1, v27
  s_cbranch_vccnz L_rtykv6_14
  s_branch L_okkv6_13
L_rtykv7_16:
  s_sub_u32 s75, s75, 1
  s_cbranch_scc1 L_exit
  global_load_dwordx2 v[130:131], v4, s[14:15] offset:2048 sc1
  global_load_dwordx4 v[122:125], v1, s[14:15] offset:0 sc1
  global_load_dwordx4 v[126:129], v1, s[14:15] offset:1024 sc1
  global_load_dwordx4 v[132:135], v6, s[14:15] offset:0 sc1
  global_load_dwordx4 v[136:139], v6, s[14:15] offset:768 sc1
  global_load_dwordx4 v[140:143], v6, s[14:15] offset:1536 sc1
  global_load_dwordx4 v[144:147], v6, s[14:15] offset:2304 sc1
  s_waitcnt vmcnt(0)
  v_max3_u32 v27, v122, v126, v130
  v_max3_u32 v27, v27, v132, v136
  v_max3_u32 v27, v27, v140, v144
  v_cmp_eq_u32 vcc, -1, v27
  s_cbranch_vccnz L_rtykv7_16
  s_branch L_okkv7_15
L_spin2:
  s_sub_u32 s75, s75, 1
  s_cbranch_scc1 L_exit
  v_and_b32 v28, 31, v0
  v_lshlrev_b32 v28, 7, v28
  v_add_u32 v28, 196608, v28
  global_load_dwordx2 v[28:29], v28, s[28:29] sc1
  s_waitcnt vmcnt(0)
  v_cmp_gt_u32 vcc, 8, v28
  v_readlane_b32 s9, v29, s67
  s_nop 1
  s_mov_b32 s88, vcc_lo
  s_cbranch_vccz L_spin2_done
  s_sleep 4
  s_branch L_spin2
L_wto:
  buffer_store_dwordx4 v[136:139], v1, s[60:63], s80 offen sc1
  buffer_store_dwordx4 v[140:143], v1, s[60:63], s80 offen offset:1024 sc1
  s_mov_b32 exec_hi, 0
  buffer_store_dwordx4 v[144:147], v1, s[60:63], s81 offen sc1
  s_mov_b32 exec_hi, -1
  s_waitcnt vmcnt(0)
  s_branch L_wtdo
L_rtyo1_20:
  s_sub_u32 s75, s75, 1
  s_cbranch_scc1 L_exit
  buffer_load_dwordx4 v[48:51], v18, s[60:63], s83 offen offset:0 sc1
  buffer_load_dwordx4 v[52:55], v18, s[60:63], s83 offen offset:2048 sc1
  buffer_load_dwordx4 v[56:59], v30, s[60:63], s83 offen offset:0 sc1
  buffer_load_dwordx4 v[60:63], v30, s[60:63], s83 offen offset:2048 sc1
  s_waitcnt vmcnt(0)
  v_max3_u32 v28, v48, v52, v56
  v_max_u32 v28, v28, v60
  v_cmp_eq_u32 vcc, -1, v28
  s_cbranch_vccnz L_rtyo1_20
  s_branch L_oko1_19
L_rtyo2_22:
  s_sub_u32 s75, s75, 1
  s_cbranch_scc1 L_exit
  buffer_load_dwordx4 v[64:67], v18, s[60:63], s87 offen offset:0 sc1
  buffer_load_dwordx4 v[68:71], v18, s[60:63], s87 offen offset:2048 sc1
  buffer_load_dwordx4 v[72:75], v30, s[60:63], s87 offen offset:0 sc1
  buffer_load_dwordx4 v[76:79], v30, s[60:63], s87 offen offset:2048 sc1
  s_waitcnt vmcnt(0)
  v_max3_u32 v28, v64, v68, v72
  v_max_u32 v28, v28, v76
  v_cmp_eq_u32 vcc, -1, v28
  s_cbranch_vccnz L_rtyo2_22
  s_branch L_oko2_21
L_rtyo3_24:
  s_sub_u32 s75, s75, 1
  s_cbranch_scc1 L_exit
  buffer_load_dwordx4 v[80:83], v18, s[60:63], s95 offen offset:0 sc1
  buffer_load_dwordx4 v[84:87], v18, s[60:63], s95 offen offset:2048 sc1
  buffer_load_dwordx4 v[88:91], v30, s[60:63], s95 offen offset:0 sc1
  buffer_load_dwordx4 v[92:95], v30, s[60:63], s95 offen offset:2048 sc1
  s_waitcnt vmcnt(0)
  v_max3_u32 v28, v80, v84, v88
  v_max_u32 v28, v28, v92
  v_cmp_eq_u32 vcc, -1, v28
  s_cbranch_vccnz L_rtyo3_24
  s_branch L_oko3_23
L_rtyo4_26:
  s_sub_u32 s75, s75, 1
  s_cbranch_scc1 L_exit
  buffer_load_dwordx4 v[96:99], v18, s[60:63], s89 offen offset:0 sc1
  buffer_load_dwordx4 v[100:103], v18, s[60:63], s89 offen offset:2048 sc1
  buffer_load_dwordx4 v[104:107], v30, s[60:63], s89 offen offset:0 sc1
  buffer_load_dwordx4 v[108:111], v30, s[60:63], s89 offen offset:2048 sc1
  s_waitcnt vmcnt(0)
  v_max3_u32 v28, v96, v100, v104
  v_max_u32 v28, v28, v108
  v_cmp_eq_u32 vcc, -1, v28
  s_cbranch_vccnz L_rtyo4_26
  s_branch L_oko4_25
L_wtst:
  s_mov_b32 exec_lo, 0xffff
  s_mov_b32 exec_hi, 0xffff
  buffer_store_dword v60, v1, s[60:63], s85 offen sc1
  s_mov_b64 exec, -1
  s_waitcnt vmcnt(0)
  s_branch L_wtdst
L_rtyhn1_32:
  s_sub_u32 s75, s75, 1
  s_cbranch_scc1 L_exit
  s_sleep 1
  s_add_u32 s7, s5, 1
  s_and_b32 s7, s7, 7
  s_lshl_b32 s7, s7, 12
  s_add_u32 s7, s7, s78
  buffer_load_dwordx4 v[48:51], v1, s[60:63], s7 offen offset:0 sc1
  buffer_load_dwordx4 v[52:55], v1, s[60:63], s7 offen offset:1024 sc1
  buffer_load_dwordx4 v[56:59], v1, s[60:63], s7 offen offset:2048 sc1
  buffer_load_dwordx4 v[60:63], v1, s[60:63], s7 offen offset:3072 sc1
  s_waitcnt vmcnt(0)
  v_max3_u32 v28, v48, v52, v56
  v_max_u32 v28, v28, v60
  v_cmp_eq_u32 vcc, -1, v28
  s_cbranch_vccnz L_rtyhn1_32
  s_branch L_okhn1_31
L_rtyhn2_34:
  s_sub_u32 s75, s75, 1
  s_cbranch_scc1 L_exit
  s_sleep 1
  s_add_u32 s7, s5, 2
  s_and_b32 s7, s7, 7
  s_lshl_b32 s7, s7, 12
  s_add_u32 s7, s7, s78
  buffer_load_dwordx4 v[64:67], v1, s[60:63], s7 offen offset:0 sc1
  buffer_load_dwordx4 v[68:71], v1, s[60:63], s7 offen offset:1024 sc1
  buffer_load_dwordx4 v[72:75], v1, s[60:63], s7 offen offset:2048 sc1
  buffer_load_dwordx4 v[76:79], v1, s[60:63], s7 offen offset:3072 sc1
  s_waitcnt vmcnt(0)
  v_max3_u32 v28, v64, v68, v72
  v_max_u32 v28, v28, v76
  v_cmp_eq_u32 vcc, -1, v28
  s_cbranch_vccnz L_rtyhn2_34
  s_branch L_okhn2_33
L_rtyhn3_36:
  s_sub_u32 s75, s75, 1
  s_cbranch_scc1 L_exit
  s_sleep 1
  s_add_u32 s7, s5, 3
  s_and_b32 s7, s7, 7
  s_lshl_b32 s7, s7, 12
  s_add_u32 s7, s7, s78
  buffer_load_dwordx4 v[80:83], v1, s[60:63], s7 offen offset:0 sc1
  buffer_load_dwordx4 v[84:87], v1, s[60:63], s7 offen offset:1024 sc1
  buffer_load_dwordx4 v[88:91], v1, s[60:63], s7 offen offset:2048 sc1
  buffer_load_dwordx4 v[92:95], v1, s[60:63], s7 offen offset:3072 sc1
  s_waitcnt vmcnt(0)
  v_max3_u32 v28, v80, v84, v88
  v_max_u32 v28, v28, v92
  v_cmp_eq_u32 vcc, -1, v28
  s_cbranch_vccnz L_rtyhn3_36
  s_branch L_okhn3_35
L_rtyhn4_38:
  s_sub_u32 s75, s75, 1
  s_cbranch_scc1 L_exit
  s_sleep 1
  s_add_u32 s7, s5, 4
  s_and_b32 s7, s7, 7
  s_lshl_b32 s7, s7, 12
  s_add_u32 s7, s7, s78
  buffer_load_dwordx4 v[32:35], v1, s[60:63], s7 offen offset:0 sc1
  buffer_load_dwordx4 v[36:39], v1, s[60:63], s7 offen offset:1024 sc1
  buffer_load_dwordx4 v[40:43], v1, s[60:63], s7 offen offset:2048 sc1
  buffer_load_dwordx4 v[44:47], v1, s[60:63], s7 offen offset:3072 sc1
  s_waitcnt vmcnt(0)
  v_max3_u32 v28, v32, v36, v40
  v_max_u32 v28, v28, v44
  v_cmp_eq_u32 vcc, -1, v28
  s_cbranch_vccnz L_rtyhn4_38
  s_branch L_okhn4_37
L_rtyhn5_40:
  s_sub_u32 s75, s75, 1
  s_cbranch_scc1 L_exit
  s_sleep 1
  s_add_u32 s7, s5, 5
  s_and_b32 s7, s7, 7
  s_lshl_b32 s7, s7, 12
  s_add_u32 s7, s7, s78
  buffer_load_dwordx4 v[48:51], v1, s[60:63], s7 offen offset:0 sc1
  buffer_load_dwordx4 v[52:55], v1, s[60:63], s7 offen offset:1024 sc1
  buffer_load_dwordx4 v[56:59], v1, s[60:63], s7 offen offset:2048 sc1
  buffer_load_dwordx4 v[60:63], v1, s[60:63], s7 offen offset:3072 sc1
  s_waitcnt vmcnt(0)
  v_max3_u32 v28, v48, v52, v56
  v_max_u32 v28, v28, v60
  v_cmp_eq_u32 vcc, -1, v28
  s_cbranch_vccnz L_rtyhn5_40
  s_branch L_okhn5_39
L_rtyhn6_42:
  s_sub_u32 s75, s75, 1
  s_cbranch_scc1 L_exit
  s_sleep 1
  s_add_u32 s7, s5, 6
  s_and_b32 s7, s7, 7
  s_lshl_b32 s7, s7, 12
  s_add_u32 s7, s7, s78
  buffer_load_dwordx4 v[64:67], v1, s[60:63], s7 offen offset:0 sc1
  buffer_load_dwordx4 v[68:71], v1, s[60:63], s7 offen offset:1024 sc1
  buffer_load_dwordx4 v[72:75], v1, s[60:63], s7 offen offset:2048 sc1
  buffer_load_dwordx4 v[76:79], v1, s[60:63], s7 offen offset:3072 sc1
  s_waitcnt vmcnt(0)
  v_max3_u32 v28, v64, v68, v72
  v_max_u32 v28, v28, v76
  v_cmp_eq_u32 vcc, -1, v28
  s_cbranch_vccnz L_rtyhn6_42
  s_branch L_okhn6_41
L_rtyhn7_44:
  s_sub_u32 s75, s75, 1
  s_cbranch_scc1 L_exit
  s_sleep 1
  s_add_u32 s7, s5, 7
  s_and_b32 s7, s7, 7
  s_lshl_b32 s7, s7, 12
  s_add_u32 s7, s7, s78
  buffer_load_dwordx4 v[80:83], v1, s[60:63], s7 offen offset:0 sc1
  buffer_load_dwordx4 v[84:87], v1, s[60:63], s7 offen offset:1024 sc1
  buffer_load_dwordx4 v[88:91], v1, s[60:63], s7 offen offset:2048 sc1
  buffer_load_dwordx4 v[92:95], v1, s[60:63], s7 offen offset:3072 sc1
  s_waitcnt vmcnt(0)
  v_max3_u32 v28, v80, v84, v88
  v_max_u32 v28, v28, v92
  v_cmp_eq_u32 vcc, -1, v28
  s_cbranch_vccnz L_rtyhn7_44
  s_branch L_okhn7_43
L_rtyhn8_46:
  s_sub_u32 s75, s75, 1
  s_cbranch_scc1 L_exit
  s_sleep 1
  s_add_u32 s7, s5, 8
  s_and_b32 s7, s7, 7
  s_lshl_b32 s7, s7, 12
  s_add_u32 s7, s7, s79
  buffer_load_dwordx4 v[32:35], v1, s[60:63], s7 offen offset:0 sc1
  buffer_load_dwordx4 v[36:39], v1, s[60:63], s7 offen offset:1024 sc1
  buffer_load_dwordx4 v[40:43], v1, s[60:63], s7 offen offset:2048 sc1
  buffer_load_dwordx4 v[44:47], v1, s[60:63], s7 offen offset:3072 sc1
  s_waitcnt vmcnt(0)
  v_max3_u32 v28, v32, v36, v40
  v_max_u32 v28, v28, v44
  v_cmp_eq_u32 vcc, -1, v28
  s_cbranch_vccnz L_rtyhn8_46
  s_branch L_okhn8_45
L_rtyhn9_48:
  s_sub_u32 s75, s75, 1
  s_cbranch_scc1 L_exit
  s_sleep 1
  s_add_u32 s7, s5, 9
  s_and_b32 s7, s7, 7
  s_lshl_b32 s7, s7, 12
  s_add_u32 s7, s7, s79
  buffer_load_dwordx4 v[48:51], v1, s[60:63], s7 offen offset:0 sc1
  buffer_load_dwordx4 v[52:55], v1, s[60:63], s7 offen offset:1024 sc1
  buffer_load_dwordx4 v[56:59], v1, s[60:63], s7 offen offset:2048 sc1
  buffer_load_dwordx4 v[60:63], v1, s[60:63], s7 offen offset:3072 sc1
  s_waitcnt vmcnt(0)
  v_max3_u32 v28, v48, v52, v56
  v_max_u32 v28, v28, v60
  v_cmp_eq_u32 vcc, -1, v28
  s_cbranch_vccnz L_rtyhn9_48
  s_branch L_okhn9_47
L_rtyhn10_50:
  s_sub_u32 s75, s75, 1
  s_cbranch_scc1 L_exit
  s_sleep 1
  s_add_u32 s7, s5, 10
  s_and_b32 s7, s7, 7
  s_lshl_b32 s7, s7, 12
  s_add_u32 s7, s7, s79
  buffer_load_dwordx4 v[64:67], v1, s[60:63], s7 offen offset:0 sc1
  buffer_load_dwordx4 v[68:71], v1, s[60:63], s7 offen offset:1024 sc1
  buffer_load_dwordx4 v[72:75], v1, s[60:63], s7 offen offset:2048 sc1
  buffer_load_dwordx4 v[76:79], v1, s[60:63], s7 offen offset:3072 sc1
  s_waitcnt vmcnt(0)
  v_max3_u32 v28, v64, v68, v72
  v_max_u32 v28, v28, v76
  v_cmp_eq_u32 vcc, -1, v28
  s_cbranch_vccnz L_rtyhn10_50
  s_branch L_okhn10_49
L_rtyhn11_52:
  s_sub_u32 s75, s75, 1
  s_cbranch_scc1 L_exit
  s_sleep 1
  s_add_u32 s7, s5, 11
  s_and_b32 s7, s7, 7
  s_lshl_b32 s7, s7, 12
  s_add_u32 s7, s7, s79
  buffer_load_dwordx4 v[80:83], v1, s[60:63], s7 offen offset:0 sc1
  buffer_load_dwordx4 v[84:87], v1, s[60:63], s7 offen offset:1024 sc1
  buffer_load_dwordx4 v[88:91], v1, s[60:63], s7 offen offset:2048 sc1
  buffer_load_dwordx4 v[92:95], v1, s[60:63], s7 offen offset:3072 sc1
  s_waitcnt vmcnt(0)
  v_max3_u32 v28, v80, v84, v88
  v_max_u32 v28, v28, v92
  v_cmp_eq_u32 vcc, -1, v28
  s_cbranch_vccnz L_rtyhn11_52
  s_branch L_okhn11_51
L_rtyhn12_54:
  s_sub_u32 s75, s75, 1
  s_cbranch_scc1 L_exit
  s_sleep 1
  s_add_u32 s7, s5, 12
  s_and_b32 s7, s7, 7
  s_lshl_b32 s7, s7, 12
  s_add_u32 s7, s7, s79
  buffer_load_dwordx4 v[32:35], v1, s[60:63], s7 offen offset:0 sc1
  buffer_load_dwordx4 v[36:39], v1, s[60:63], s7 offen offset:1024 sc1
  buffer_load_dwordx4 v[40:43], v1, s[60:63], s7 offen offset:2048 sc1
  buffer_load_dwordx4 v[44:47], v1, s[60:63], s7 offen offset:3072 sc1
  s_waitcnt vmcnt(0)
  v_max3_u32 v28, v32, v36, v40
  v_max_u32 v28, v28, v44
  v_cmp_eq_u32 vcc, -1, v28
  s_cbranch_vccnz L_rtyhn12_54
  s_branch L_okhn12_53
L_rtyhn13_56:
  s_sub_u32 s75, s75, 1
  s_cbranch_scc1 L_exit
  s_sleep 1
  s_add_u32 s7, s5, 13
  s_and_b32 s7, s7, 7
  s_lshl_b32 s7, s7, 12
  s_add_u32 s7, s7, s79
  buffer_load_dwordx4 v[48:51], v1, s[60:63], s7 offen offset:0 sc1
  buffer_load_dwordx4 v[52:55], v1, s[60:63], s7 offen offset:1024 sc1
  buffer_load_dwordx4 v[56:59], v1, s[60:63], s7 offen offset:2048 sc1
  buffer_load_dwordx4 v[60:63], v1, s[60:63], s7 offen offset:3072 sc1
  s_waitcnt vmcnt(0)
  v_max3_u32 v28, v48, v52, v56
  v_max_u32 v28, v28, v60
  v_cmp_eq_u32 vcc, -1, v28
  s_cbranch_vccnz L_rtyhn13_56
  s_branch L_okhn13_55
L_rtyhn14_58:
  s_sub_u32 s75, s75, 1
  s_cbranch_scc1 L_exit
  s_sleep 1
  s_add_u32 s7, s5, 14
  s_and_b32 s7, s7, 7
  s_lshl_b32 s7, s7, 12
  s_add_u32 s7, s7, s79
  buffer_load_dwordx4 v[64:67], v1, s[60:63], s7 offen offset:0 sc1
  buffer_load_dwordx4 v[68:71], v1, s[60:63], s7 offen offset:1024 sc1
  buffer_load_dwordx4 v[72:75], v1, s[60:63], s7 offen offset:2048 sc1
  buffer_load_dwordx4 v[76:79], v1, s[60:63], s7 offen offset:3072 sc1
  s_waitcnt vmcnt(0)
  v_max3_u32 v28, v64, v68, v72
  v_max_u32 v28, v28, v76
  v_cmp_eq_u32 vcc, -1, v28
  s_cbranch_vccnz L_rtyhn14_58
  s_branch L_okhn14_57
L_rtyhn15_60:
  s_sub_u32 s75, s75, 1
  s_cbranch_scc1 L_exit
  s_sleep 1
  s_add_u32 s7, s5, 15
  s_and_b32 s7, s7, 7
  s_lshl_b32 s7, s7, 12
  s_add_u32 s7, s7, s79
  buffer_load_dwordx4 v[80:83], v1, s[60:63], s7 offen offset:0 sc1
  buffer_load_dwordx4 v[84:87], v1, s[60:63], s7 offen offset:1024 sc1
  buffer_load_dwordx4 v[88:91], v1, s[60:63], s7 offen offset:2048 sc1
  buffer_load_dwordx4 v[92:95], v1, s[60:63], s7 offen offset:3072 sc1
  s_waitcnt vmcnt(0)
  v_max3_u32 v28, v80, v84, v88
  v_max_u32 v28, v28, v92
  v_cmp_eq_u32 vcc, -1, v28
  s_cbranch_vccnz L_rtyhn15_60
  s_branch L_okhn15_59
L_p3idle:
  v_bfe_u32 v96, v0, 2, 3
  v_lshrrev_b32 v97, 1, v96
  v_lshrrev_b32 v98, 5, v0
  v_lshlrev_b32 v98, 11, v98
  v_lshl_add_u32 v98, v96, 7, v98
  v_and_b32 v99, 3, v0
  v_lshl_add_u32 v98, v99, 3, v98
  v_add_u32 v98, s94, v98
  v_xor_b32 v97, s64, v97
  v_xor_b32 v99, 0, v97
  v_lshl_add_u32 v12, v99, 5, v98
  v_xor_b32 v99, 1, v97
  v_lshl_add_u32 v13, v99, 5, v98
  v_xor_b32 v99, 2, v97
  v_lshl_add_u32 v14, v99, 5, v98
  v_xor_b32 v99, 3, v97
  v_lshl_add_u32 v15, v99, 5, v98
  s_mul_i32 s73, s12, 48
  s_mul_i32 s74, s64, 12
  s_add_u32 s73, s73, s74
  s_lshl_b32 s73, s73, 10
  s_add_u32 s73, s73, 6426624
  s_and_b32 s74, s68, 1
  s_mul_i32 s74, s74, 835584
  s_add_u32 s74, s74, 98304
  s_add_u32 s38, s28, s73
  s_addc_u32 s39, s29, 0
  s_add_u32 s40, s38, 49152
  s_addc_u32 s41, s39, 0
  s_add_u32 s42, s38, s74
  s_addc_u32 s43, s39, 0
  s_add_u32 s44, s38, 983040
  s_addc_u32 s45, s39, 0
  s_add_u32 s46, s38, 1032192
  s_addc_u32 s47, s39, 0
  v_add_u32 v30, 8192, v1
  v_mul_u32_u24 v96, 144, v2
  v_lshl_add_u32 v96, v3, 3, v96
  v_add_u32 v17, s94, v96
  v_lshrrev_b32 v96, 3, v0
  v_and_b32 v97, 7, v0
  v_lshlrev_b32 v97, 4, v97
  v_mul_u32_u24 v98, 144, v96
  v_add3_u32 v18, v98, v97, s94
  v_mul_u32_u24 v98, 1280, v96
  v_add_u32 v19, v98, v97
  v_mul_u32_u24 v96, 1280, v2
  v_lshl_add_u32 v27, v3, 3, v96
  s_add_u32 s13, s10, 10240
  v_lshlrev_b32 v31, 16, v31
  v_add_f32 v112, v112, v31
  v_add_f32 v113, v113, v31
  v_add_f32 v114, v114, v31
  v_add_f32 v115, v115, v31
  v_add_f32 v116, v116, v31
  v_add_f32 v117, v117, v31
  v_add_f32 v118, v118, v31
  v_add_f32 v119, v119, v31
  v_add_f32 v120, v120, v31
  v_add_f32 v121, v121, v31
  v_add_f32 v122, v122, v31
  v_add_f32 v123, v123, v31
  v_add_f32 v124, v124, v31
  v_add_f32 v125, v125, v31
  v_add_f32 v126, v126, v31
  v_add_f32 v127, v127, v31
  v_add_f32 v128, v128, v31
  v_add_f32 v129, v129, v31
  v_add_f32 v130, v130, v31
  v_add_f32 v131, v131, v31
  s_waitcnt lgkmcnt(0)
  s_add_u32 m0, s94, 0
  s_nop 0
  global_load_lds_dwordx4 v8, s[36:37] offset:0
  global_load_lds_dwordx4 v9, s[36:37] offset:1024
  global_load_lds_dwordx4 v10, s[36:37] offset:2048
  global_load_lds_dwordx4 v11, s[36:37] offset:3072
  s_add_u32 m0, s94, 4096
  s_add_u32 s36, s36, 131072
  s_addc_u32 s37, s37, 0
  global_load_lds_dwordx4 v8, s[36:37] offset:0
  global_load_lds_dwordx4 v9, s[36:37] offset:1024
  global_load_lds_dwordx4 v10, s[36:37] offset:2048
  global_load_lds_dwordx4 v11, s[36:37] offset:3072
  s_add_u32 m0, s94, 8192
  s_add_u32 s36, s36, 131072
  s_addc_u32 s37, s37, 0
  global_load_lds_dwordx4 v8, s[36:37] offset:0
  global_load_lds_dwordx4 v9, s[36:37] offset:1024
  global_load_lds_dwordx4 v10, s[36:37] offset:2048
  global_load_lds_dwordx4 v11, s[36:37] offset:3072
  s_add_u32 m0, s94, 12288
  s_add_u32 s36, s36, 131072
  s_addc_u32 s37, s37, 0
  global_load_lds_dwordx4 v8, s[36:37] offset:0
  global_load_lds_dwordx4 v9, s[36:37] offset:1024
  global_load_lds_dwordx4 v10, s[36:37] offset:2048
  global_load_lds_dwordx4 v11, s[36:37] offset:3072
  s_add_u32 m0, s94, 16384
  s_add_u32 s36, s36, 131072
  s_addc_u32 s37, s37, 0
  global_load_lds_dwordx4 v8, s[36:37] offset:0
  global_load_lds_dwordx4 v9, s[36:37] offset:1024
  global_load_lds_dwordx4 v10, s[36:37] offset:2048
  global_load_lds_dwordx4 v11, s[36:37] offset:3072
  s_add_u32 m0, s94, 20480
  s_add_u32 s36, s36, 131072
  s_addc_u32 s37, s37, 0
  global_load_lds_dwordx4 v8, s[36:37] offset:0
  global_load_lds_dwordx4 v9, s[36:37] offset:1024
  global_load_lds_dwordx4 v10, s[36:37] offset:2048
  global_load_lds_dwordx4 v11, s[36:37] offset:3072
  s_add_u32 m0, s94, 0
  s_add_u32 s36, s36, 131072
  s_addc_u32 s37, s37, 0
  s_waitcnt vmcnt(0)
  ds_read_b64_tr_b16 a[136:137], v12 offset:0
  ds_read_b64_tr_b16 a[138:139], v12 offset:1024
  ds_read_b64_tr_b16 a[140:141], v13 offset:0
  ds_read_b64_tr_b16 a[142:143], v13 offset:1024
  ds_read_b64_tr_b16 a[144:145], v14 offset:0
  ds_read_b64_tr_b16 a[146:147], v14 offset:1024
  ds_read_b64_tr_b16 a[148:149], v15 offset:0
  ds_read_b64_tr_b16 a[150:151], v15 offset:1024
  ds_read_b64_tr_b16 a[152:153], v12 offset:4096
  ds_read_b64_tr_b16 a[154:155], v12 offset:5120
  ds_read_b64_tr_b16 a[156:157], v13 offset:4096
  ds_read_b64_tr_b16 a[158:159], v13 offset:5120
  ds_read_b64_tr_b16 a[160:161], v14 offset:4096
  ds_read_b64_tr_b16 a[162:163], v14 offset:5120
  ds_read_b64_tr_b16 a[164:165], v15 offset:4096
  ds_read_b64_tr_b16 a[166:167], v15 offset:5120
  ds_read_b64_tr_b16 a[168:169], v12 offset:8192
  ds_read_b64_tr_b16 a[170:171], v12 offset:9216
  ds_read_b64_tr_b16 a[172:173], v13 offset:8192
  ds_read_b64_tr_b16 a[174:175], v13 offset:9216
  ds_read_b64_tr_b16 a[176:177], v14 offset:8192
  ds_read_b64_tr_b16 a[178:179], v14 offset:9216
  ds_read_b64_tr_b16 a[180:181], v15 offset:8192
  ds_read_b64_tr_b16 a[182:183], v15 offset:9216
  ds_read_b64_tr_b16 a[184:185], v12 offset:12288
  ds_read_b64_tr_b16 a[186:187], v12 offset:13312
  ds_read_b64_tr_b16 a[188:189], v13 offset:12288
  ds_read_b64_tr_b16 a[190:191], v13 offset:13312
  ds_read_b64_tr_b16 a[192:193], v14 offset:12288
  ds_read_b64_tr_b16 a[194:195], v14 offset:13312
  ds_read_b64_tr_b16 a[196:197], v15 offset:12288
  ds_read_b64_tr_b16 a[198:199], v15 offset:13312
  ds_read_b64_tr_b16 a[200:201], v12 offset:16384
  ds_read_b64_tr_b16 a[202:203], v12 offset:17408
  ds_read_b64_tr_b16 a[204:205], v13 offset:16384
  ds_read_b64_tr_b16 a[206:207], v13 offset:17408
  ds_read_b64_tr_b16 a[208:209], v14 offset:16384
  ds_read_b64_tr_b16 a[210:211], v14 offset:17408
  ds_read_b64_tr_b16 a[212:213], v15 offset:16384
  ds_read_b64_tr_b16 a[214:215], v15 offset:17408
  ds_read_b64_tr_b16 a[216:217], v12 offset:20480
  ds_read_b64_tr_b16 a[218:219], v12 offset:21504
  ds_read_b64_tr_b16 a[220:221], v13 offset:20480
  ds_read_b64_tr_b16 a[222:223], v13 offset:21504
  ds_read_b64_tr_b16 a[224:225], v14 offset:20480
  ds_read_b64_tr_b16 a[226:227], v14 offset:21504
  ds_read_b64_tr_b16 a[228:229], v15 offset:20480
  ds_read_b64_tr_b16 a[230:231], v15 offset:21504
  s_waitcnt lgkmcnt(0)
  global_load_lds_dwordx4 v8, s[36:37] offset:0
  global_load_lds_dwordx4 v9, s[36:37] offset:1024
  global_load_lds_dwordx4 v10, s[36:37] offset:2048
  global_load_lds_dwordx4 v11, s[36:37] offset:3072
  s_add_u32 m0, s94, 4096
  s_add_u32 s36, s36, 131072
  s_addc_u32 s37, s37, 0
  global_load_lds_dwordx4 v8, s[36:37] offset:0
  global_load_lds_dwordx4 v9, s[36:37] offset:1024
  global_load_lds_dwordx4 v10, s[36:37] offset:2048
  global_load_lds_dwordx4 v11, s[36:37] offset:3072
  s_add_u32 m0, s94, 8192
  s_add_u32 s36, s36, 131072
  s_addc_u32 s37, s37, 0
  global_load_lds_dwordx4 v8, s[36:37] offset:0
  global_load_lds_dwordx4 v9, s[36:37] offset:1024
  global_load_lds_dwordx4 v10, s[36:37] offset:2048
  global_load_lds_dwordx4 v11, s[36:37] offset:3072
  s_add_u32 m0, s94, 12288
  s_add_u32 s36, s36, 131072
  s_addc_u32 s37, s37, 0
  v_mov_b32 v60, 0
L_p3poll:
  global_load_dword v61, v60, s[40:41] sc1
  s_waitcnt vmcnt(0)
  v_cmp_eq_u32 vcc, -1, v61
  s_cbranch_vccz L_p3go
  s_sub_u32 s75, s75, 1
  s_cbranch_scc1 L_exit
  s_sleep 8
  s_branch L_p3poll
L_p3go:
  global_load_dwordx4 v[32:35], v1, s[38:39] offset:-4096 sc1
  global_load_dwordx4 v[36:39], v1, s[38:39] offset:-3072 sc1
  global_load_dwordx4 v[40:43], v1, s[38:39] offset:-2048 sc1
  global_load_dwordx4 v[44:47], v1, s[38:39] offset:-1024 sc1
  global_load_dwordx4 v[48:51], v1, s[38:39] offset:0 sc1
  global_load_dwordx4 v[52:55], v1, s[38:39] offset:1024 sc1
  global_load_dwordx4 v[56:59], v1, s[38:39] offset:2048 sc1
  global_load_dwordx4 v[60:63], v1, s[38:39] offset:3072 sc1
  global_load_dwordx4 v[64:67], v30, s[38:39] offset:-4096 sc1
  s_waitcnt vmcnt(0)
  s_branch L_p3join
L_rtyu0_62:
  s_sub_u32 s75, s75, 1
  s_cbranch_scc1 L_exit
  s_sleep 1
  global_load_dwordx4 v[32:35], v1, s[38:39] offset:-4096 sc1
  global_load_dwordx4 v[36:39], v1, s[38:39] offset:-3072 sc1
  global_load_dwordx4 v[40:43], v1, s[38:39] offset:-2048 sc1
  s_waitcnt vmcnt(0)
  v_max3_u32 v28, v32, v36, v40
  v_cmp_eq_u32 vcc, -1, v28
  s_cbranch_vccnz L_rtyu0_62
  s_branch L_oku0_61
L_rtyu1_64:
  s_sub_u32 s75, s75, 1
  s_cbranch_scc1 L_exit
  s_sleep 1
  global_load_dwordx4 v[44:47], v1, s[38:39] offset:-1024 sc1
  global_load_dwordx4 v[48:51], v1, s[38:39] offset:0 sc1
  global_load_dwordx4 v[52:55], v1, s[38:39] offset:1024 sc1
  s_waitcnt vmcnt(0)
  v_max3_u32 v28, v44, v48, v52
  v_cmp_eq_u32 vcc, -1, v28
  s_cbranch_vccnz L_rtyu1_64
  s_branch L_oku1_63
L_rtyu2_66:
  s_sub_u32 s75, s75, 1
  s_cbranch_scc1 L_exit
  s_sleep 1
  global_load_dwordx4 v[56:59], v1, s[38:39] offset:2048 sc1
  global_load_dwordx4 v[60:63], v1, s[38:39] offset:3072 sc1
  global_load_dwordx4 v[64:67], v30, s[38:39] offset:-4096 sc1
  s_waitcnt vmcnt(0)
  v_max3_u32 v28, v56, v60, v64
  v_cmp_eq_u32 vcc, -1, v28
  s_cbranch_vccnz L_rtyu2_66
  s_branch L_oku2_65
L_rtyu3_68:
  s_sub_u32 s75, s75, 1
  s_cbranch_scc1 L_exit
  s_sleep 1
  global_load_dwordx4 v[68:71], v1, s[40:41] offset:-4096 sc1
  global_load_dwordx4 v[72:75], v1, s[40:41] offset:-3072 sc1
  global_load_dwordx4 v[76:79], v1, s[40:41] offset:-2048 sc1
  s_waitcnt vmcnt(0)
  v_max3_u32 v28, v68, v72, v76
  v_cmp_eq_u32 vcc, -1, v28
  s_cbranch_vccnz L_rtyu3_68
  s_branch L_oku3_67
L_rtyu4_70:
  s_sub_u32 s75, s75, 1
  s_cbranch_scc1 L_exit
  s_sleep 1
  global_load_dwordx4 v[80:83], v1, s[40:41] offset:-1024 sc1
  global_load_dwordx4 v[84:87], v1, s[40:41] offset:0 sc1
  global_load_dwordx4 v[88:91], v1, s[40:41] offset:1024 sc1
  s_waitcnt vmcnt(0)
  v_max3_u32 v28, v80, v84, v88
  v_cmp_eq_u32 vcc, -1, v28
  s_cbranch_vccnz L_rtyu4_70
  s_branch L_oku4_69
L_rtyu5_72:
  s_sub_u32 s75, s75, 1
  s_cbranch_scc1 L_exit
  s_sleep 1
  global_load_dwordx4 v[92:95], v1, s[40:41] offset:2048 sc1
  global_load_dwordx4 v[96:99], v1, s[40:41] offset:3072 sc1
  global_load_dwordx4 v[100:103], v30, s[40:41] offset:-4096 sc1
  s_waitcnt vmcnt(0)
  v_max3_u32 v28, v92, v96, v100
  v_cmp_eq_u32 vcc, -1, v28
  s_cbranch_vccnz L_rtyu5_72
  s_branch L_oku5_71
L_rtyu6_74:
  s_sub_u32 s75, s75, 1
  s_cbranch_scc1 L_exit
  s_sleep 1
  global_load_dwordx4 v[32:35], v30, s[38:39] offset:-3072 sc1
  global_load_dwordx4 v[36:39], v30, s[38:39] offset:-2048 sc1
  global_load_dwordx4 v[40:43], v30, s[38:39] offset:-1024 sc1
  s_waitcnt vmcnt(0)
  v_max3_u32 v28, v32, v36, v40
  v_cmp_eq_u32 vcc, -1, v28
  s_cbranch_vccnz L_rtyu6_74
  s_branch L_oku6_73
L_rtyu7_76:
  s_sub_u32 s75, s75, 1
  s_cbranch_scc1 L_exit
  s_sleep 1
  global_load_dwordx4 v[44:47], v30, s[40:41] offset:-3072 sc1
  global_load_dwordx4 v[48:51], v30, s[40:41] offset:-2048 sc1
  global_load_dwordx4 v[52:55], v30, s[40:41] offset:-1024 sc1
  s_waitcnt vmcnt(0)
  v_max3_u32 v28, v44, v48, v52
  v_cmp_eq_u32 vcc, -1, v28
  s_cbranch_vccnz L_rtyu7_76
  s_branch L_oku7_75
L_rtyu8_78:
  s_sub_u32 s75, s75, 1
  s_cbranch_scc1 L_exit
  s_sleep 1
  global_load_dwordx4 v[56:59], v1, s[42:43] offset:-4096 sc1
  global_load_dwordx4 v[60:63], v1, s[42:43] offset:-3072 sc1
  global_load_dwordx4 v[64:67], v1, s[42:43] offset:-2048 sc1
  s_waitcnt vmcnt(0)
  v_max3_u32 v28, v56, v60, v64
  v_cmp_eq_u32 vcc, -1, v28
  s_cbranch_vccnz L_rtyu8_78
  s_branch L_oku8_77
L_rtyu9_80:
  s_sub_u32 s75, s75, 1
  s_cbranch_scc1 L_exit
  s_sleep 1
  global_load_dwordx4 v[68:71], v1, s[42:43] offset:-1024 sc1
  global_load_dwordx4 v[72:75], v1, s[42:43] offset:0 sc1
  global_load_dwordx4 v[76:79], v1, s[42:43] offset:1024 sc1
  s_waitcnt vmcnt(0)
  v_max3_u32 v28, v68, v72, v76
  v_cmp_eq_u32 vcc, -1, v28
  s_cbranch_vccnz L_rtyu9_80
  s_branch L_oku9_79
L_rtyu10_82:
  s_sub_u32 s75, s75, 1
  s_cbranch_scc1 L_exit
  s_sleep 1
  global_load_dwordx4 v[80:83], v1, s[42:43] offset:2048 sc1
  global_load_dwordx4 v[84:87], v1, s[42:43] offset:3072 sc1
  global_load_dwordx4 v[88:91], v30, s[42:43] offset:-4096 sc1
  s_waitcnt vmcnt(0)
  v_max3_u32 v28, v80, v84, v88
  v_cmp_eq_u32 vcc, -1, v28
  s_cbranch_vccnz L_rtyu10_82
  s_branch L_oku10_81
L_rtyu11_84:
  s_sub_u32 s75, s75, 1
  s_cbranch_scc1 L_exit
  s_sleep 1
  global_load_dwordx4 v[92:95], v30, s[42:43] offset:-3072 sc1
  global_load_dwordx4 v[96:99], v30, s[42:43] offset:-2048 sc1
  global_load_dwordx4 v[100:103], v30, s[42:43] offset:-1024 sc1
  s_waitcnt vmcnt(0)
  v_max3_u32 v28, v92, v96, v100
  v_cmp_eq_u32 vcc, -1, v28
  s_cbranch_vccnz L_rtyu11_84
  s_branch L_oku11_83
L_rtyu12_86:
  s_sub_u32 s75, s75, 1
  s_cbranch_scc1 L_exit
  s_sleep 1
  global_load_dwordx4 v[32:35], v1, s[44:45] offset:-4096 sc1
  global_load_dwordx4 v[36:39], v1, s[44:45] offset:-3072 sc1
  global_load_dwordx4 v[40:43], v1, s[44:45] offset:-2048 sc1
  s_waitcnt vmcnt(0)
  v_max3_u32 v28, v32, v36, v40
  v_cmp_eq_u32 vcc, -1, v28
  s_cbranch_vccnz L_rtyu12_86
  s_branch L_oku12_85
L_rtyu13_88:
  s_sub_u32 s75, s75, 1
  s_cbranch_scc1 L_exit
  s_sleep 1
  global_load_dwordx4 v[44:47], v1, s[44:45] offset:-1024 sc1
  global_load_dwordx4 v[48:51], v1, s[44:45] offset:0 sc1
  global_load_dwordx4 v[52:55], v1, s[44:45] offset:1024 sc1
  s_waitcnt vmcnt(0)
  v_max3_u32 v28, v44, v48, v52
  v_cmp_eq_u32 vcc, -1, v28
  s_cbranch_vccnz L_rtyu13_88
  s_branch L_oku13_87
L_rtyu14_90:
  s_sub_u32 s75, s75, 1
  s_cbranch_scc1 L_exit
  s_sleep 1
  global_load_dwordx4 v[56:59], v1, s[44:45] offset:2048 sc1
  global_load_dwordx4 v[60:63], v1, s[44:45] offset:3072 sc1
  global_load_dwordx4 v[64:67], v30, s[44:45] offset:-4096 sc1
  s_waitcnt vmcnt(0)
  v_max3_u32 v28, v56, v60, v64
  v_cmp_eq_u32 vcc, -1, v28
  s_cbranch_vccnz L_rtyu14_90
  s_branch L_oku14_89
L_rtyu15_92:
  s_sub_u32 s75, s75, 1
  s_cbranch_scc1 L_exit
  s_sleep 1
  global_load_dwordx4 v[68:71], v30, s[44:45] offset:-3072 sc1
  global_load_dwordx4 v[72:75], v30, s[44:45] offset:-2048 sc1
  global_load_dwordx4 v[76:79], v30, s[44:45] offset:-1024 sc1
  s_waitcnt vmcnt(0)
  v_max3_u32 v28, v68, v72, v76
  v_cmp_eq_u32 vcc, -1, v28
  s_cbranch_vccnz L_rtyu15_92
  s_branch L_oku15_91
L_rtyu16_94:
  s_sub_u32 s75, s75, 1
  s_cbranch_scc1 L_exit
  s_sleep 1
  global_load_dwordx4 v[80:83], v1, s[46:47] offset:-4096 sc1
  global_load_dwordx4 v[84:87], v1, s[46:47] offset:-3072 sc1
  global_load_dwordx4 v[88:91], v1, s[46:47] offset:-2048 sc1
  s_waitcnt vmcnt(0)
  v_max3_u32 v28, v80, v84, v88
  v_cmp_eq_u32 vcc, -1, v28
  s_cbranch_vccnz L_rtyu16_94
  s_branch L_oku16_93
L_rtyu17_96:
  s_sub_u32 s75, s75, 1
  s_cbranch_scc1 L_exit
  s_sleep 1
  global_load_dwordx4 v[92:95], v1, s[46:47] offset:-1024 sc1
  global_load_dwordx4 v[96:99], v1, s[46:47] offset:0 sc1
  global_load_dwordx4 v[100:103], v1, s[46:47] offset:1024 sc1
  s_waitcnt vmcnt(0)
  v_max3_u32 v28, v92, v96, v100
  v_cmp_eq_u32 vcc, -1, v28
  s_cbranch_vccnz L_rtyu17_96
  s_branch L_oku17_95
L_rtyu18_98:
  s_sub_u32 s75, s75, 1
  s_cbranch_scc1 L_exit
  s_sleep 1
  global_load_dwordx4 v[32:35], v1, s[46:47] offset:2048 sc1
  global_load_dwordx4 v[36:39], v1, s[46:47] offset:3072 sc1
  global_load_dwordx4 v[40:43], v30, s[46:47] offset:-4096 sc1
  s_waitcnt vmcnt(0)
  v_max3_u32 v28, v32, v36, v40
  v_cmp_eq_u32 vcc, -1, v28
  s_cbranch_vccnz L_rtyu18_98
  s_branch L_oku18_97
L_rtyu19_100:
  s_sub_u32 s75, s75, 1
  s_cbranch_scc1 L_exit
  s_sleep 1
  global_load_dwordx4 v[44:47], v30, s[46:47] offset:-3072 sc1
  global_load_dwordx4 v[48:51], v30, s[46:47] offset:-2048 sc1
  global_load_dwordx4 v[52:55], v30, s[46:47] offset:-1024 sc1
  s_waitcnt vmcnt(0)
  v_max3_u32 v28, v44, v48, v52
  v_cmp_eq_u32 vcc, -1, v28
  s_cbranch_vccnz L_rtyu19_100
  s_branch L_oku19_99
L_fallback:
  s_waitcnt vmcnt(0) lgkmcnt(0)
  s_mov_b32 s31, 1
  v_mov_b32 v124, 0xff800000
  v_mov_b32 v125, 0xff800000
  v_mov_b32 v126, 0xff800000
  v_mov_b32 v127, 0xff800000
  v_mov_b32 v128, 0xff800000
  v_mov_b32 v129, 0xff800000
  v_mov_b32 v130, 0xff800000
  v_mov_b32 v131, 0xff800000
  s_mov_b32 s74, 0
L_fb0:
  s_add_u32 s77, s92, s74
  s_and_b32 s77, s77, 31
  s_mul_i32 s77, s77, 6144
  s_add_u32 s14, s28, s77
  s_addc_u32 s15, s29, 0
  s_nop 15
  global_load_dwordx2 v[104:105], v4, s[14:15] offset:2048 sc1
  global_load_dwordx4 v[96:99], v1, s[14:15] offset:0 sc1
  global_load_dwordx4 v[100:103], v1, s[14:15] offset:1024 sc1
  global_load_dwordx4 v[106:109], v6, s[14:15] offset:0 sc1
  global_load_dwordx4 v[110:113], v6, s[14:15] offset:768 sc1
  global_load_dwordx4 v[114:117], v6, s[14:15] offset:1536 sc1
  global_load_dwordx4 v[118:121], v6, s[14:15] offset:2304 sc1
  s_waitcnt vmcnt(0)
  v_mfma_f32_32x32x4_2b_bf16 v[32:63], v[104:105], a[114:115], 0 cbsz:1 abid:0
  s_nop 15
  s_nop 1
  v_mfma_f32_32x32x16_bf16 v[32:47], v[96:99], a[106:109], v[32:47]
  v_mfma_f32_32x32x16_bf16 v[48:63], v[96:99], a[110:113], v[48:63]
  s_nop 10
  v_max3_f32 v126, v126, v32, v33
  v_max3_f32 v126, v126, v34, v35
  v_max3_f32 v126, v126, v36, v37
  v_max3_f32 v126, v126, v38, v39
  v_max3_f32 v126, v126, v40, v41
  v_max3_f32 v126, v126, v42, v43
  v_max3_f32 v126, v126, v44, v45
  v_max3_f32 v126, v126, v46, v47
  v_max3_f32 v127, v127, v48, v49
  v_max3_f32 v127, v127, v50, v51
  v_max3_f32 v127, v127, v52, v53
  v_max3_f32 v127, v127, v54, v55
  v_max3_f32 v127, v127, v56, v57
  v_max3_f32 v127, v127, v58, v59
  v_max3_f32 v127, v127, v60, v61
  v_max3_f32 v127, v127, v62, v63
  v_mfma_f32_32x32x4_2b_bf16 v[32:63], v[104:105], a[114:115], 0 cbsz:1 abid:1
  s_nop 15
  s_nop 1
  v_mfma_f32_32x32x16_bf16 v[32:47], v[100:103], a[106:109], v[32:47]
  v_mfma_f32_32x32x16_bf16 v[48:63], v[100:103], a[110:113], v[48:63]
  s_nop 10
  v_max3_f32 v126, v126, v32, v33
  v_max3_f32 v126, v126, v34, v35
  v_max3_f32 v126, v126, v36, v37
  v_max3_f32 v126, v126, v38, v39
  v_max3_f32 v126, v126, v40, v41
  v_max3_f32 v126, v126, v42, v43
  v_max3_f32 v126, v126, v44, v45
  v_max3_f32 v126, v126, v46, v47
  v_max3_f32 v127, v127, v48, v49
  v_max3_f32 v127, v127, v50, v51
  v_max3_f32 v127, v127, v52, v53
  v_max3_f32 v127, v127, v54, v55
  v_max3_f32 v127, v127, v56, v57
  v_max3_f32 v127, v127, v58, v59
  v_max3_f32 v127, v127, v60, v61
  v_max3_f32 v127, v127, v62, v63
  v_mfma_f32_32x32x4_2b_bf16 v[32:63], v[104:105], a[124:125], 0 cbsz:1 abid:0
  s_nop 15
  s_nop 1
  v_mfma_f32_32x32x16_bf16 v[32:47], v[96:99], a[116:119], v[32:47]
  v_mfma_f32_32x32x16_bf16 v[48:63], v[96:99], a[120:123], v[48:63]
  s_nop 10
  v_max3_f32 v128, v128, v32, v33
  v_max3_f32 v128, v128, v34, v35
  v_max3_f32 v128, v128, v36, v37
  v_max3_f32 v128, v128, v38, v39
  v_max3_f32 v128, v128, v40, v41
  v_max3_f32 v128, v128, v42, v43
  v_max3_f32 v128, v128, v44, v45
  v_max3_f32 v128, v128, v46, v47
  v_max3_f32 v129, v129, v48, v49
  v_max3_f32 v129, v129, v50, v51
  v_max3_f32 v129, v129, v52, v53
  v_max3_f32 v129, v129, v54, v55
  v_max3_f32 v129, v129, v56, v57
  v_max3_f32 v129, v129, v58, v59
  v_max3_f32 v129, v129, v60, v61
  v_max3_f32 v129, v129, v62, v63
  v_mfma_f32_32x32x4_2b_bf16 v[32:63], v[104:105], a[124:125], 0 cbsz:1 abid:1
  s_nop 15
  s_nop 1
  v_mfma_f32_32x32x16_bf16 v[32:47], v[100:103], a[116:119], v[32:47]
  v_mfma_f32_32x32x16_bf16 v[48:63], v[100:103], a[120:123], v[48:63]
  s_nop 10
  v_max3_f32 v128, v128, v32, v33
  v_max3_f32 v128, v128, v34, v35
  v_max3_f32 v128, v128, v36, v37
  v_max3_f32 v128, v128, v38, v39
  v_max3_f32 v128, v128, v40, v41
  v_max3_f32 v128, v128, v42, v43
  v_max3_f32 v128, v128, v44, v45
  v_max3_f32 v128, v128, v46, v47
  v_max3_f32 v129, v129, v48, v49
  v_max3_f32 v129, v129, v50, v51
  v_max3_f32 v129, v129, v52, v53
  v_max3_f32 v129, v129, v54, v55
  v_max3_f32 v129, v129, v56, v57
  v_max3_f32 v129, v129, v58, v59
  v_max3_f32 v129, v129, v60, v61
  v_max3_f32 v129, v129, v62, v63
  v_mfma_f32_32x32x4_2b_bf16 v[32:63], v[104:105], a[134:135], 0 cbsz:1 abid:0
  s_nop 15
  s_nop 1
  v_mfma_f32_32x32x16_bf16 v[32:47], v[96:99], a[126:129], v[32:47]
  v_mfma_f32_32x32x16_bf16 v[48:63], v[96:99], a[130:133], v[48:63]
  s_nop 10
  v_max3_f32 v130, v130, v32, v33
  v_max3_f32 v130, v130, v34, v35
  v_max3_f32 v130, v130, v36, v37
  v_max3_f32 v130, v130, v38, v39
  v_max3_f32 v130, v130, v40, v41
  v_max3_f32 v130, v130, v42, v43
  v_max3_f32 v130, v130, v44, v45
  v_max3_f32 v130, v130, v46, v47
  v_max3_f32 v131, v131, v48, v49
  v_max3_f32 v131, v131, v50, v51
  v_max3_f32 v131, v131, v52, v53
  v_max3_f32 v131, v131, v54, v55
  v_max3_f32 v131, v131, v56, v57
  v_max3_f32 v131, v131, v58, v59
  v_max3_f32 v131, v131, v60, v61
  v_max3_f32 v131, v131, v62, v63
  v_mfma_f32_32x32x4_2b_bf16 v[32:63], v[104:105], a[134:135], 0 cbsz:1 abid:1
  s_nop 15
  s_nop 1
  v_mfma_f32_32x32x16_bf16 v[32:47], v[100:103], a[126:129], v[32:47]
  v_mfma_f32_32x32x16_bf16 v[48:63], v[100:103], a[130:133], v[48:63]
  s_nop 10
  v_max3_f32 v130, v130, v32, v33
  v_max3_f32 v130, v130, v34, v35
  v_max3_f32 v130, v130, v36, v37
  v_max3_f32 v130, v130, v38, v39
  v_max3_f32 v130, v130, v40, v41
  v_max3_f32 v130, v130, v42, v43
  v_max3_f32 v130, v130, v44, v45
  v_max3_f32 v130, v130, v46, v47
  v_max3_f32 v131, v131, v48, v49
  v_max3_f32 v131, v131, v50, v51
  v_max3_f32 v131, v131, v52, v53
  v_max3_f32 v131, v131, v54, v55
  v_max3_f32 v131, v131, v56, v57
  v_max3_f32 v131, v131, v58, v59
  v_max3_f32 v131, v131, v60, v61
  v_max3_f32 v131, v131, v62, v63
  v_mfma_f32_32x32x4_2b_bf16 v[32:63], v[104:105], a[104:105], 0 cbsz:1 abid:0
  s_nop 15
  s_nop 1
  v_mfma_f32_32x32x16_bf16 v[32:47], v[96:99], a[96:99], v[32:47]
  v_mfma_f32_32x32x16_bf16 v[48:63], v[96:99], a[100:103], v[48:63]
  s_nop 10
  v_max3_f32 v124, v124, v32, v33
  v_max3_f32 v124, v124, v34, v35
  v_max3_f32 v124, v124, v36, v37
  v_max3_f32 v124, v124, v38, v39
  v_max3_f32 v124, v124, v40, v41
  v_max3_f32 v124, v124, v42, v43
  v_max3_f32 v124, v124, v44, v45
  v_max3_f32 v124, v124, v46, v47
  v_max3_f32 v125, v125, v48, v49
  v_max3_f32 v125, v125, v50, v51
  v_max3_f32 v125, v125, v52, v53
  v_max3_f32 v125, v125, v54, v55
  v_max3_f32 v125, v125, v56, v57
  v_max3_f32 v125, v125, v58, v59
  v_max3_f32 v125, v125, v60, v61
  v_max3_f32 v125, v125, v62, v63
  v_mfma_f32_32x32x4_2b_bf16 v[32:63], v[104:105], a[104:105], 0 cbsz:1 abid:1
  s_nop 15
  s_nop 1
  v_mfma_f32_32x32x16_bf16 v[32:47], v[100:103], a[96:99], v[32:47]
  v_mfma_f32_32x32x16_bf16 v[48:63], v[100:103], a[100:103], v[48:63]
  s_nop 10
  v_max3_f32 v124, v124, v32, v33
  v_max3_f32 v124, v124, v34, v35
  v_max3_f32 v124, v124, v36, v37
  v_max3_f32 v124, v124, v38, v39
  v_max3_f32 v124, v124, v40, v41
  v_max3_f32 v124, v124, v42, v43
  v_max3_f32 v124, v124, v44, v45
  v_max3_f32 v124, v124, v46, v47
  v_max3_f32 v125, v125, v48, v49
  v_max3_f32 v125, v125, v50, v51
  v_max3_f32 v125, v125, v52, v53
  v_max3_f32 v125, v125, v54, v55
  v_max3_f32 v125, v125, v56, v57
  v_max3_f32 v125, v125, v58, v59
  v_max3_f32 v125, v125, v60, v61
  v_max3_f32 v125, v125, v62, v63
  s_add_u32 s74, s74, 4
  s_cmp_lt_u32 s74, 32
  s_cbranch_scc1 L_fb0
  v_mov_b32 v64, v124
  s_nop 1
  v_permlane32_swap_b32 v124, v64
  v_max_f32 v124, v124, v64
  v_mov_b32 v64, v125
  s_nop 1
  v_permlane32_swap_b32 v125, v64
  v_max_f32 v125, v125, v64
  v_mov_b32 v64, v126
  s_nop 1
  v_permlane32_swap_b32 v126, v64
  v_max_f32 v126, v126, v64
  v_mov_b32 v64, v127
  s_nop 1
  v_permlane32_swap_b32 v127, v64
  v_max_f32 v127, v127, v64
  v_mov_b32 v64, v128
  s_nop 1
  v_permlane32_swap_b32 v128, v64
  v_max_f32 v128, v128, v64
  v_mov_b32 v64, v129
  s_nop 1
  v_permlane32_swap_b32 v129, v64
  v_max_f32 v129, v129, v64
  v_mov_b32 v64, v130
  s_nop 1
  v_permlane32_swap_b32 v130, v64
  v_max_f32 v130, v130, v64
  v_mov_b32 v64, v131
  s_nop 1
  v_permlane32_swap_b32 v131, v64
  v_max_f32 v131, v131, v64
  v_and_b32 v64, 31, v0
  v_lshlrev_b32 v64, 2, v64
  s_lshl_b32 s72, s64, 10
  s_xor_b32 s71, s64, 0
  s_lshl_b32 s71, s71, 8
  s_add_u32 s71, s71, 25600
  v_add_u32 v66, s71, v64
  v_add_u32 v65, s72, v66
  ds_write_b32 v65, v124
  ds_write_b32 v65, v125 offset:128
  s_xor_b32 s71, s64, 1
  s_lshl_b32 s71, s71, 8
  s_add_u32 s71, s71, 25600
  v_add_u32 v67, s71, v64
  v_add_u32 v65, s72, v67
  ds_write_b32 v65, v126
  ds_write_b32 v65, v127 offset:128
  s_xor_b32 s71, s64, 2
  s_lshl_b32 s71, s71, 8
  s_add_u32 s71, s71, 25600
  v_add_u32 v68, s71, v64
  v_add_u32 v65, s72, v68
  ds_write_b32 v65, v128
  ds_write_b32 v65, v129 offset:128
  s_xor_b32 s71, s64, 3
  s_lshl_b32 s71, s71, 8
  s_add_u32 s71, s71, 25600
  v_add_u32 v69, s71, v64
  v_add_u32 v65, s72, v69
  ds_write_b32 v65, v130
  ds_write_b32 v65, v131 offset:128
  s_waitcnt lgkmcnt(0)
  s_barrier
  ds_read_b32 v72, v66 offset:0
  ds_read_b32 v73, v66 offset:1024
  ds_read_b32 v74, v66 offset:2048
  ds_read_b32 v75, v66 offset:3072
  s_waitcnt lgkmcnt(0)
  v_max3_f32 v72, v72, v73, v74
  v_max_f32 v124, v72, v75
  ds_read_b32 v72, v66 offset:128
  ds_read_b32 v73, v66 offset:1152
  ds_read_b32 v74, v66 offset:2176
  ds_read_b32 v75, v66 offset:3200
  s_waitcnt lgkmcnt(0)
  v_max3_f32 v72, v72, v73, v74
  v_max_f32 v125, v72, v75
  ds_read_b32 v72, v67 offset:0
  ds_read_b32 v73, v67 offset:1024
  ds_read_b32 v74, v67 offset:2048
  ds_read_b32 v75, v67 offset:3072
  s_waitcnt lgkmcnt(0)
  v_max3_f32 v72, v72, v73, v74
  v_max_f32 v126, v72, v75
  ds_read_b32 v72, v67 offset:128
  ds_read_b32 v73, v67 offset:1152
  ds_read_b32 v74, v67 offset:2176
  ds_read_b32 v75, v67 offset:3200
  s_waitcnt lgkmcnt(0)
  v_max3_f32 v72, v72, v73, v74
  v_max_f32 v127, v72, v75
  ds_read_b32 v72, v68 offset:0
  ds_read_b32 v73, v68 offset:1024
  ds_read_b32 v74, v68 offset:2048
  ds_read_b32 v75, v68 offset:3072
  s_waitcnt lgkmcnt(0)
  v_max3_f32 v72, v72, v73, v74
  v_max_f32 v128, v72, v75
  ds_read_b32 v72, v68 offset:128
  ds_read_b32 v73, v68 offset:1152
  ds_read_b32 v74, v68 offset:2176
  ds_read_b32 v75, v68 offset:3200
  s_waitcnt lgkmcnt(0)
  v_max3_f32 v72, v72, v73, v74
  v_max_f32 v129, v72, v75
  ds_read_b32 v72, v69 offset:0
  ds_read_b32 v73, v69 offset:1024
  ds_read_b32 v74, v69 offset:2048
  ds_read_b32 v75, v69 offset:3072
  s_waitcnt lgkmcnt(0)
  v_max3_f32 v72, v72, v73, v74
  v_max_f32 v130, v72, v75
  ds_read_b32 v72, v69 offset:128
  ds_read_b32 v73, v69 offset:1152
  ds_read_b32 v74, v69 offset:2176
  ds_read_b32 v75, v69 offset:3200
  s_waitcnt lgkmcnt(0)
  v_max3_f32 v72, v72, v73, v74
  v_max_f32 v131, v72, v75
  s_barrier
  v_accvgpr_write_b32 a0, 0
  v_accvgpr_write_b32 a1, 0
  v_accvgpr_write_b32 a2, 0
  v_accvgpr_write_b32 a3, 0
  v_accvgpr_write_b32 a4, 0
  v_accvgpr_write_b32 a5, 0
  v_accvgpr_write_b32 a6, 0
  v_accvgpr_write_b32 a7, 0
  v_accvgpr_write_b32 a8, 0
  v_accvgpr_write_b32 a9, 0
  v_accvgpr_write_b32 a10, 0
  v_accvgpr_write_b32 a11, 0
  v_accvgpr_write_b32 a12, 0
  v_accvgpr_write_b32 a13, 0
  v_accvgpr_write_b32 a14, 0
  v_accvgpr_write_b32 a15, 0
  v_accvgpr_write_b32 a16, 0
  v_accvgpr_write_b32 a17, 0
  v_accvgpr_write_b32 a18, 0
  v_accvgpr_write_b32 a19, 0
  v_accvgpr_write_b32 a20, 0
  v_accvgpr_write_b32 a21, 0
  v_accvgpr_write_b32 a22, 0
  v_accvgpr_write_b32 a23, 0
  v_accvgpr_write_b32 a24, 0
  v_accvgpr_write_b32 a25, 0
  v_accvgpr_write_b32 a26, 0
  v_accvgpr_write_b32 a27, 0
  v_accvgpr_write_b32 a28, 0
  v_accvgpr_write_b32 a29, 0
  v_accvgpr_write_b32 a30, 0
  v_accvgpr_write_b32 a31, 0
  v_accvgpr_write_b32 a32, 0
  v_accvgpr_write_b32 a33, 0
  v_accvgpr_write_b32 a34, 0
  v_accvgpr_write_b32 a35, 0
  v_accvgpr_write_b32 a36, 0
  v_accvgpr_write_b32 a37, 0
  v_accvgpr_write_b32 a38, 0
  v_accvgpr_write_b32 a39, 0
  v_accvgpr_write_b32 a40, 0
  v_accvgpr_write_b32 a41, 0
  v_accvgpr_write_b32 a42, 0
  v_accvgpr_write_b32 a43, 0
  v_accvgpr_write_b32 a44, 0
  v_accvgpr_write_b32 a45, 0
  v_accvgpr_write_b32 a46, 0
  v_accvgpr_write_b32 a47, 0
  v_accvgpr_write_b32 a48, 0
  v_accvgpr_write_b32 a49, 0
  v_accvgpr_write_b32 a50, 0
  v_accvgpr_write_b32 a51, 0
  v_accvgpr_write_b32 a52, 0
  v_accvgpr_write_b32 a53, 0
  v_accvgpr_write_b32 a54, 0
  v_accvgpr_write_b32 a55, 0
  v_accvgpr_write_b32 a56, 0
  v_accvgpr_write_b32 a57, 0
  v_accvgpr_write_b32 a58, 0
  v_accvgpr_write_b32 a59, 0
  v_accvgpr_write_b32 a60, 0
  v_accvgpr_write_b32 a61, 0
  v_accvgpr_write_b32 a62, 0
  v_accvgpr_write_b32 a63, 0
  v_accvgpr_write_b32 a64, 0
  v_accvgpr_write_b32 a65, 0
  v_accvgpr_write_b32 a66, 0
  v_accvgpr_write_b32 a67, 0
  v_accvgpr_write_b32 a68, 0
  v_accvgpr_write_b32 a69, 0
  v_accvgpr_write_b32 a70, 0
  v_accvgpr_write_b32 a71, 0
  v_accvgpr_write_b32 a72, 0
  v_accvgpr_write_b32 a73, 0
  v_accvgpr_write_b32 a74, 0
  v_accvgpr_write_b32 a75, 0
  v_accvgpr_write_b32 a76, 0
  v_accvgpr_write_b32 a77, 0
  v_accvgpr_write_b32 a78, 0
  v_accvgpr_write_b32 a79, 0
  v_accvgpr_write_b32 a80, 0
  v_accvgpr_write_b32 a81, 0
  v_accvgpr_write_b32 a82, 0
  v_accvgpr_write_b32 a83, 0
  v_accvgpr_write_b32 a84, 0
  v_accvgpr_write_b32 a85, 0
  v_accvgpr_write_b32 a86, 0
  v_accvgpr_write_b32 a87, 0
  v_accvgpr_write_b32 a88, 0
  v_accvgpr_write_b32 a89, 0
  v_accvgpr_write_b32 a90, 0
  v_accvgpr_write_b32 a91, 0
  v_accvgpr_write_b32 a92, 0
  v_accvgpr_write_b32 a93, 0
  v_accvgpr_write_b32 a94, 0
  v_accvgpr_write_b32 a95, 0
  v_mov_b32 v148, 0
  v_mov_b32 v149, 0
  v_mov_b32 v150, 0
  v_mov_b32 v151, 0
  v_mov_b32 v152, 0
  v_mov_b32 v153, 0
  v_mov_b32 v154, 0
  v_mov_b32 v155, 0
  v_mov_b32 v156, 0
  v_mov_b32 v157, 0
  v_mov_b32 v158, 0
  v_mov_b32 v159, 0
  v_mov_b32 v160, 0
  v_mov_b32 v161, 0
  v_mov_b32 v162, 0
  v_mov_b32 v163, 0
  v_mov_b32 v164, 0
  v_mov_b32 v165, 0
  v_mov_b32 v166, 0
  v_mov_b32 v167, 0
  v_mov_b32 v168, 0
  v_mov_b32 v169, 0
  v_mov_b32 v170, 0
  v_mov_b32 v171, 0
  v_mov_b32 v172, 0
  v_mov_b32 v173, 0
  v_mov_b32 v174, 0
  v_mov_b32 v175, 0
  v_mov_b32 v176, 0
  v_mov_b32 v177, 0
  v_mov_b32 v178, 0
  v_mov_b32 v179, 0
  s_mov_b32 s74, 0
L_fb1:
  s_add_u32 s77, s92, s74
  s_and_b32 s77, s77, 31
  s_mul_i32 s77, s77, 6144
  s_add_u32 s14, s28, s77
  s_addc_u32 s15, s29, 0
  s_nop 15
  global_load_dwordx2 v[104:105], v4, s[14:15] offset:2048 sc1
  global_load_dwordx4 v[96:99], v1, s[14:15] offset:0 sc1
  global_load_dwordx4 v[100:103], v1, s[14:15] offset:1024 sc1
  global_load_dwordx4 v[106:109], v6, s[14:15] offset:0 sc1
  global_load_dwordx4 v[110:113], v6, s[14:15] offset:768 sc1
  global_load_dwordx4 v[114:117], v6, s[14:15] offset:1536 sc1
  global_load_dwordx4 v[118:121], v6, s[14:15] offset:2304 sc1
  s_waitcnt vmcnt(0)
  v_mfma_f32_32x32x4_2b_bf16 v[32:63], v[104:105], a[114:115], 0 cbsz:1 abid:0
  s_nop 15
  s_nop 1
  v_mfma_f32_32x32x16_bf16 v[32:47], v[96:99], a[106:109], v[32:47]
  v_mfma_f32_32x32x16_bf16 v[48:63], v[96:99], a[110:113], v[48:63]
  s_nop 10
  v_sub_f32 v32, v32, v126
  v_sub_f32 v33, v33, v126
  v_sub_f32 v34, v34, v126
  v_sub_f32 v35, v35, v126
  v_sub_f32 v36, v36, v126
  v_sub_f32 v37, v37, v126
  v_sub_f32 v38, v38, v126
  v_sub_f32 v39, v39, v126
  v_sub_f32 v40, v40, v126
  v_sub_f32 v41, v41, v126
  v_sub_f32 v42, v42, v126
  v_sub_f32 v43, v43, v126
  v_sub_f32 v44, v44, v126
  v_sub_f32 v45, v45, v126
  v_sub_f32 v46, v46, v126
  v_sub_f32 v47, v47, v126
  v_sub_f32 v48, v48, v127
  v_sub_f32 v49, v49, v127
  v_sub_f32 v50, v50, v127
  v_sub_f32 v51, v51, v127
  v_sub_f32 v52, v52, v127
  v_sub_f32 v53, v53, v127
  v_sub_f32 v54, v54, v127
  v_sub_f32 v55, v55, v127
  v_sub_f32 v56, v56, v127
  v_sub_f32 v57, v57, v127
  v_sub_f32 v58, v58, v127
  v_sub_f32 v59, v59, v127
  v_sub_f32 v60, v60, v127
  v_sub_f32 v61, v61, v127
  v_sub_f32 v62, v62, v127
  v_sub_f32 v63, v63, v127
  v_exp_f32 v32, v32
  v_exp_f32 v33, v33
  v_exp_f32 v34, v34
  v_exp_f32 v35, v35
  v_exp_f32 v36, v36
  v_exp_f32 v37, v37
  v_exp_f32 v38, v38
  v_exp_f32 v39, v39
  v_exp_f32 v40, v40
  v_exp_f32 v41, v41
  v_exp_f32 v42, v42
  v_exp_f32 v43, v43
  v_exp_f32 v44, v44
  v_exp_f32 v45, v45
  v_exp_f32 v46, v46
  v_exp_f32 v47, v47
  v_exp_f32 v48, v48
  v_exp_f32 v49, v49
  v_exp_f32 v50, v50
  v_exp_f32 v51, v51
  v_exp_f32 v52, v52
  v_exp_f32 v53, v53
  v_exp_f32 v54, v54
  v_exp_f32 v55, v55
  v_exp_f32 v56, v56
  v_exp_f32 v57, v57
  v_exp_f32 v58, v58
  v_exp_f32 v59, v59
  v_exp_f32 v60, v60
  v_exp_f32 v61, v61
  v_exp_f32 v62, v62
  v_exp_f32 v63, v63
  v_smfmac_f32_32x32x32_bf16 a[0:15], v[106:109], v[32:39], v5
  v_smfmac_f32_32x32x32_bf16 a[0:15], v[110:113], v[40:47], v5
  v_smfmac_f32_32x32x32_bf16 a[16:31], v[106:109], v[48:55], v5
  v_smfmac_f32_32x32x32_bf16 a[16:31], v[110:113], v[56:63], v5
  v_mfma_f32_32x32x4_2b_bf16 v[32:63], v[104:105], a[114:115], 0 cbsz:1 abid:1
  s_nop 15
  s_nop 1
  v_mfma_f32_32x32x16_bf16 v[32:47], v[100:103], a[106:109], v[32:47]
  v_mfma_f32_32x32x16_bf16 v[48:63], v[100:103], a[110:113], v[48:63]
  s_nop 10
  v_sub_f32 v32, v32, v126
  v_sub_f32 v33, v33, v126
  v_sub_f32 v34, v34, v126
  v_sub_f32 v35, v35, v126
  v_sub_f32 v36, v36, v126
  v_sub_f32 v37, v37, v126
  v_sub_f32 v38, v38, v126
  v_sub_f32 v39, v39, v126
  v_sub_f32 v40, v40, v126
  v_sub_f32 v41, v41, v126
  v_sub_f32 v42, v42, v126
  v_sub_f32 v43, v43, v126
  v_sub_f32 v44, v44, v126
  v_sub_f32 v45, v45, v126
  v_sub_f32 v46, v46, v126
  v_sub_f32 v47, v47, v126
  v_sub_f32 v48, v48, v127
  v_sub_f32 v49, v49, v127
  v_sub_f32 v50, v50, v127
  v_sub_f32 v51, v51, v127
  v_sub_f32 v52, v52, v127
  v_sub_f32 v53, v53, v127
  v_sub_f32 v54, v54, v127
  v_sub_f32 v55, v55, v127
  v_sub_f32 v56, v56, v127
  v_sub_f32 v57, v57, v127
  v_sub_f32 v58, v58, v127
  v_sub_f32 v59, v59, v127
  v_sub_f32 v60, v60, v127
  v_sub_f32 v61, v61, v127
  v_sub_f32 v62, v62, v127
  v_sub_f32 v63, v63, v127
  v_exp_f32 v32, v32
  v_exp_f32 v33, v33
  v_exp_f32 v34, v34
  v_exp_f32 v35, v35
  v_exp_f32 v36, v36
  v_exp_f32 v37, v37
  v_exp_f32 v38, v38
  v_exp_f32 v39, v39
  v_exp_f32 v40, v40
  v_exp_f32 v41, v41
  v_exp_f32 v42, v42
  v_exp_f32 v43, v43
  v_exp_f32 v44, v44
  v_exp_f32 v45, v45
  v_exp_f32 v46, v46
  v_exp_f32 v47, v47
  v_exp_f32 v48, v48
  v_exp_f32 v49, v49
  v_exp_f32 v50, v50
  v_exp_f32 v51, v51
  v_exp_f32 v52, v52
  v_exp_f32 v53, v53
  v_exp_f32 v54, v54
  v_exp_f32 v55, v55
  v_exp_f32 v56, v56
  v_exp_f32 v57, v57
  v_exp_f32 v58, v58
  v_exp_f32 v59, v59
  v_exp_f32 v60, v60
  v_exp_f32 v61, v61
  v_exp_f32 v62, v62
  v_exp_f32 v63, v63
  v_smfmac_f32_32x32x32_bf16 a[0:15], v[114:117], v[32:39], v5
  v_smfmac_f32_32x32x32_bf16 a[0:15], v[118:121], v[40:47], v5
  v_smfmac_f32_32x32x32_bf16 a[16:31], v[114:117], v[48:55], v5
  v_smfmac_f32_32x32x32_bf16 a[16:31], v[118:121], v[56:63], v5
  v_mfma_f32_32x32x4_2b_bf16 v[32:63], v[104:105], a[124:125], 0 cbsz:1 abid:0
  s_nop 15
  s_nop 1
  v_mfma_f32_32x32x16_bf16 v[32:47], v[96:99], a[116:119], v[32:47]
  v_mfma_f32_32x32x16_bf16 v[48:63], v[96:99], a[120:123], v[48:63]
  s_nop 10
  v_sub_f32 v32, v32, v128
  v_sub_f32 v33, v33, v128
  v_sub_f32 v34, v34, v128
  v_sub_f32 v35, v35, v128
  v_sub_f32 v36, v36, v128
  v_sub_f32 v37, v37, v128
  v_sub_f32 v38, v38, v128
  v_sub_f32 v39, v39, v128
  v_sub_f32 v40, v40, v128
  v_sub_f32 v41, v41, v128
  v_sub_f32 v42, v42, v128
  v_sub_f32 v43, v43, v128
  v_sub_f32 v44, v44, v128
  v_sub_f32 v45, v45, v128
  v_sub_f32 v46, v46, v128
  v_sub_f32 v47, v47, v128
  v_sub_f32 v48, v48, v129
  v_sub_f32 v49, v49, v129
  v_sub_f32 v50, v50, v129
  v_sub_f32 v51, v51, v129
  v_sub_f32 v52, v52, v129
  v_sub_f32 v53, v53, v129
  v_sub_f32 v54, v54, v129
  v_sub_f32 v55, v55, v129
  v_sub_f32 v56, v56, v129
  v_sub_f32 v57, v57, v129
  v_sub_f32 v58, v58, v129
  v_sub_f32 v59, v59, v129
  v_sub_f32 v60, v60, v129
  v_sub_f32 v61, v61, v129
  v_sub_f32 v62, v62, v129
  v_sub_f32 v63, v63, v129
  v_exp_f32 v32, v32
  v_exp_f32 v33, v33
  v_exp_f32 v34, v34
  v_exp_f32 v35, v35
  v_exp_f32 v36, v36
  v_exp_f32 v37, v37
  v_exp_f32 v38, v38
  v_exp_f32 v39, v39
  v_exp_f32 v40, v40
  v_exp_f32 v41, v41
  v_exp_f32 v42, v42
  v_exp_f32 v43, v43
  v_exp_f32 v44, v44
  v_exp_f32 v45, v45
  v_exp_f32 v46, v46
  v_exp_f32 v47, v47
  v_exp_f32 v48, v48
  v_exp_f32 v49, v49
  v_exp_f32 v50, v50
  v_exp_f32 v51, v51
  v_exp_f32 v52, v52
  v_exp_f32 v53, v53
  v_exp_f32 v54, v54
  v_exp_f32 v55, v55
  v_exp_f32 v56, v56
  v_exp_f32 v57, v57
  v_exp_f32 v58, v58
  v_exp_f32 v59, v59
  v_exp_f32 v60, v60
  v_exp_f32 v61, v61
  v_exp_f32 v62, v62
  v_exp_f32 v63, v63
  v_smfmac_f32_32x32x32_bf16 a[32:47], v[106:109], v[32:39], v5
  v_smfmac_f32_32x32x32_bf16 a[32:47], v[110:113], v[40:47], v5
  v_smfmac_f32_32x32x32_bf16 a[48:63], v[106:109], v[48:55], v5
  v_smfmac_f32_32x32x32_bf16 a[48:63], v[110:113], v[56:63], v5
  v_mfma_f32_32x32x4_2b_bf16 v[32:63], v[104:105], a[124:125], 0 cbsz:1 abid:1
  s_nop 15
  s_nop 1
  v_mfma_f32_32x32x16_bf16 v[32:47], v[100:103], a[116:119], v[32:47]
  v_mfma_f32_32x32x16_bf16 v[48:63], v[100:103], a[120:123], v[48:63]
  s_nop 10
  v_sub_f32 v32, v32, v128
  v_sub_f32 v33, v33, v128
  v_sub_f32 v34, v34, v128
  v_sub_f32 v35, v35, v128
  v_sub_f32 v36, v36, v128
  v_sub_f32 v37, v37, v128
  v_sub_f32 v38, v38, v128
  v_sub_f32 v39, v39, v128
  v_sub_f32 v40, v40, v128
  v_sub_f32 v41, v41, v128
  v_sub_f32 v42, v42, v128
  v_sub_f32 v43, v43, v128
  v_sub_f32 v44, v44, v128
  v_sub_f32 v45, v45, v128
  v_sub_f32 v46, v46, v128
  v_sub_f32 v47, v47, v128
  v_sub_f32 v48, v48, v129
  v_sub_f32 v49, v49, v129
  v_sub_f32 v50, v50, v129
  v_sub_f32 v51, v51, v129
  v_sub_f32 v52, v52, v129
  v_sub_f32 v53, v53, v129
  v_sub_f32 v54, v54, v129
  v_sub_f32 v55, v55, v129
  v_sub_f32 v56, v56, v129
  v_sub_f32 v57, v57, v129
  v_sub_f32 v58, v58, v129
  v_sub_f32 v59, v59, v129
  v_sub_f32 v60, v60, v129
  v_sub_f32 v61, v61, v129
  v_sub_f32 v62, v62, v129
  v_sub_f32 v63, v63, v129
  v_exp_f32 v32, v32
  v_exp_f32 v33, v33
  v_exp_f32 v34, v34
  v_exp_f32 v35, v35
  v_exp_f32 v36, v36
  v_exp_f32 v37, v37
  v_exp_f32 v38, v38
  v_exp_f32 v39, v39
  v_exp_f32 v40, v40
  v_exp_f32 v41, v41
  v_exp_f32 v42, v42
  v_exp_f32 v43, v43
  v_exp_f32 v44, v44
  v_exp_f32 v45, v45
  v_exp_f32 v46, v46
  v_exp_f32 v47, v47
  v_exp_f32 v48, v48
  v_exp_f32 v49, v49
  v_exp_f32 v50, v50
  v_exp_f32 v51, v51
  v_exp_f32 v52, v52
  v_exp_f32 v53, v53
  v_exp_f32 v54, v54
  v_exp_f32 v55, v55
  v_exp_f32 v56, v56
  v_exp_f32 v57, v57
  v_exp_f32 v58, v58
  v_exp_f32 v59, v59
  v_exp_f32 v60, v60
  v_exp_f32 v61, v61
  v_exp_f32 v62, v62
  v_exp_f32 v63, v63
  v_smfmac_f32_32x32x32_bf16 a[32:47], v[114:117], v[32:39], v5
  v_smfmac_f32_32x32x32_bf16 a[32:47], v[118:121], v[40:47], v5
  v_smfmac_f32_32x32x32_bf16 a[48:63], v[114:117], v[48:55], v5
  v_smfmac_f32_32x32x32_bf16 a[48:63], v[118:121], v[56:63], v5
  v_mfma_f32_32x32x4_2b_bf16 v[32:63], v[104:105], a[134:135], 0 cbsz:1 abid:0
  s_nop 15
  s_nop 1
  v_mfma_f32_32x32x16_bf16 v[32:47], v[96:99], a[126:129], v[32:47]
  v_mfma_f32_32x32x16_bf16 v[48:63], v[96:99], a[130:133], v[48:63]
  s_nop 10
  v_sub_f32 v32, v32, v130
  v_sub_f32 v33, v33, v130
  v_sub_f32 v34, v34, v130
  v_sub_f32 v35, v35, v130
  v_sub_f32 v36, v36, v130
  v_sub_f32 v37, v37, v130
  v_sub_f32 v38, v38, v130
  v_sub_f32 v39, v39, v130
  v_sub_f32 v40, v40, v130
  v_sub_f32 v41, v41, v130
  v_sub_f32 v42, v42, v130
  v_sub_f32 v43, v43, v130
  v_sub_f32 v44, v44, v130
  v_sub_f32 v45, v45, v130
  v_sub_f32 v46, v46, v130
  v_sub_f32 v47, v47, v130
  v_sub_f32 v48, v48, v131
  v_sub_f32 v49, v49, v131
  v_sub_f32 v50, v50, v131
  v_sub_f32 v51, v51, v131
  v_sub_f32 v52, v52, v131
  v_sub_f32 v53, v53, v131
  v_sub_f32 v54, v54, v131
  v_sub_f32 v55, v55, v131
  v_sub_f32 v56, v56, v131
  v_sub_f32 v57, v57, v131
  v_sub_f32 v58, v58, v131
  v_sub_f32 v59, v59, v131
  v_sub_f32 v60, v60, v131
  v_sub_f32 v61, v61, v131
  v_sub_f32 v62, v62, v131
  v_sub_f32 v63, v63, v131
  v_exp_f32 v32, v32
  v_exp_f32 v33, v33
  v_exp_f32 v34, v34
  v_exp_f32 v35, v35
  v_exp_f32 v36, v36
  v_exp_f32 v37, v37
  v_exp_f32 v38, v38
  v_exp_f32 v39, v39
  v_exp_f32 v40, v40
  v_exp_f32 v41, v41
  v_exp_f32 v42, v42
  v_exp_f32 v43, v43
  v_exp_f32 v44, v44
  v_exp_f32 v45, v45
  v_exp_f32 v46, v46
  v_exp_f32 v47, v47
  v_exp_f32 v48, v48
  v_exp_f32 v49, v49
  v_exp_f32 v50, v50
  v_exp_f32 v51, v51
  v_exp_f32 v52, v52
  v_exp_f32 v53, v53
  v_exp_f32 v54, v54
  v_exp_f32 v55, v55
  v_exp_f32 v56, v56
  v_exp_f32 v57, v57
  v_exp_f32 v58, v58
  v_exp_f32 v59, v59
  v_exp_f32 v60, v60
  v_exp_f32 v61, v61
  v_exp_f32 v62, v62
  v_exp_f32 v63, v63
  v_smfmac_f32_32x32x32_bf16 a[64:79], v[106:109], v[32:39], v5
  v_smfmac_f32_32x32x32_bf16 a[64:79], v[110:113], v[40:47], v5
  v_smfmac_f32_32x32x32_bf16 a[80:95], v[106:109], v[48:55], v5
  v_smfmac_f32_32x32x32_bf16 a[80:95], v[110:113], v[56:63], v5
  v_mfma_f32_32x32x4_2b_bf16 v[32:63], v[104:105], a[134:135], 0 cbsz:1 abid:1
  s_nop 15
  s_nop 1
  v_mfma_f32_32x32x16_bf16 v[32:47], v[100:103], a[126:129], v[32:47]
  v_mfma_f32_32x32x16_bf16 v[48:63], v[100:103], a[130:133], v[48:63]
  s_nop 10
  v_sub_f32 v32, v32, v130
  v_sub_f32 v33, v33, v130
  v_sub_f32 v34, v34, v130
  v_sub_f32 v35, v35, v130
  v_sub_f32 v36, v36, v130
  v_sub_f32 v37, v37, v130
  v_sub_f32 v38, v38, v130
  v_sub_f32 v39, v39, v130
  v_sub_f32 v40, v40, v130
  v_sub_f32 v41, v41, v130
  v_sub_f32 v42, v42, v130
  v_sub_f32 v43, v43, v130
  v_sub_f32 v44, v44, v130
  v_sub_f32 v45, v45, v130
  v_sub_f32 v46, v46, v130
  v_sub_f32 v47, v47, v130
  v_sub_f32 v48, v48, v131
  v_sub_f32 v49, v49, v131
  v_sub_f32 v50, v50, v131
  v_sub_f32 v51, v51, v131
  v_sub_f32 v52, v52, v131
  v_sub_f32 v53, v53, v131
  v_sub_f32 v54, v54, v131
  v_sub_f32 v55, v55, v131
  v_sub_f32 v56, v56, v131
  v_sub_f32 v57, v57, v131
  v_sub_f32 v58, v58, v131
  v_sub_f32 v59, v59, v131
  v_sub_f32 v60, v60, v131
  v_sub_f32 v61, v61, v131
  v_sub_f32 v62, v62, v131
  v_sub_f32 v63, v63, v131
  v_exp_f32 v32, v32
  v_exp_f32 v33, v33
  v_exp_f32 v34, v34
  v_exp_f32 v35, v35
  v_exp_f32 v36, v36
  v_exp_f32 v37, v37
  v_exp_f32 v38, v38
  v_exp_f32 v39, v39
  v_exp_f32 v40, v40
  v_exp_f32 v41, v41
  v_exp_f32 v42, v42
  v_exp_f32 v43, v43
  v_exp_f32 v44, v44
  v_exp_f32 v45, v45
  v_exp_f32 v46, v46
  v_exp_f32 v47, v47
  v_exp_f32 v48, v48
  v_exp_f32 v49, v49
  v_exp_f32 v50, v50
  v_exp_f32 v51, v51
  v_exp_f32 v52, v52
  v_exp_f32 v53, v53
  v_exp_f32 v54, v54
  v_exp_f32 v55, v55
  v_exp_f32 v56, v56
  v_exp_f32 v57, v57
  v_exp_f32 v58, v58
  v_exp_f32 v59, v59
  v_exp_f32 v60, v60
  v_exp_f32 v61, v61
  v_exp_f32 v62, v62
  v_exp_f32 v63, v63
  v_smfmac_f32_32x32x32_bf16 a[64:79], v[114:117], v[32:39], v5
  v_smfmac_f32_32x32x32_bf16 a[64:79], v[118:121], v[40:47], v5
  v_smfmac_f32_32x32x32_bf16 a[80:95], v[114:117], v[48:55], v5
  v_smfmac_f32_32x32x32_bf16 a[80:95], v[118:121], v[56:63], v5
  v_mfma_f32_32x32x4_2b_bf16 v[32:63], v[104:105], a[104:105], 0 cbsz:1 abid:0
  s_nop 15
  s_nop 1
  v_mfma_f32_32x32x16_bf16 v[32:47], v[96:99], a[96:99], v[32:47]
  v_mfma_f32_32x32x16_bf16 v[48:63], v[96:99], a[100:103], v[48:63]
  s_nop 10
  v_sub_f32 v32, v32, v124
  v_sub_f32 v33, v33, v124
  v_sub_f32 v34, v34, v124
  v_sub_f32 v35, v35, v124
  v_sub_f32 v36, v36, v124
  v_sub_f32 v37, v37, v124
  v_sub_f32 v38, v38, v124
  v_sub_f32 v39, v39, v124
  v_sub_f32 v40, v40, v124
  v_sub_f32 v41, v41, v124
  v_sub_f32 v42, v42, v124
  v_sub_f32 v43, v43, v124
  v_sub_f32 v44, v44, v124
  v_sub_f32 v45, v45, v124
  v_sub_f32 v46, v46, v124
  v_sub_f32 v47, v47, v124
  v_sub_f32 v48, v48, v125
  v_sub_f32 v49, v49, v125
  v_sub_f32 v50, v50, v125
  v_sub_f32 v51, v51, v125
  v_sub_f32 v52, v52, v125
  v_sub_f32 v53, v53, v125
  v_sub_f32 v54, v54, v125
  v_sub_f32 v55, v55, v125
  v_sub_f32 v56, v56, v125
  v_sub_f32 v57, v57, v125
  v_sub_f32 v58, v58, v125
  v_sub_f32 v59, v59, v125
  v_sub_f32 v60, v60, v125
  v_sub_f32 v61, v61, v125
  v_sub_f32 v62, v62, v125
  v_sub_f32 v63, v63, v125
  v_exp_f32 v32, v32
  v_exp_f32 v33, v33
  v_exp_f32 v34, v34
  v_exp_f32 v35, v35
  v_exp_f32 v36, v36
  v_exp_f32 v37, v37
  v_exp_f32 v38, v38
  v_exp_f32 v39, v39
  v_exp_f32 v40, v40
  v_exp_f32 v41, v41
  v_exp_f32 v42, v42
  v_exp_f32 v43, v43
  v_exp_f32 v44, v44
  v_exp_f32 v45, v45
  v_exp_f32 v46, v46
  v_exp_f32 v47, v47
  v_exp_f32 v48, v48
  v_exp_f32 v49, v49
  v_exp_f32 v50, v50
  v_exp_f32 v51, v51
  v_exp_f32 v52, v52
  v_exp_f32 v53, v53
  v_exp_f32 v54, v54
  v_exp_f32 v55, v55
  v_exp_f32 v56, v56
  v_exp_f32 v57, v57
  v_exp_f32 v58, v58
  v_exp_f32 v59, v59
  v_exp_f32 v60, v60
  v_exp_f32 v61, v61
  v_exp_f32 v62, v62
  v_exp_f32 v63, v63
  v_smfmac_f32_32x32x32_bf16 v[148:163], v[106:109], v[32:39], v5
  v_smfmac_f32_32x32x32_bf16 v[148:163], v[110:113], v[40:47], v5
  v_smfmac_f32_32x32x32_bf16 v[164:179], v[106:109], v[48:55], v5
  v_smfmac_f32_32x32x32_bf16 v[164:179], v[110:113], v[56:63], v5
  v_mfma_f32_32x32x4_2b_bf16 v[32:63], v[104:105], a[104:105], 0 cbsz:1 abid:1
  s_nop 15
  s_nop 1
  v_mfma_f32_32x32x16_bf16 v[32:47], v[100:103], a[96:99], v[32:47]
  v_mfma_f32_32x32x16_bf16 v[48:63], v[100:103], a[100:103], v[48:63]
  s_nop 10
  v_sub_f32 v32, v32, v124
  v_sub_f32 v33, v33, v124
  v_sub_f32 v34, v34, v124
  v_sub_f32 v35, v35, v124
  v_sub_f32 v36, v36, v124
  v_sub_f32 v37, v37, v124
  v_sub_f32 v38, v38, v124
  v_sub_f32 v39, v39, v124
  v_sub_f32 v40, v40, v124
  v_sub_f32 v41, v41, v124
  v_sub_f32 v42, v42, v124
  v_sub_f32 v43, v43, v124
  v_sub_f32 v44, v44, v124
  v_sub_f32 v45, v45, v124
  v_sub_f32 v46, v46, v124
  v_sub_f32 v47, v47, v124
  v_sub_f32 v48, v48, v125
  v_sub_f32 v49, v49, v125
  v_sub_f32 v50, v50, v125
  v_sub_f32 v51, v51, v125
  v_sub_f32 v52, v52, v125
  v_sub_f32 v53, v53, v125
  v_sub_f32 v54, v54, v125
  v_sub_f32 v55, v55, v125
  v_sub_f32 v56, v56, v125
  v_sub_f32 v57, v57, v125
  v_sub_f32 v58, v58, v125
  v_sub_f32 v59, v59, v125
  v_sub_f32 v60, v60, v125
  v_sub_f32 v61, v61, v125
  v_sub_f32 v62, v62, v125
  v_sub_f32 v63, v63, v125
  v_exp_f32 v32, v32
  v_exp_f32 v33, v33
  v_exp_f32 v34, v34
  v_exp_f32 v35, v35
  v_exp_f32 v36, v36
  v_exp_f32 v37, v37
  v_exp_f32 v38, v38
  v_exp_f32 v39, v39
  v_exp_f32 v40, v40
  v_exp_f32 v41, v41
  v_exp_f32 v42, v42
  v_exp_f32 v43, v43
  v_exp_f32 v44, v44
  v_exp_f32 v45, v45
  v_exp_f32 v46, v46
  v_exp_f32 v47, v47
  v_exp_f32 v48, v48
  v_exp_f32 v49, v49
  v_exp_f32 v50, v50
  v_exp_f32 v51, v51
  v_exp_f32 v52, v52
  v_exp_f32 v53, v53
  v_exp_f32 v54, v54
  v_exp_f32 v55, v55
  v_exp_f32 v56, v56
  v_exp_f32 v57, v57
  v_exp_f32 v58, v58
  v_exp_f32 v59, v59
  v_exp_f32 v60, v60
  v_exp_f32 v61, v61
  v_exp_f32 v62, v62
  v_exp_f32 v63, v63
  v_smfmac_f32_32x32x32_bf16 v[148:163], v[114:117], v[32:39], v5
  v_smfmac_f32_32x32x32_bf16 v[148:163], v[118:121], v[40:47], v5
  v_smfmac_f32_32x32x32_bf16 v[164:179], v[114:117], v[48:55], v5
  v_smfmac_f32_32x32x32_bf16 v[164:179], v[118:121], v[56:63], v5
  s_add_u32 s74, s74, 4
  s_cmp_lt_u32 s74, 32
  s_cbranch_scc1 L_fb1
  s_nop 15
  ds_write_b128 v23, a[0:3] offset:1024
  ds_write_b128 v23, a[4:7] offset:2048
  ds_write_b128 v23, a[8:11] offset:3072
  ds_write_b128 v23, a[16:19] offset:4096
  ds_write_b128 v23, a[20:23] offset:5120
  ds_write_b128 v23, a[24:27] offset:6144
  s_waitcnt lgkmcnt(0)
  s_barrier
  ds_read_b128 v[96:99], v26 offset:1024
  ds_read_b128 v[100:103], v26 offset:2048
  ds_read_b128 v[104:107], v26 offset:3072
  ds_read_b128 v[108:111], v26 offset:4096
  ds_read_b128 v[112:115], v26 offset:5120
  ds_read_b128 v[116:119], v26 offset:6144
  s_waitcnt lgkmcnt(0)
  v_add_f32 v148, v148, v96
  v_add_f32 v149, v149, v97
  v_add_f32 v150, v150, v98
  v_add_f32 v151, v151, v99
  v_add_f32 v152, v152, v100
  v_add_f32 v153, v153, v101
  v_add_f32 v154, v154, v102
  v_add_f32 v155, v155, v103
  v_add_f32 v156, v156, v104
  v_add_f32 v157, v157, v105
  v_add_f32 v158, v158, v106
  v_add_f32 v164, v164, v108
  v_add_f32 v165, v165, v109
  v_add_f32 v166, v166, v110
  v_add_f32 v167, v167, v111
  v_add_f32 v168, v168, v112
  v_add_f32 v169, v169, v113
  v_add_f32 v170, v170, v114
  v_add_f32 v171, v171, v115
  v_add_f32 v172, v172, v116
  v_add_f32 v173, v173, v117
  v_add_f32 v174, v174, v118
  s_barrier
  ds_write_b128 v24, a[32:35] offset:1024
  ds_write_b128 v24, a[36:39] offset:2048
  ds_write_b128 v24, a[40:43] offset:3072
  ds_write_b128 v24, a[48:51] offset:4096
  ds_write_b128 v24, a[52:55] offset:5120
  ds_write_b128 v24, a[56:59] offset:6144
  s_waitcnt lgkmcnt(0)
  s_barrier
  ds_read_b128 v[96:99], v26 offset:1024
  ds_read_b128 v[100:103], v26 offset:2048
  ds_read_b128 v[104:107], v26 offset:3072
  ds_read_b128 v[108:111], v26 offset:4096
  ds_read_b128 v[112:115], v26 offset:5120
  ds_read_b128 v[116:119], v26 offset:6144
  s_waitcnt lgkmcnt(0)
  v_add_f32 v148, v148, v96
  v_add_f32 v149, v149, v97
  v_add_f32 v150, v150, v98
  v_add_f32 v151, v151, v99
  v_add_f32 v152, v152, v100
  v_add_f32 v153, v153, v101
  v_add_f32 v154, v154, v102
  v_add_f32 v155, v155, v103
  v_add_f32 v156, v156, v104
  v_add_f32 v157, v157, v105
  v_add_f32 v158, v158, v106
  v_add_f32 v164, v164, v108
  v_add_f32 v165, v165, v109
  v_add_f32 v166, v166, v110
  v_add_f32 v167, v167, v111
  v_add_f32 v168, v168, v112
  v_add_f32 v169, v169, v113
  v_add_f32 v170, v170, v114
  v_add_f32 v171, v171, v115
  v_add_f32 v172, v172, v116
  v_add_f32 v173, v173, v117
  v_add_f32 v174, v174, v118
  s_barrier
  ds_write_b128 v25, a[64:67] offset:1024
  ds_write_b128 v25, a[68:71] offset:2048
  ds_write_b128 v25, a[72:75] offset:3072
  ds_write_b128 v25, a[80:83] offset:4096
  ds_write_b128 v25, a[84:87] offset:5120
  ds_write_b128 v25, a[88:91] offset:6144
  s_waitcnt lgkmcnt(0)
  s_barrier
  ds_read_b128 v[96:99], v26 offset:1024
  ds_read_b128 v[100:103], v26 offset:2048
  ds_read_b128 v[104:107], v26 offset:3072
  ds_read_b128 v[108:111], v26 offset:4096
  ds_read_b128 v[112:115], v26 offset:5120
  ds_read_b128 v[116:119], v26 offset:6144
  s_waitcnt lgkmcnt(0)
  s_branch L_attn_sum
L_end:
.section .rodata,"a"
.p2align 6
.amdhsa_kernel sequential_preLN__grouped_kv_mqa__mixer_token_mlp__prompt_kernel
  .amdhsa_next_free_vgpr 512
  .amdhsa_next_free_sgpr 102
  .amdhsa_accum_offset 256
  .amdhsa_group_segment_fixed_size 0
  .amdhsa_kernarg_size 104
  .amdhsa_user_sgpr_count 2
  .amdhsa_user_sgpr_kernarg_segment_ptr 1
  .amdhsa_system_sgpr_workgroup_id_x 1
  .amdhsa_float_denorm_mode_32 3
.end_amdhsa_kernel
```
